```python
import torch

def _softmax(x, axis=-1):
    return torch.softmax(x, dim=axis)
def _gelu(x):
    return torch.nn.functional.gelu(x, approximate="tanh")
def _silu(x):
    return torch.nn.functional.silu(x)
def _sigmoid(x):
    return torch.sigmoid(x)
def _layernorm(x, axis=-1, eps=1e-5):
    m = x.mean(dim=axis, keepdim=True)
    v = x.var(dim=axis, keepdim=True, unbiased=False)
    return (x - m) / torch.sqrt(v + eps)
def _scatter_add(tgt, idx, src, axis=0):
    return tgt.clone().index_add_(axis, idx, src)
def _segment_sum(src, seg, n):
    out = torch.zeros((n,) + src.shape[1:], dtype=src.dtype)
    return out.index_add_(0, seg, src)
def _pad(x, pw):
    flat = tuple(v for pair in reversed(pw) for v in pair)
    return torch.nn.functional.pad(x, flat)

kernel_name = 'sequential_preLN__spectral_gfnet__mixer_channel_mlp__prompt'

def setup_inputs():

    _w = (lambda a: (lambda t: t.to(torch.bfloat16) if t.is_floating_point() else t)(torch.as_tensor(a)))
    def _A_setup():
        B, S, D = 1, 2048, 640
        Df = D // 2 + 1
        return {
            "x": _w((lambda *s: torch.randn(*s, dtype=torch.bfloat16) * 0.05)(B, S, D)),
            "w_r": _w((lambda *s: torch.randn(*s, dtype=torch.bfloat16) * 0.8)(S, Df) * 0.02),
            "w_i": _w((lambda *s: torch.randn(*s, dtype=torch.bfloat16) * 0.8)(S, Df) * 0.02),
        }
    _A_in = _A_setup()

    def _B_setup():
        B, S, D, F = 1, 2048, 640, 1728
        return {
            "x": _w((lambda *s: torch.randn(*s, dtype=torch.bfloat16) * 0.05)(B, S, D)),
            "w1": _w((lambda *s: torch.randn(*s, dtype=torch.bfloat16) * 0.8)(D, F) * (D ** -0.5)),
            "b1": _w((lambda *s: torch.randn(*s, dtype=torch.bfloat16) * 0.4)(F)),
            "w2": _w((lambda *s: torch.randn(*s, dtype=torch.bfloat16) * 0.05)(F, D) * (F ** -0.5)),
            "b2": _w((lambda *s: torch.randn(*s, dtype=torch.bfloat16) * 0.05)(D)),
        }
    _B_in = _B_setup()

    return {
        "A_x": _A_in["x"],
        "A_w_r": _A_in["w_r"],
        "A_w_i": _A_in["w_i"],
        "B_x": _B_in["x"],
        "B_w1": _B_in["w1"],
        "B_b1": _B_in["b1"],
        "B_w2": _B_in["w2"],
        "B_b2": _B_in["b2"],
    }

def reference(A_x, A_w_r, A_w_i, B_x, B_w1, B_b1, B_w2, B_b2):
    def _A_ref(x, w_r, w_i):
        B, S, D = x.shape
        X = (lambda x, axes=(-2,-1): torch.fft.rfft2(x.float(), dim=axes))(x, axes=(-2, -1))
        W = w_r + 1j * w_i
        X = X * W
        y = (lambda x, s, axes=(-2,-1): torch.fft.irfft2(x, s=s, dim=axes).to(torch.bfloat16))(X, (S, D), axes=(-2, -1))
        return y

    def _B_ref(x, w1, b1, w2, b2):
        y = _layernorm(x, axis=-1)
        h = _gelu(torch.einsum("bsd,df->bsf", y, w1) + b1)
        return torch.einsum("bsf,fd->bsd", h, w2) + b2

    x = A_x
    h = x + _A_ref(_layernorm(x, axis=-1), A_w_r, A_w_i)
    h2 = h + _B_ref(_layernorm(h, axis=-1), B_w1, B_b1, B_w2, B_b2)
    return h2
```

```asm
; @launch kernel=k1_kernel grid=(448,1,1) block=(256,1,1) lds=23040
; @launch kernel=k2_kernel grid=(321,1,1) block=(256,1,1) lds=36864
; @launch kernel=k3_kernel grid=(531,1,1) block=(256,1,1) lds=23040
; @launch kernel=k4_kernel grid=(256,1,1) block=(512,1,1) lds=131072
; @launch kernel=k5_kernel grid=(256,1,1) block=(512,1,1) lds=122880
.amdgcn_target "amdgcn-amd-amdhsa--gfx950"
.text
.globl k1_kernel
.p2align 8
.type k1_kernel,@function
k1_kernel:
    s_load_dwordx2 s[4:5], s[0:1], 80
    s_load_dwordx2 s[6:7], s[0:1], 0
    s_cmp_ge_u32 s2, 448
    s_cbranch_scc1 k1_end
    v_lshrrev_b32 v1, 6, v0
    v_and_b32 v0, 63, v0
    s_nop 0
    v_readfirstlane_b32 s3, v1
    s_cmp_ge_u32 s2, 256
    s_cbranch_scc1 k1_tr
    s_waitcnt lgkmcnt(0)
    s_mov_b32 s8, s6
    s_mov_b32 s9, s7
    s_mov_b32 s10, 0x280000
    s_mov_b32 s11, 0x00020000
    s_mov_b32 s12, s4
    s_mov_b32 s13, s5
    s_mov_b32 s14, 0x504000
    s_mov_b32 s15, 0x00020000
    s_lshl_b32 s16, s2, 2
    s_add_u32 s16, s16, s3
    s_mul_i32 s17, s16, 2560
    s_mul_i32 s18, s3, 5760
    s_lshl_b32 s19, s16, 4
    v_lshlrev_b32 v1, 1, v0
    v_mov_b32 v2, 0
    v_mov_b32 v3, 0
    v_mov_b32 v4, 0
    v_mov_b32 v5, 0
    v_mov_b32 v6, 0
    v_mov_b32 v7, 0
    v_mov_b32 v8, 0
    v_mov_b32 v9, 0
    v_mov_b32 v10, 0
    v_mov_b32 v11, 0
    v_mov_b32 v12, 0
    v_mov_b32 v13, 0
    v_mov_b32 v14, 0
    v_mov_b32 v15, 0
    v_mov_b32 v16, 0
    v_mov_b32 v17, 0
    v_mov_b32 v18, 0
    v_mov_b32 v19, 0
    v_mov_b32 v20, 0
    v_mov_b32 v21, 0
    buffer_load_short_d16_hi v2, v1, s[8:11], s17 offen offset:0
    buffer_load_short_d16_hi v3, v1, s[8:11], s17 offen offset:1280
    buffer_load_short_d16_hi v4, v1, s[8:11], s17 offen offset:128
    buffer_load_short_d16_hi v5, v1, s[8:11], s17 offen offset:1408
    buffer_load_short_d16_hi v6, v1, s[8:11], s17 offen offset:256
    buffer_load_short_d16_hi v7, v1, s[8:11], s17 offen offset:1536
    buffer_load_short_d16_hi v8, v1, s[8:11], s17 offen offset:384
    buffer_load_short_d16_hi v9, v1, s[8:11], s17 offen offset:1664
    buffer_load_short_d16_hi v10, v1, s[8:11], s17 offen offset:512
    buffer_load_short_d16_hi v11, v1, s[8:11], s17 offen offset:1792
    buffer_load_short_d16_hi v12, v1, s[8:11], s17 offen offset:640
    buffer_load_short_d16_hi v13, v1, s[8:11], s17 offen offset:1920
    buffer_load_short_d16_hi v14, v1, s[8:11], s17 offen offset:768
    buffer_load_short_d16_hi v15, v1, s[8:11], s17 offen offset:2048
    buffer_load_short_d16_hi v16, v1, s[8:11], s17 offen offset:896
    buffer_load_short_d16_hi v17, v1, s[8:11], s17 offen offset:2176
    buffer_load_short_d16_hi v18, v1, s[8:11], s17 offen offset:1024
    buffer_load_short_d16_hi v19, v1, s[8:11], s17 offen offset:2304
    buffer_load_short_d16_hi v20, v1, s[8:11], s17 offen offset:1152
    buffer_load_short_d16_hi v21, v1, s[8:11], s17 offen offset:2432
    v_mov_b32 v22, 0x3f3504f3
    v_mov_b32 v23, 0x3f3504f3
    v_mov_b32 v24, 0x3e9e377a
    v_mov_b32 v25, 0xbf4f1bbd
    v_mov_b32 v26, 0x3f737871
    v_mov_b32 v27, 0x3f167918
    v_cvt_f32_u32 v1, v0
    v_mul_f32 v1, 0xbacccccd, v1
    v_cos_f32 v28, v1
    v_sin_f32 v29, v1
    s_nop 0
    v_pk_mul_f32 v[46:47], v[28:29], v[28:29] op_sel:[0,0] op_sel_hi:[1,0]
    v_pk_fma_f32 v[30:31], v[28:29], v[28:29], v[46:47] op_sel:[1,1,0] op_sel_hi:[0,1,1] neg_lo:[1,0,0]
    v_pk_mul_f32 v[46:47], v[30:31], v[28:29] op_sel:[0,0] op_sel_hi:[1,0]
    v_pk_fma_f32 v[32:33], v[30:31], v[28:29], v[46:47] op_sel:[1,1,0] op_sel_hi:[0,1,1] neg_lo:[1,0,0]
    v_pk_mul_f32 v[46:47], v[30:31], v[30:31] op_sel:[0,0] op_sel_hi:[1,0]
    v_pk_fma_f32 v[34:35], v[30:31], v[30:31], v[46:47] op_sel:[1,1,0] op_sel_hi:[0,1,1] neg_lo:[1,0,0]
    v_pk_mul_f32 v[46:47], v[34:35], v[28:29] op_sel:[0,0] op_sel_hi:[1,0]
    v_pk_fma_f32 v[36:37], v[34:35], v[28:29], v[46:47] op_sel:[1,1,0] op_sel_hi:[0,1,1] neg_lo:[1,0,0]
    v_pk_mul_f32 v[46:47], v[32:33], v[32:33] op_sel:[0,0] op_sel_hi:[1,0]
    v_pk_fma_f32 v[38:39], v[32:33], v[32:33], v[46:47] op_sel:[1,1,0] op_sel_hi:[0,1,1] neg_lo:[1,0,0]
    v_pk_mul_f32 v[46:47], v[34:35], v[32:33] op_sel:[0,0] op_sel_hi:[1,0]
    v_pk_fma_f32 v[40:41], v[34:35], v[32:33], v[46:47] op_sel:[1,1,0] op_sel_hi:[0,1,1] neg_lo:[1,0,0]
    v_pk_mul_f32 v[46:47], v[34:35], v[34:35] op_sel:[0,0] op_sel_hi:[1,0]
    v_pk_fma_f32 v[42:43], v[34:35], v[34:35], v[46:47] op_sel:[1,1,0] op_sel_hi:[0,1,1] neg_lo:[1,0,0]
    v_pk_mul_f32 v[46:47], v[42:43], v[28:29] op_sel:[0,0] op_sel_hi:[1,0]
    v_pk_fma_f32 v[44:45], v[42:43], v[28:29], v[46:47] op_sel:[1,1,0] op_sel_hi:[0,1,1] neg_lo:[1,0,0]
    v_and_b32 v1, 7, v0
    v_cvt_f32_u32 v46, v1
    v_mul_f32 v46, 0xbc800000, v46
    v_cos_f32 v48, v46
    v_sin_f32 v49, v46
    s_nop 0
    v_pk_mul_f32 v[46:47], v[48:49], v[48:49] op_sel:[0,0] op_sel_hi:[1,0]
    v_pk_fma_f32 v[50:51], v[48:49], v[48:49], v[46:47] op_sel:[1,1,0] op_sel_hi:[0,1,1] neg_lo:[1,0,0]
    v_pk_mul_f32 v[46:47], v[50:51], v[48:49] op_sel:[0,0] op_sel_hi:[1,0]
    v_pk_fma_f32 v[52:53], v[50:51], v[48:49], v[46:47] op_sel:[1,1,0] op_sel_hi:[0,1,1] neg_lo:[1,0,0]
    v_pk_mul_f32 v[46:47], v[50:51], v[50:51] op_sel:[0,0] op_sel_hi:[1,0]
    v_pk_fma_f32 v[54:55], v[50:51], v[50:51], v[46:47] op_sel:[1,1,0] op_sel_hi:[0,1,1] neg_lo:[1,0,0]
    v_pk_mul_f32 v[46:47], v[54:55], v[48:49] op_sel:[0,0] op_sel_hi:[1,0]
    v_pk_fma_f32 v[56:57], v[54:55], v[48:49], v[46:47] op_sel:[1,1,0] op_sel_hi:[0,1,1] neg_lo:[1,0,0]
    v_pk_mul_f32 v[46:47], v[52:53], v[52:53] op_sel:[0,0] op_sel_hi:[1,0]
    v_pk_fma_f32 v[58:59], v[52:53], v[52:53], v[46:47] op_sel:[1,1,0] op_sel_hi:[0,1,1] neg_lo:[1,0,0]
    v_pk_mul_f32 v[46:47], v[54:55], v[52:53] op_sel:[0,0] op_sel_hi:[1,0]
    v_pk_fma_f32 v[60:61], v[54:55], v[52:53], v[46:47] op_sel:[1,1,0] op_sel_hi:[0,1,1] neg_lo:[1,0,0]
    v_lshrrev_b32 v46, 3, v0
    v_lshlrev_b32 v47, 3, v0
    v_add_u32 v47, s18, v47
    v_mul_u32_u24 v62, 72, v46
    v_add_u32 v62, v62, v1
    v_lshlrev_b32 v62, 3, v62
    v_add_u32 v62, s18, v62
    v_mul_u32_u24 v63, 72, v46
    v_mad_u32_u24 v63, v1, 9, v63
    v_lshlrev_b32 v63, 3, v63
    v_add_u32 v63, s18, v63
    v_mad_u32_u24 v64, v1, 10, v46
    v_lshlrev_b32 v64, 3, v64
    v_add_u32 v64, s18, v64
    v_sub_u32 v65, 320, v0
    v_lshlrev_b32 v65, 3, v65
    v_add_u32 v65, s18, v65
    v_lshlrev_b32 v66, 14, v0
    s_waitcnt vmcnt(0)
    v_mov_b32 v74, 0x3acccccd
    v_mov_b32 v75, 0x3acccccd
    v_pk_add_f32 v[68:69], v[2:3], v[4:5]
    v_pk_add_f32 v[68:69], v[68:69], v[6:7]
    v_pk_add_f32 v[68:69], v[68:69], v[8:9]
    v_pk_add_f32 v[68:69], v[68:69], v[10:11]
    v_pk_add_f32 v[68:69], v[68:69], v[12:13]
    v_pk_add_f32 v[68:69], v[68:69], v[14:15]
    v_pk_add_f32 v[68:69], v[68:69], v[16:17]
    v_pk_add_f32 v[68:69], v[68:69], v[18:19]
    v_pk_add_f32 v[68:69], v[68:69], v[20:21]
    s_nop 1
    v_add_f32_dpp v68, v68, v68 quad_perm:[1,0,3,2] row_mask:0xf bank_mask:0xf
    v_add_f32_dpp v69, v69, v69 quad_perm:[1,0,3,2] row_mask:0xf bank_mask:0xf
    s_nop 1
    v_add_f32_dpp v68, v68, v68 quad_perm:[2,3,0,1] row_mask:0xf bank_mask:0xf
    v_add_f32_dpp v69, v69, v69 quad_perm:[2,3,0,1] row_mask:0xf bank_mask:0xf
    s_nop 1
    v_add_f32_dpp v68, v68, v68 row_half_mirror row_mask:0xf bank_mask:0xf
    v_add_f32_dpp v69, v69, v69 row_half_mirror row_mask:0xf bank_mask:0xf
    s_nop 1
    v_add_f32_dpp v68, v68, v68 row_mirror row_mask:0xf bank_mask:0xf
    v_add_f32_dpp v69, v69, v69 row_mirror row_mask:0xf bank_mask:0xf
    s_nop 1
    v_readlane_b32 s20, v68, 0
    v_readlane_b32 s21, v68, 16
    v_readlane_b32 s22, v68, 32
    v_readlane_b32 s23, v68, 48
    v_readlane_b32 s24, v69, 0
    v_readlane_b32 s25, v69, 16
    v_readlane_b32 s26, v69, 32
    v_readlane_b32 s27, v69, 48
    s_nop 1
    v_mov_b32 v68, s20
    v_add_f32 v68, s21, v68
    v_add_f32 v68, s22, v68
    v_add_f32 v68, s23, v68
    v_mov_b32 v69, s24
    v_add_f32 v69, s25, v69
    v_add_f32 v69, s26, v69
    v_add_f32 v69, s27, v69
    v_pk_mul_f32 v[68:69], v[68:69], v[74:75] op_sel:[0,0] op_sel_hi:[1,0]
    v_pk_add_f32 v[72:73], v[2:3], v[68:69] neg_lo:[0,1] neg_hi:[0,1]
    v_pk_mul_f32 v[70:71], v[72:73], v[72:73]
    v_pk_add_f32 v[72:73], v[4:5], v[68:69] neg_lo:[0,1] neg_hi:[0,1]
    v_pk_fma_f32 v[70:71], v[72:73], v[72:73], v[70:71]
    v_pk_add_f32 v[72:73], v[6:7], v[68:69] neg_lo:[0,1] neg_hi:[0,1]
    v_pk_fma_f32 v[70:71], v[72:73], v[72:73], v[70:71]
    v_pk_add_f32 v[72:73], v[8:9], v[68:69] neg_lo:[0,1] neg_hi:[0,1]
    v_pk_fma_f32 v[70:71], v[72:73], v[72:73], v[70:71]
    v_pk_add_f32 v[72:73], v[10:11], v[68:69] neg_lo:[0,1] neg_hi:[0,1]
    v_pk_fma_f32 v[70:71], v[72:73], v[72:73], v[70:71]
    v_pk_add_f32 v[72:73], v[12:13], v[68:69] neg_lo:[0,1] neg_hi:[0,1]
    v_pk_fma_f32 v[70:71], v[72:73], v[72:73], v[70:71]
    v_pk_add_f32 v[72:73], v[14:15], v[68:69] neg_lo:[0,1] neg_hi:[0,1]
    v_pk_fma_f32 v[70:71], v[72:73], v[72:73], v[70:71]
    v_pk_add_f32 v[72:73], v[16:17], v[68:69] neg_lo:[0,1] neg_hi:[0,1]
    v_pk_fma_f32 v[70:71], v[72:73], v[72:73], v[70:71]
    v_pk_add_f32 v[72:73], v[18:19], v[68:69] neg_lo:[0,1] neg_hi:[0,1]
    v_pk_fma_f32 v[70:71], v[72:73], v[72:73], v[70:71]
    v_pk_add_f32 v[72:73], v[20:21], v[68:69] neg_lo:[0,1] neg_hi:[0,1]
    v_pk_fma_f32 v[70:71], v[72:73], v[72:73], v[70:71]
    s_nop 1
    v_add_f32_dpp v70, v70, v70 quad_perm:[1,0,3,2] row_mask:0xf bank_mask:0xf
    v_add_f32_dpp v71, v71, v71 quad_perm:[1,0,3,2] row_mask:0xf bank_mask:0xf
    s_nop 1
    v_add_f32_dpp v70, v70, v70 quad_perm:[2,3,0,1] row_mask:0xf bank_mask:0xf
    v_add_f32_dpp v71, v71, v71 quad_perm:[2,3,0,1] row_mask:0xf bank_mask:0xf
    s_nop 1
    v_add_f32_dpp v70, v70, v70 row_half_mirror row_mask:0xf bank_mask:0xf
    v_add_f32_dpp v71, v71, v71 row_half_mirror row_mask:0xf bank_mask:0xf
    s_nop 1
    v_add_f32_dpp v70, v70, v70 row_mirror row_mask:0xf bank_mask:0xf
    v_add_f32_dpp v71, v71, v71 row_mirror row_mask:0xf bank_mask:0xf
    s_nop 1
    v_readlane_b32 s20, v70, 0
    v_readlane_b32 s21, v70, 16
    v_readlane_b32 s22, v70, 32
    v_readlane_b32 s23, v70, 48
    v_readlane_b32 s24, v71, 0
    v_readlane_b32 s25, v71, 16
    v_readlane_b32 s26, v71, 32
    v_readlane_b32 s27, v71, 48
    s_nop 1
    v_mov_b32 v70, s20
    v_add_f32 v70, s21, v70
    v_add_f32 v70, s22, v70
    v_add_f32 v70, s23, v70
    v_mov_b32 v71, s24
    v_add_f32 v71, s25, v71
    v_add_f32 v71, s26, v71
    v_add_f32 v71, s27, v71
    v_pk_mul_f32 v[70:71], v[70:71], v[74:75] op_sel:[0,0] op_sel_hi:[1,0]
    v_cvt_pk_bf16_f32 v1, v68, v69
    v_lshlrev_b32 v68, 16, v1
    v_and_b32 v69, 0xffff0000, v1
    v_cvt_pk_bf16_f32 v1, v70, v71
    v_lshlrev_b32 v70, 16, v1
    v_and_b32 v71, 0xffff0000, v1
    v_add_f32 v70, 0x3727c5ac, v70
    v_add_f32 v71, 0x3727c5ac, v71
    v_cvt_pk_bf16_f32 v1, v70, v71
    v_lshlrev_b32 v70, 16, v1
    v_and_b32 v71, 0xffff0000, v1
    v_sqrt_f32 v70, v70
    v_sqrt_f32 v71, v71
    s_nop 0
    v_cvt_pk_bf16_f32 v1, v70, v71
    v_lshlrev_b32 v70, 16, v1
    v_and_b32 v71, 0xffff0000, v1
    v_rcp_f32 v74, v70
    v_rcp_f32 v75, v71
    s_nop 0
    v_pk_add_f32 v[72:73], v[2:3], v[68:69] neg_lo:[0,1] neg_hi:[0,1]
    v_cvt_pk_bf16_f32 v1, v72, v73
    v_lshlrev_b32 v72, 16, v1
    v_and_b32 v73, 0xffff0000, v1
    v_pk_mul_f32 v[76:77], v[72:73], v[74:75]
    v_pk_fma_f32 v[78:79], v[76:77], v[70:71], v[72:73] neg_lo:[1,0,0] neg_hi:[1,0,0]
    v_pk_fma_f32 v[76:77], v[78:79], v[74:75], v[76:77]
    v_cvt_pk_bf16_f32 v1, v76, v77
    v_lshlrev_b32 v2, 16, v1
    v_and_b32 v3, 0xffff0000, v1
    v_pk_add_f32 v[72:73], v[4:5], v[68:69] neg_lo:[0,1] neg_hi:[0,1]
    v_cvt_pk_bf16_f32 v1, v72, v73
    v_lshlrev_b32 v72, 16, v1
    v_and_b32 v73, 0xffff0000, v1
    v_pk_mul_f32 v[76:77], v[72:73], v[74:75]
    v_pk_fma_f32 v[78:79], v[76:77], v[70:71], v[72:73] neg_lo:[1,0,0] neg_hi:[1,0,0]
    v_pk_fma_f32 v[76:77], v[78:79], v[74:75], v[76:77]
    v_cvt_pk_bf16_f32 v1, v76, v77
    v_lshlrev_b32 v4, 16, v1
    v_and_b32 v5, 0xffff0000, v1
    v_pk_add_f32 v[72:73], v[6:7], v[68:69] neg_lo:[0,1] neg_hi:[0,1]
    v_cvt_pk_bf16_f32 v1, v72, v73
    v_lshlrev_b32 v72, 16, v1
    v_and_b32 v73, 0xffff0000, v1
    v_pk_mul_f32 v[76:77], v[72:73], v[74:75]
    v_pk_fma_f32 v[78:79], v[76:77], v[70:71], v[72:73] neg_lo:[1,0,0] neg_hi:[1,0,0]
    v_pk_fma_f32 v[76:77], v[78:79], v[74:75], v[76:77]
    v_cvt_pk_bf16_f32 v1, v76, v77
    v_lshlrev_b32 v6, 16, v1
    v_and_b32 v7, 0xffff0000, v1
    v_pk_add_f32 v[72:73], v[8:9], v[68:69] neg_lo:[0,1] neg_hi:[0,1]
    v_cvt_pk_bf16_f32 v1, v72, v73
    v_lshlrev_b32 v72, 16, v1
    v_and_b32 v73, 0xffff0000, v1
    v_pk_mul_f32 v[76:77], v[72:73], v[74:75]
    v_pk_fma_f32 v[78:79], v[76:77], v[70:71], v[72:73] neg_lo:[1,0,0] neg_hi:[1,0,0]
    v_pk_fma_f32 v[76:77], v[78:79], v[74:75], v[76:77]
    v_cvt_pk_bf16_f32 v1, v76, v77
    v_lshlrev_b32 v8, 16, v1
    v_and_b32 v9, 0xffff0000, v1
    v_pk_add_f32 v[72:73], v[10:11], v[68:69] neg_lo:[0,1] neg_hi:[0,1]
    v_cvt_pk_bf16_f32 v1, v72, v73
    v_lshlrev_b32 v72, 16, v1
    v_and_b32 v73, 0xffff0000, v1
    v_pk_mul_f32 v[76:77], v[72:73], v[74:75]
    v_pk_fma_f32 v[78:79], v[76:77], v[70:71], v[72:73] neg_lo:[1,0,0] neg_hi:[1,0,0]
    v_pk_fma_f32 v[76:77], v[78:79], v[74:75], v[76:77]
    v_cvt_pk_bf16_f32 v1, v76, v77
    v_lshlrev_b32 v10, 16, v1
    v_and_b32 v11, 0xffff0000, v1
    v_pk_add_f32 v[72:73], v[12:13], v[68:69] neg_lo:[0,1] neg_hi:[0,1]
    v_cvt_pk_bf16_f32 v1, v72, v73
    v_lshlrev_b32 v72, 16, v1
    v_and_b32 v73, 0xffff0000, v1
    v_pk_mul_f32 v[76:77], v[72:73], v[74:75]
    v_pk_fma_f32 v[78:79], v[76:77], v[70:71], v[72:73] neg_lo:[1,0,0] neg_hi:[1,0,0]
    v_pk_fma_f32 v[76:77], v[78:79], v[74:75], v[76:77]
    v_cvt_pk_bf16_f32 v1, v76, v77
    v_lshlrev_b32 v12, 16, v1
    v_and_b32 v13, 0xffff0000, v1
    v_pk_add_f32 v[72:73], v[14:15], v[68:69] neg_lo:[0,1] neg_hi:[0,1]
    v_cvt_pk_bf16_f32 v1, v72, v73
    v_lshlrev_b32 v72, 16, v1
    v_and_b32 v73, 0xffff0000, v1
    v_pk_mul_f32 v[76:77], v[72:73], v[74:75]
    v_pk_fma_f32 v[78:79], v[76:77], v[70:71], v[72:73] neg_lo:[1,0,0] neg_hi:[1,0,0]
    v_pk_fma_f32 v[76:77], v[78:79], v[74:75], v[76:77]
    v_cvt_pk_bf16_f32 v1, v76, v77
    v_lshlrev_b32 v14, 16, v1
    v_and_b32 v15, 0xffff0000, v1
    v_pk_add_f32 v[72:73], v[16:17], v[68:69] neg_lo:[0,1] neg_hi:[0,1]
    v_cvt_pk_bf16_f32 v1, v72, v73
    v_lshlrev_b32 v72, 16, v1
    v_and_b32 v73, 0xffff0000, v1
    v_pk_mul_f32 v[76:77], v[72:73], v[74:75]
    v_pk_fma_f32 v[78:79], v[76:77], v[70:71], v[72:73] neg_lo:[1,0,0] neg_hi:[1,0,0]
    v_pk_fma_f32 v[76:77], v[78:79], v[74:75], v[76:77]
    v_cvt_pk_bf16_f32 v1, v76, v77
    v_lshlrev_b32 v16, 16, v1
    v_and_b32 v17, 0xffff0000, v1
    v_pk_add_f32 v[72:73], v[18:19], v[68:69] neg_lo:[0,1] neg_hi:[0,1]
    v_cvt_pk_bf16_f32 v1, v72, v73
    v_lshlrev_b32 v72, 16, v1
    v_and_b32 v73, 0xffff0000, v1
    v_pk_mul_f32 v[76:77], v[72:73], v[74:75]
    v_pk_fma_f32 v[78:79], v[76:77], v[70:71], v[72:73] neg_lo:[1,0,0] neg_hi:[1,0,0]
    v_pk_fma_f32 v[76:77], v[78:79], v[74:75], v[76:77]
    v_cvt_pk_bf16_f32 v1, v76, v77
    v_lshlrev_b32 v18, 16, v1
    v_and_b32 v19, 0xffff0000, v1
    v_pk_add_f32 v[72:73], v[20:21], v[68:69] neg_lo:[0,1] neg_hi:[0,1]
    v_cvt_pk_bf16_f32 v1, v72, v73
    v_lshlrev_b32 v72, 16, v1
    v_and_b32 v73, 0xffff0000, v1
    v_pk_mul_f32 v[76:77], v[72:73], v[74:75]
    v_pk_fma_f32 v[78:79], v[76:77], v[70:71], v[72:73] neg_lo:[1,0,0] neg_hi:[1,0,0]
    v_pk_fma_f32 v[76:77], v[78:79], v[74:75], v[76:77]
    v_cvt_pk_bf16_f32 v1, v76, v77
    v_lshlrev_b32 v20, 16, v1
    v_and_b32 v21, 0xffff0000, v1
    v_pk_add_f32 v[68:69], v[2:3], v[12:13] neg_lo:[0,1] neg_hi:[0,1]
    v_pk_add_f32 v[2:3], v[2:3], v[12:13]
    v_pk_add_f32 v[12:13], v[6:7], v[16:17] neg_lo:[0,1] neg_hi:[0,1]
    v_pk_add_f32 v[6:7], v[6:7], v[16:17]
    v_pk_add_f32 v[16:17], v[10:11], v[20:21] neg_lo:[0,1] neg_hi:[0,1]
    v_pk_add_f32 v[10:11], v[10:11], v[20:21]
    v_pk_add_f32 v[20:21], v[14:15], v[4:5] neg_lo:[0,1] neg_hi:[0,1]
    v_pk_add_f32 v[14:15], v[14:15], v[4:5]
    v_pk_add_f32 v[4:5], v[18:19], v[8:9] neg_lo:[0,1] neg_hi:[0,1]
    v_pk_add_f32 v[18:19], v[18:19], v[8:9]
    v_pk_add_f32 v[8:9], v[6:7], v[18:19]
    v_pk_add_f32 v[70:71], v[10:11], v[14:15]
    v_pk_add_f32 v[6:7], v[6:7], v[18:19] neg_lo:[0,1] neg_hi:[0,1]
    v_pk_add_f32 v[10:11], v[10:11], v[14:15] neg_lo:[0,1] neg_hi:[0,1]
    v_pk_fma_f32 v[18:19], v[8:9], v[24:25], v[2:3] op_sel:[0,0,0] op_sel_hi:[1,0,1]
    v_pk_fma_f32 v[18:19], v[70:71], v[24:25], v[18:19] op_sel:[0,1,0] op_sel_hi:[1,1,1]
    v_pk_fma_f32 v[14:15], v[8:9], v[24:25], v[2:3] op_sel:[0,1,0] op_sel_hi:[1,1,1]
    v_pk_fma_f32 v[14:15], v[70:71], v[24:25], v[14:15] op_sel:[0,0,0] op_sel_hi:[1,0,1]
    v_pk_add_f32 v[8:9], v[8:9], v[70:71]
    v_pk_add_f32 v[2:3], v[2:3], v[8:9]
    v_pk_mul_f32 v[8:9], v[6:7], v[26:27] op_sel:[0,0] op_sel_hi:[1,0]
    v_pk_fma_f32 v[8:9], v[10:11], v[26:27], v[8:9] op_sel:[0,1,0] op_sel_hi:[1,1,1]
    v_pk_mul_f32 v[70:71], v[6:7], v[26:27] op_sel:[0,1] op_sel_hi:[1,1]
    v_pk_fma_f32 v[70:71], v[10:11], v[26:27], v[70:71] op_sel:[0,0,0] op_sel_hi:[1,0,1] neg_lo:[1,0,0] neg_hi:[1,0,0]
    v_pk_add_f32 v[6:7], v[18:19], v[8:9] op_sel:[0,1] op_sel_hi:[1,0] neg_hi:[0,1]
    v_pk_add_f32 v[18:19], v[18:19], v[8:9] op_sel:[0,1] op_sel_hi:[1,0] neg_lo:[0,1]
    v_pk_add_f32 v[10:11], v[14:15], v[70:71] op_sel:[0,1] op_sel_hi:[1,0] neg_hi:[0,1]
    v_pk_add_f32 v[14:15], v[14:15], v[70:71] op_sel:[0,1] op_sel_hi:[1,0] neg_lo:[0,1]
    v_pk_add_f32 v[8:9], v[12:13], v[4:5]
    v_pk_add_f32 v[70:71], v[16:17], v[20:21]
    v_pk_add_f32 v[12:13], v[12:13], v[4:5] neg_lo:[0,1] neg_hi:[0,1]
    v_pk_add_f32 v[16:17], v[16:17], v[20:21] neg_lo:[0,1] neg_hi:[0,1]
    v_pk_fma_f32 v[4:5], v[8:9], v[24:25], v[68:69] op_sel:[0,0,0] op_sel_hi:[1,0,1]
    v_pk_fma_f32 v[4:5], v[70:71], v[24:25], v[4:5] op_sel:[0,1,0] op_sel_hi:[1,1,1]
    v_pk_fma_f32 v[20:21], v[8:9], v[24:25], v[68:69] op_sel:[0,1,0] op_sel_hi:[1,1,1]
    v_pk_fma_f32 v[20:21], v[70:71], v[24:25], v[20:21] op_sel:[0,0,0] op_sel_hi:[1,0,1]
    v_pk_add_f32 v[8:9], v[8:9], v[70:71]
    v_pk_add_f32 v[68:69], v[68:69], v[8:9]
    v_pk_mul_f32 v[8:9], v[12:13], v[26:27] op_sel:[0,0] op_sel_hi:[1,0]
    v_pk_fma_f32 v[8:9], v[16:17], v[26:27], v[8:9] op_sel:[0,1,0] op_sel_hi:[1,1,1]
    v_pk_mul_f32 v[70:71], v[12:13], v[26:27] op_sel:[0,1] op_sel_hi:[1,1]
    v_pk_fma_f32 v[70:71], v[16:17], v[26:27], v[70:71] op_sel:[0,0,0] op_sel_hi:[1,0,1] neg_lo:[1,0,0] neg_hi:[1,0,0]
    v_pk_add_f32 v[12:13], v[4:5], v[8:9] op_sel:[0,1] op_sel_hi:[1,0] neg_hi:[0,1]
    v_pk_add_f32 v[4:5], v[4:5], v[8:9] op_sel:[0,1] op_sel_hi:[1,0] neg_lo:[0,1]
    v_pk_add_f32 v[16:17], v[20:21], v[70:71] op_sel:[0,1] op_sel_hi:[1,0] neg_hi:[0,1]
    v_pk_add_f32 v[20:21], v[20:21], v[70:71] op_sel:[0,1] op_sel_hi:[1,0] neg_lo:[0,1]
    v_pk_mul_f32 v[8:9], v[12:13], v[28:29] op_sel:[0,0] op_sel_hi:[1,0]
    v_pk_fma_f32 v[12:13], v[12:13], v[28:29], v[8:9] op_sel:[1,1,0] op_sel_hi:[0,1,1] neg_lo:[1,0,0]
    v_pk_mul_f32 v[8:9], v[10:11], v[30:31] op_sel:[0,0] op_sel_hi:[1,0]
    v_pk_fma_f32 v[10:11], v[10:11], v[30:31], v[8:9] op_sel:[1,1,0] op_sel_hi:[0,1,1] neg_lo:[1,0,0]
    v_pk_mul_f32 v[8:9], v[20:21], v[32:33] op_sel:[0,0] op_sel_hi:[1,0]
    v_pk_fma_f32 v[20:21], v[20:21], v[32:33], v[8:9] op_sel:[1,1,0] op_sel_hi:[0,1,1] neg_lo:[1,0,0]
    v_pk_mul_f32 v[8:9], v[18:19], v[34:35] op_sel:[0,0] op_sel_hi:[1,0]
    v_pk_fma_f32 v[18:19], v[18:19], v[34:35], v[8:9] op_sel:[1,1,0] op_sel_hi:[0,1,1] neg_lo:[1,0,0]
    v_pk_mul_f32 v[8:9], v[68:69], v[36:37] op_sel:[0,0] op_sel_hi:[1,0]
    v_pk_fma_f32 v[68:69], v[68:69], v[36:37], v[8:9] op_sel:[1,1,0] op_sel_hi:[0,1,1] neg_lo:[1,0,0]
    v_pk_mul_f32 v[8:9], v[6:7], v[38:39] op_sel:[0,0] op_sel_hi:[1,0]
    v_pk_fma_f32 v[6:7], v[6:7], v[38:39], v[8:9] op_sel:[1,1,0] op_sel_hi:[0,1,1] neg_lo:[1,0,0]
    v_pk_mul_f32 v[8:9], v[16:17], v[40:41] op_sel:[0,0] op_sel_hi:[1,0]
    v_pk_fma_f32 v[16:17], v[16:17], v[40:41], v[8:9] op_sel:[1,1,0] op_sel_hi:[0,1,1] neg_lo:[1,0,0]
    v_pk_mul_f32 v[8:9], v[14:15], v[42:43] op_sel:[0,0] op_sel_hi:[1,0]
    v_pk_fma_f32 v[14:15], v[14:15], v[42:43], v[8:9] op_sel:[1,1,0] op_sel_hi:[0,1,1] neg_lo:[1,0,0]
    v_pk_mul_f32 v[8:9], v[4:5], v[44:45] op_sel:[0,0] op_sel_hi:[1,0]
    v_pk_fma_f32 v[4:5], v[4:5], v[44:45], v[8:9] op_sel:[1,1,0] op_sel_hi:[0,1,1] neg_lo:[1,0,0]
    ds_write_b64 v47, v[2:3] offset:0
    ds_write_b64 v47, v[12:13] offset:576
    ds_write_b64 v47, v[10:11] offset:1152
    ds_write_b64 v47, v[20:21] offset:1728
    ds_write_b64 v47, v[18:19] offset:2304
    ds_write_b64 v47, v[68:69] offset:2880
    ds_write_b64 v47, v[6:7] offset:3456
    ds_write_b64 v47, v[16:17] offset:4032
    ds_write_b64 v47, v[14:15] offset:4608
    ds_write_b64 v47, v[4:5] offset:5184
    ds_read_b64 v[2:3], v62 offset:0
    ds_read_b64 v[12:13], v62 offset:64
    ds_read_b64 v[10:11], v62 offset:128
    ds_read_b64 v[20:21], v62 offset:192
    ds_read_b64 v[18:19], v62 offset:256
    ds_read_b64 v[68:69], v62 offset:320
    ds_read_b64 v[6:7], v62 offset:384
    ds_read_b64 v[16:17], v62 offset:448
    s_mov_b64 exec, 0xffff
    ds_read_b64 v[14:15], v62 offset:4608
    ds_read_b64 v[4:5], v62 offset:4672
    ds_read_b64 v[8:9], v62 offset:4736
    ds_read_b64 v[28:29], v62 offset:4800
    ds_read_b64 v[30:31], v62 offset:4864
    ds_read_b64 v[32:33], v62 offset:4928
    ds_read_b64 v[34:35], v62 offset:4992
    ds_read_b64 v[36:37], v62 offset:5056
    s_mov_b64 exec, -1
    s_waitcnt lgkmcnt(0)
    v_pk_add_f32 v[38:39], v[2:3], v[18:19] neg_lo:[0,1] neg_hi:[0,1]
    v_pk_add_f32 v[2:3], v[2:3], v[18:19]
    v_pk_add_f32 v[18:19], v[12:13], v[68:69] neg_lo:[0,1] neg_hi:[0,1]
    v_pk_add_f32 v[12:13], v[12:13], v[68:69]
    v_pk_add_f32 v[68:69], v[10:11], v[6:7] neg_lo:[0,1] neg_hi:[0,1]
    v_pk_add_f32 v[10:11], v[10:11], v[6:7]
    v_pk_add_f32 v[6:7], v[20:21], v[16:17] neg_lo:[0,1] neg_hi:[0,1]
    v_pk_add_f32 v[20:21], v[20:21], v[16:17]
    v_pk_add_f32 v[16:17], v[2:3], v[10:11] neg_lo:[0,1] neg_hi:[0,1]
    v_pk_add_f32 v[2:3], v[2:3], v[10:11]
    v_pk_add_f32 v[10:11], v[12:13], v[20:21] neg_lo:[0,1] neg_hi:[0,1]
    v_pk_add_f32 v[12:13], v[12:13], v[20:21]
    v_pk_add_f32 v[20:21], v[2:3], v[12:13] neg_lo:[0,1] neg_hi:[0,1]
    v_pk_add_f32 v[2:3], v[2:3], v[12:13]
    v_pk_add_f32 v[12:13], v[16:17], v[10:11] op_sel:[0,1] op_sel_hi:[1,0] neg_hi:[0,1]
    v_pk_add_f32 v[10:11], v[16:17], v[10:11] op_sel:[0,1] op_sel_hi:[1,0] neg_lo:[0,1]
    v_pk_add_f32 v[16:17], v[38:39], v[68:69] op_sel:[0,1] op_sel_hi:[1,0] neg_hi:[0,1]
    v_pk_add_f32 v[38:39], v[38:39], v[68:69] op_sel:[0,1] op_sel_hi:[1,0] neg_lo:[0,1]
    v_pk_add_f32 v[68:69], v[18:19], v[18:19] op_sel:[0,1] op_sel_hi:[1,0] neg_hi:[0,1]
    v_pk_add_f32 v[18:19], v[6:7], v[6:7] op_sel:[0,1] op_sel_hi:[1,0] neg_lo:[0,1]
    v_pk_add_f32 v[6:7], v[68:69], v[18:19] neg_lo:[0,1] neg_hi:[0,1]
    v_pk_add_f32 v[68:69], v[68:69], v[18:19]
    v_pk_fma_f32 v[18:19], v[6:7], v[22:23], v[16:17] op_sel:[0,0,0] op_sel_hi:[1,0,1]
    v_pk_fma_f32 v[16:17], v[6:7], v[22:23], v[16:17] op_sel:[0,0,0] op_sel_hi:[1,0,1] neg_lo:[1,0,0] neg_hi:[1,0,0]
    v_pk_fma_f32 v[6:7], v[68:69], v[22:23], v[38:39] op_sel:[1,0,0] op_sel_hi:[0,0,1] neg_hi:[1,0,0]
    v_pk_fma_f32 v[68:69], v[68:69], v[22:23], v[38:39] op_sel:[1,0,0] op_sel_hi:[0,0,1] neg_lo:[1,0,0]
    v_pk_mul_f32 v[38:39], v[18:19], v[48:49] op_sel:[0,0] op_sel_hi:[1,0]
    v_pk_fma_f32 v[18:19], v[18:19], v[48:49], v[38:39] op_sel:[1,1,0] op_sel_hi:[0,1,1] neg_lo:[1,0,0]
    v_pk_mul_f32 v[38:39], v[12:13], v[50:51] op_sel:[0,0] op_sel_hi:[1,0]
    v_pk_fma_f32 v[12:13], v[12:13], v[50:51], v[38:39] op_sel:[1,1,0] op_sel_hi:[0,1,1] neg_lo:[1,0,0]
    v_pk_mul_f32 v[38:39], v[6:7], v[52:53] op_sel:[0,0] op_sel_hi:[1,0]
    v_pk_fma_f32 v[6:7], v[6:7], v[52:53], v[38:39] op_sel:[1,1,0] op_sel_hi:[0,1,1] neg_lo:[1,0,0]
    v_pk_mul_f32 v[38:39], v[20:21], v[54:55] op_sel:[0,0] op_sel_hi:[1,0]
    v_pk_fma_f32 v[20:21], v[20:21], v[54:55], v[38:39] op_sel:[1,1,0] op_sel_hi:[0,1,1] neg_lo:[1,0,0]
    v_pk_mul_f32 v[38:39], v[16:17], v[56:57] op_sel:[0,0] op_sel_hi:[1,0]
    v_pk_fma_f32 v[16:17], v[16:17], v[56:57], v[38:39] op_sel:[1,1,0] op_sel_hi:[0,1,1] neg_lo:[1,0,0]
    v_pk_mul_f32 v[38:39], v[10:11], v[58:59] op_sel:[0,0] op_sel_hi:[1,0]
    v_pk_fma_f32 v[10:11], v[10:11], v[58:59], v[38:39] op_sel:[1,1,0] op_sel_hi:[0,1,1] neg_lo:[1,0,0]
    v_pk_mul_f32 v[38:39], v[68:69], v[60:61] op_sel:[0,0] op_sel_hi:[1,0]
    v_pk_fma_f32 v[68:69], v[68:69], v[60:61], v[38:39] op_sel:[1,1,0] op_sel_hi:[0,1,1] neg_lo:[1,0,0]
    v_pk_add_f32 v[38:39], v[14:15], v[30:31] neg_lo:[0,1] neg_hi:[0,1]
    v_pk_add_f32 v[14:15], v[14:15], v[30:31]
    v_pk_add_f32 v[30:31], v[4:5], v[32:33] neg_lo:[0,1] neg_hi:[0,1]
    v_pk_add_f32 v[4:5], v[4:5], v[32:33]
    v_pk_add_f32 v[32:33], v[8:9], v[34:35] neg_lo:[0,1] neg_hi:[0,1]
    v_pk_add_f32 v[8:9], v[8:9], v[34:35]
    v_pk_add_f32 v[34:35], v[28:29], v[36:37] neg_lo:[0,1] neg_hi:[0,1]
    v_pk_add_f32 v[28:29], v[28:29], v[36:37]
    v_pk_add_f32 v[36:37], v[14:15], v[8:9] neg_lo:[0,1] neg_hi:[0,1]
    v_pk_add_f32 v[14:15], v[14:15], v[8:9]
    v_pk_add_f32 v[8:9], v[4:5], v[28:29] neg_lo:[0,1] neg_hi:[0,1]
    v_pk_add_f32 v[4:5], v[4:5], v[28:29]
    v_pk_add_f32 v[28:29], v[14:15], v[4:5] neg_lo:[0,1] neg_hi:[0,1]
    v_pk_add_f32 v[14:15], v[14:15], v[4:5]
    v_pk_add_f32 v[4:5], v[36:37], v[8:9] op_sel:[0,1] op_sel_hi:[1,0] neg_hi:[0,1]
    v_pk_add_f32 v[8:9], v[36:37], v[8:9] op_sel:[0,1] op_sel_hi:[1,0] neg_lo:[0,1]
    v_pk_add_f32 v[36:37], v[38:39], v[32:33] op_sel:[0,1] op_sel_hi:[1,0] neg_hi:[0,1]
    v_pk_add_f32 v[38:39], v[38:39], v[32:33] op_sel:[0,1] op_sel_hi:[1,0] neg_lo:[0,1]
    v_pk_add_f32 v[32:33], v[30:31], v[30:31] op_sel:[0,1] op_sel_hi:[1,0] neg_hi:[0,1]
    v_pk_add_f32 v[30:31], v[34:35], v[34:35] op_sel:[0,1] op_sel_hi:[1,0] neg_lo:[0,1]
    v_pk_add_f32 v[34:35], v[32:33], v[30:31] neg_lo:[0,1] neg_hi:[0,1]
    v_pk_add_f32 v[32:33], v[32:33], v[30:31]
    v_pk_fma_f32 v[30:31], v[34:35], v[22:23], v[36:37] op_sel:[0,0,0] op_sel_hi:[1,0,1]
    v_pk_fma_f32 v[36:37], v[34:35], v[22:23], v[36:37] op_sel:[0,0,0] op_sel_hi:[1,0,1] neg_lo:[1,0,0] neg_hi:[1,0,0]
    v_pk_fma_f32 v[34:35], v[32:33], v[22:23], v[38:39] op_sel:[1,0,0] op_sel_hi:[0,0,1] neg_hi:[1,0,0]
    v_pk_fma_f32 v[32:33], v[32:33], v[22:23], v[38:39] op_sel:[1,0,0] op_sel_hi:[0,0,1] neg_lo:[1,0,0]
    v_pk_mul_f32 v[38:39], v[30:31], v[48:49] op_sel:[0,0] op_sel_hi:[1,0]
    v_pk_fma_f32 v[30:31], v[30:31], v[48:49], v[38:39] op_sel:[1,1,0] op_sel_hi:[0,1,1] neg_lo:[1,0,0]
    v_pk_mul_f32 v[38:39], v[4:5], v[50:51] op_sel:[0,0] op_sel_hi:[1,0]
    v_pk_fma_f32 v[4:5], v[4:5], v[50:51], v[38:39] op_sel:[1,1,0] op_sel_hi:[0,1,1] neg_lo:[1,0,0]
    v_pk_mul_f32 v[38:39], v[34:35], v[52:53] op_sel:[0,0] op_sel_hi:[1,0]
    v_pk_fma_f32 v[34:35], v[34:35], v[52:53], v[38:39] op_sel:[1,1,0] op_sel_hi:[0,1,1] neg_lo:[1,0,0]
    v_pk_mul_f32 v[38:39], v[28:29], v[54:55] op_sel:[0,0] op_sel_hi:[1,0]
    v_pk_fma_f32 v[28:29], v[28:29], v[54:55], v[38:39] op_sel:[1,1,0] op_sel_hi:[0,1,1] neg_lo:[1,0,0]
    v_pk_mul_f32 v[38:39], v[36:37], v[56:57] op_sel:[0,0] op_sel_hi:[1,0]
    v_pk_fma_f32 v[36:37], v[36:37], v[56:57], v[38:39] op_sel:[1,1,0] op_sel_hi:[0,1,1] neg_lo:[1,0,0]
    v_pk_mul_f32 v[38:39], v[8:9], v[58:59] op_sel:[0,0] op_sel_hi:[1,0]
    v_pk_fma_f32 v[8:9], v[8:9], v[58:59], v[38:39] op_sel:[1,1,0] op_sel_hi:[0,1,1] neg_lo:[1,0,0]
    v_pk_mul_f32 v[38:39], v[32:33], v[60:61] op_sel:[0,0] op_sel_hi:[1,0]
    v_pk_fma_f32 v[32:33], v[32:33], v[60:61], v[38:39] op_sel:[1,1,0] op_sel_hi:[0,1,1] neg_lo:[1,0,0]
    ds_write_b64 v63, v[2:3] offset:0
    ds_write_b64 v63, v[18:19] offset:8
    ds_write_b64 v63, v[12:13] offset:16
    ds_write_b64 v63, v[6:7] offset:24
    ds_write_b64 v63, v[20:21] offset:32
    ds_write_b64 v63, v[16:17] offset:40
    ds_write_b64 v63, v[10:11] offset:48
    ds_write_b64 v63, v[68:69] offset:56
    s_mov_b64 exec, 0xffff
    ds_write_b64 v63, v[14:15] offset:4608
    ds_write_b64 v63, v[30:31] offset:4616
    ds_write_b64 v63, v[4:5] offset:4624
    ds_write_b64 v63, v[34:35] offset:4632
    ds_write_b64 v63, v[28:29] offset:4640
    ds_write_b64 v63, v[36:37] offset:4648
    ds_write_b64 v63, v[8:9] offset:4656
    ds_write_b64 v63, v[32:33] offset:4664
    s_mov_b64 exec, -1
    ds_read_b64 v[2:3], v62 offset:0
    ds_read_b64 v[18:19], v62 offset:72
    ds_read_b64 v[12:13], v62 offset:144
    ds_read_b64 v[6:7], v62 offset:216
    ds_read_b64 v[20:21], v62 offset:288
    ds_read_b64 v[16:17], v62 offset:360
    ds_read_b64 v[10:11], v62 offset:432
    ds_read_b64 v[68:69], v62 offset:504
    s_mov_b64 exec, 0xffff
    ds_read_b64 v[14:15], v62 offset:4608
    ds_read_b64 v[30:31], v62 offset:4680
    ds_read_b64 v[4:5], v62 offset:4752
    ds_read_b64 v[34:35], v62 offset:4824
    ds_read_b64 v[28:29], v62 offset:4896
    ds_read_b64 v[36:37], v62 offset:4968
    ds_read_b64 v[8:9], v62 offset:5040
    ds_read_b64 v[32:33], v62 offset:5112
    s_mov_b64 exec, -1
    s_waitcnt lgkmcnt(0)
    v_pk_add_f32 v[38:39], v[2:3], v[20:21] neg_lo:[0,1] neg_hi:[0,1]
    v_pk_add_f32 v[2:3], v[2:3], v[20:21]
    v_pk_add_f32 v[20:21], v[18:19], v[16:17] neg_lo:[0,1] neg_hi:[0,1]
    v_pk_add_f32 v[18:19], v[18:19], v[16:17]
    v_pk_add_f32 v[16:17], v[12:13], v[10:11] neg_lo:[0,1] neg_hi:[0,1]
    v_pk_add_f32 v[12:13], v[12:13], v[10:11]
    v_pk_add_f32 v[10:11], v[6:7], v[68:69] neg_lo:[0,1] neg_hi:[0,1]
    v_pk_add_f32 v[6:7], v[6:7], v[68:69]
    v_pk_add_f32 v[68:69], v[2:3], v[12:13] neg_lo:[0,1] neg_hi:[0,1]
    v_pk_add_f32 v[2:3], v[2:3], v[12:13]
    v_pk_add_f32 v[12:13], v[18:19], v[6:7] neg_lo:[0,1] neg_hi:[0,1]
    v_pk_add_f32 v[18:19], v[18:19], v[6:7]
    v_pk_add_f32 v[6:7], v[2:3], v[18:19] neg_lo:[0,1] neg_hi:[0,1]
    v_pk_add_f32 v[2:3], v[2:3], v[18:19]
    v_pk_add_f32 v[18:19], v[68:69], v[12:13] op_sel:[0,1] op_sel_hi:[1,0] neg_hi:[0,1]
    v_pk_add_f32 v[12:13], v[68:69], v[12:13] op_sel:[0,1] op_sel_hi:[1,0] neg_lo:[0,1]
    v_pk_add_f32 v[68:69], v[38:39], v[16:17] op_sel:[0,1] op_sel_hi:[1,0] neg_hi:[0,1]
    v_pk_add_f32 v[38:39], v[38:39], v[16:17] op_sel:[0,1] op_sel_hi:[1,0] neg_lo:[0,1]
    v_pk_add_f32 v[16:17], v[20:21], v[20:21] op_sel:[0,1] op_sel_hi:[1,0] neg_hi:[0,1]
    v_pk_add_f32 v[20:21], v[10:11], v[10:11] op_sel:[0,1] op_sel_hi:[1,0] neg_lo:[0,1]
    v_pk_add_f32 v[10:11], v[16:17], v[20:21] neg_lo:[0,1] neg_hi:[0,1]
    v_pk_add_f32 v[16:17], v[16:17], v[20:21]
    v_pk_fma_f32 v[20:21], v[10:11], v[22:23], v[68:69] op_sel:[0,0,0] op_sel_hi:[1,0,1]
    v_pk_fma_f32 v[68:69], v[10:11], v[22:23], v[68:69] op_sel:[0,0,0] op_sel_hi:[1,0,1] neg_lo:[1,0,0] neg_hi:[1,0,0]
    v_pk_fma_f32 v[10:11], v[16:17], v[22:23], v[38:39] op_sel:[1,0,0] op_sel_hi:[0,0,1] neg_hi:[1,0,0]
    v_pk_fma_f32 v[16:17], v[16:17], v[22:23], v[38:39] op_sel:[1,0,0] op_sel_hi:[0,0,1] neg_lo:[1,0,0]
    v_pk_add_f32 v[38:39], v[14:15], v[28:29] neg_lo:[0,1] neg_hi:[0,1]
    v_pk_add_f32 v[14:15], v[14:15], v[28:29]
    v_pk_add_f32 v[28:29], v[30:31], v[36:37] neg_lo:[0,1] neg_hi:[0,1]
    v_pk_add_f32 v[30:31], v[30:31], v[36:37]
    v_pk_add_f32 v[36:37], v[4:5], v[8:9] neg_lo:[0,1] neg_hi:[0,1]
    v_pk_add_f32 v[4:5], v[4:5], v[8:9]
    v_pk_add_f32 v[8:9], v[34:35], v[32:33] neg_lo:[0,1] neg_hi:[0,1]
    v_pk_add_f32 v[34:35], v[34:35], v[32:33]
    v_pk_add_f32 v[32:33], v[14:15], v[4:5] neg_lo:[0,1] neg_hi:[0,1]
    v_pk_add_f32 v[14:15], v[14:15], v[4:5]
    v_pk_add_f32 v[4:5], v[30:31], v[34:35] neg_lo:[0,1] neg_hi:[0,1]
    v_pk_add_f32 v[30:31], v[30:31], v[34:35]
    v_pk_add_f32 v[34:35], v[14:15], v[30:31] neg_lo:[0,1] neg_hi:[0,1]
    v_pk_add_f32 v[14:15], v[14:15], v[30:31]
    v_pk_add_f32 v[30:31], v[32:33], v[4:5] op_sel:[0,1] op_sel_hi:[1,0] neg_hi:[0,1]
    v_pk_add_f32 v[4:5], v[32:33], v[4:5] op_sel:[0,1] op_sel_hi:[1,0] neg_lo:[0,1]
    v_pk_add_f32 v[32:33], v[38:39], v[36:37] op_sel:[0,1] op_sel_hi:[1,0] neg_hi:[0,1]
    v_pk_add_f32 v[38:39], v[38:39], v[36:37] op_sel:[0,1] op_sel_hi:[1,0] neg_lo:[0,1]
    v_pk_add_f32 v[36:37], v[28:29], v[28:29] op_sel:[0,1] op_sel_hi:[1,0] neg_hi:[0,1]
    v_pk_add_f32 v[28:29], v[8:9], v[8:9] op_sel:[0,1] op_sel_hi:[1,0] neg_lo:[0,1]
    v_pk_add_f32 v[8:9], v[36:37], v[28:29] neg_lo:[0,1] neg_hi:[0,1]
    v_pk_add_f32 v[36:37], v[36:37], v[28:29]
    v_pk_fma_f32 v[28:29], v[8:9], v[22:23], v[32:33] op_sel:[0,0,0] op_sel_hi:[1,0,1]
    v_pk_fma_f32 v[32:33], v[8:9], v[22:23], v[32:33] op_sel:[0,0,0] op_sel_hi:[1,0,1] neg_lo:[1,0,0] neg_hi:[1,0,0]
    v_pk_fma_f32 v[8:9], v[36:37], v[22:23], v[38:39] op_sel:[1,0,0] op_sel_hi:[0,0,1] neg_hi:[1,0,0]
    v_pk_fma_f32 v[36:37], v[36:37], v[22:23], v[38:39] op_sel:[1,0,0] op_sel_hi:[0,0,1] neg_lo:[1,0,0]
    ds_write_b64 v64, v[2:3] offset:0
    ds_write_b64 v64, v[20:21] offset:640
    ds_write_b64 v64, v[18:19] offset:1280
    ds_write_b64 v64, v[10:11] offset:1920
    ds_write_b64 v64, v[6:7] offset:2560
    ds_write_b64 v64, v[68:69] offset:3200
    ds_write_b64 v64, v[12:13] offset:3840
    ds_write_b64 v64, v[16:17] offset:4480
    s_mov_b64 exec, 0xffff
    ds_write_b64 v64, v[14:15] offset:64
    ds_write_b64 v64, v[28:29] offset:704
    ds_write_b64 v64, v[30:31] offset:1344
    ds_write_b64 v64, v[8:9] offset:1984
    ds_write_b64 v64, v[34:35] offset:2624
    ds_write_b64 v64, v[32:33] offset:3264
    ds_write_b64 v64, v[4:5] offset:3904
    ds_write_b64 v64, v[36:37] offset:4544
    s_mov_b64 exec, 1
    ds_write_b64 v64, v[2:3] offset:5120
    s_mov_b64 exec, -1
    ds_read_b64 v[2:3], v47 offset:0
    ds_read_b64 v[4:5], v65 offset:2560
    s_waitcnt lgkmcnt(0)
    v_pk_add_f32 v[8:9], v[2:3], v[4:5] neg_hi:[0,1]
    v_pk_add_f32 v[10:11], v[2:3], v[4:5] op_sel:[1,1] op_sel_hi:[0,0] neg_hi:[1,0]
    s_add_u32 s20, s19, 0
    buffer_store_dwordx4 v[8:11], v66, s[12:15], s20 offen
    ds_read_b64 v[2:3], v47 offset:512
    ds_read_b64 v[4:5], v65 offset:2048
    s_waitcnt lgkmcnt(0)
    v_pk_add_f32 v[8:9], v[2:3], v[4:5] neg_hi:[0,1]
    v_pk_add_f32 v[10:11], v[2:3], v[4:5] op_sel:[1,1] op_sel_hi:[0,0] neg_hi:[1,0]
    s_add_u32 s20, s19, 1048576
    buffer_store_dwordx4 v[8:11], v66, s[12:15], s20 offen
    ds_read_b64 v[2:3], v47 offset:1024
    ds_read_b64 v[4:5], v65 offset:1536
    s_waitcnt lgkmcnt(0)
    v_pk_add_f32 v[8:9], v[2:3], v[4:5] neg_hi:[0,1]
    v_pk_add_f32 v[10:11], v[2:3], v[4:5] op_sel:[1,1] op_sel_hi:[0,0] neg_hi:[1,0]
    s_add_u32 s20, s19, 2097152
    buffer_store_dwordx4 v[8:11], v66, s[12:15], s20 offen
    ds_read_b64 v[2:3], v47 offset:1536
    ds_read_b64 v[4:5], v65 offset:1024
    s_waitcnt lgkmcnt(0)
    v_pk_add_f32 v[8:9], v[2:3], v[4:5] neg_hi:[0,1]
    v_pk_add_f32 v[10:11], v[2:3], v[4:5] op_sel:[1,1] op_sel_hi:[0,0] neg_hi:[1,0]
    s_add_u32 s20, s19, 3145728
    buffer_store_dwordx4 v[8:11], v66, s[12:15], s20 offen
    ds_read_b64 v[2:3], v47 offset:2048
    ds_read_b64 v[4:5], v65 offset:512
    s_waitcnt lgkmcnt(0)
    v_pk_add_f32 v[8:9], v[2:3], v[4:5] neg_hi:[0,1]
    v_pk_add_f32 v[10:11], v[2:3], v[4:5] op_sel:[1,1] op_sel_hi:[0,0] neg_hi:[1,0]
    s_add_u32 s20, s19, 4194304
    buffer_store_dwordx4 v[8:11], v66, s[12:15], s20 offen
    s_mov_b64 exec, 1
    ds_read_b64 v[2:3], v47 offset:2560
    ds_read_b64 v[4:5], v65 offset:0
    s_waitcnt lgkmcnt(0)
    v_pk_add_f32 v[8:9], v[2:3], v[4:5] neg_hi:[0,1]
    v_pk_add_f32 v[10:11], v[2:3], v[4:5] op_sel:[1,1] op_sel_hi:[0,0] neg_hi:[1,0]
    s_add_u32 s20, s19, 5242880
    buffer_store_dwordx4 v[8:11], v66, s[12:15], s20 offen
    s_endpgm
k1_tr:
    s_load_dwordx2 s[8:9], s[0:1], 8
    s_load_dwordx2 s[10:11], s[0:1], 16
    s_sub_u32 s16, s2, 256
    s_lshl_b32 s16, s16, 2
    s_add_u32 s16, s16, s3
    s_and_b32 s17, s16, 127
    s_lshr_b32 s18, s16, 7
    s_waitcnt lgkmcnt(0)
    s_mov_b32 s12, s8
    s_mov_b32 s13, s9
    s_mov_b32 s14, 0x141000
    s_mov_b32 s15, 0x00020000
    s_mov_b32 s24, s10
    s_mov_b32 s25, s11
    s_mov_b32 s26, 0x141000
    s_mov_b32 s27, 0x00020000
    s_add_u32 s28, s4, 0xc00000
    s_addc_u32 s29, s5, 0
    s_mov_b32 s30, 0x282000
    s_mov_b32 s31, 0x00020000
    s_lshr_b32 s19, s17, 4
    s_bfe_u32 s20, s17, 0x30001
    s_lshl_b32 s20, s20, 3
    s_add_u32 s19, s19, s20
    s_and_b32 s20, s17, 1
    s_lshl_b32 s20, s20, 8
    s_add_u32 s19, s19, s20
    s_mul_i32 s19, s19, 642
    s_lshl_b32 s21, s17, 6
    s_lshl_b32 s18, s18, 6
    v_add_u32 v1, s18, v0
    v_cmp_gt_u32 vcc, 321, v1
    s_and_saveexec_b64 s[22:23], vcc
    s_cbranch_execz k1_end
    v_lshlrev_b32 v2, 1, v1
    v_lshlrev_b32 v3, 13, v1
    s_add_u32 s32, s19, 0
    buffer_load_ushort v4, v2, s[12:15], s32 offen
    buffer_load_ushort v28, v2, s[24:27], s32 offen
    s_add_u32 s33, s19, 328704
    buffer_load_ushort v5, v2, s[12:15], s33 offen
    buffer_load_ushort v29, v2, s[24:27], s33 offen
    s_add_u32 s34, s19, 657408
    buffer_load_ushort v6, v2, s[12:15], s34 offen
    buffer_load_ushort v30, v2, s[24:27], s34 offen
    s_add_u32 s35, s19, 986112
    buffer_load_ushort v7, v2, s[12:15], s35 offen
    buffer_load_ushort v31, v2, s[24:27], s35 offen
    s_add_u32 s36, s19, 41088
    buffer_load_ushort v8, v2, s[12:15], s36 offen
    buffer_load_ushort v32, v2, s[24:27], s36 offen
    s_add_u32 s37, s19, 369792
    buffer_load_ushort v9, v2, s[12:15], s37 offen
    buffer_load_ushort v33, v2, s[24:27], s37 offen
    s_add_u32 s38, s19, 698496
    buffer_load_ushort v10, v2, s[12:15], s38 offen
    buffer_load_ushort v34, v2, s[24:27], s38 offen
    s_add_u32 s39, s19, 1027200
    buffer_load_ushort v11, v2, s[12:15], s39 offen
    buffer_load_ushort v35, v2, s[24:27], s39 offen
    s_add_u32 s40, s19, 82176
    buffer_load_ushort v12, v2, s[12:15], s40 offen
    buffer_load_ushort v36, v2, s[24:27], s40 offen
    s_add_u32 s41, s19, 410880
    buffer_load_ushort v13, v2, s[12:15], s41 offen
    buffer_load_ushort v37, v2, s[24:27], s41 offen
    s_add_u32 s42, s19, 739584
    buffer_load_ushort v14, v2, s[12:15], s42 offen
    buffer_load_ushort v38, v2, s[24:27], s42 offen
    s_add_u32 s43, s19, 1068288
    buffer_load_ushort v15, v2, s[12:15], s43 offen
    buffer_load_ushort v39, v2, s[24:27], s43 offen
    s_add_u32 s44, s19, 123264
    buffer_load_ushort v16, v2, s[12:15], s44 offen
    buffer_load_ushort v40, v2, s[24:27], s44 offen
    s_add_u32 s45, s19, 451968
    buffer_load_ushort v17, v2, s[12:15], s45 offen
    buffer_load_ushort v41, v2, s[24:27], s45 offen
    s_add_u32 s46, s19, 780672
    buffer_load_ushort v18, v2, s[12:15], s46 offen
    buffer_load_ushort v42, v2, s[24:27], s46 offen
    s_add_u32 s47, s19, 1109376
    buffer_load_ushort v19, v2, s[12:15], s47 offen
    buffer_load_ushort v43, v2, s[24:27], s47 offen
    s_waitcnt vmcnt(0)
    v_lshl_or_b32 v4, v28, 16, v4
    v_lshl_or_b32 v5, v29, 16, v5
    v_lshl_or_b32 v6, v30, 16, v6
    v_lshl_or_b32 v7, v31, 16, v7
    v_lshl_or_b32 v8, v32, 16, v8
    v_lshl_or_b32 v9, v33, 16, v9
    v_lshl_or_b32 v10, v34, 16, v10
    v_lshl_or_b32 v11, v35, 16, v11
    v_lshl_or_b32 v12, v36, 16, v12
    v_lshl_or_b32 v13, v37, 16, v13
    v_lshl_or_b32 v14, v38, 16, v14
    v_lshl_or_b32 v15, v39, 16, v15
    v_lshl_or_b32 v16, v40, 16, v16
    v_lshl_or_b32 v17, v41, 16, v17
    v_lshl_or_b32 v18, v42, 16, v18
    v_lshl_or_b32 v19, v43, 16, v19
    buffer_store_dwordx4 v[4:7], v3, s[28:31], s21 offen offset:0
    buffer_store_dwordx4 v[8:11], v3, s[28:31], s21 offen offset:16
    buffer_store_dwordx4 v[12:15], v3, s[28:31], s21 offen offset:32
    buffer_store_dwordx4 v[16:19], v3, s[28:31], s21 offen offset:48
k1_end:
    s_endpgm
.globl k2_kernel
.p2align 8
.type k2_kernel,@function
k2_kernel:
    s_load_dwordx2 s[4:5], s[0:1], 80
    s_cmp_ge_u32 s2, 321
    s_cbranch_scc1 k2_end
    s_waitcnt lgkmcnt(0)
    s_mov_b32 s8, s4
    s_mov_b32 s9, s5
    s_mov_b32 s10, 0x504000
    s_mov_b32 s11, 0x00020000
    s_add_u32 s12, s4, 0x600000
    s_addc_u32 s13, s5, 0
    s_mov_b32 s14, 0x504000
    s_mov_b32 s15, 0x00020000
    s_add_u32 s16, s4, 0xc00000
    s_addc_u32 s17, s5, 0
    s_mov_b32 s18, 0x282000
    s_mov_b32 s19, 0x00020000
    s_lshl_b32 s20, s2, 14
    s_add_u32 s21, s20, 2048
    s_add_u32 s22, s20, 4096
    s_add_u32 s23, s20, 6144
    s_add_u32 s24, s20, 8192
    s_add_u32 s25, s20, 10240
    s_add_u32 s26, s20, 12288
    s_add_u32 s27, s20, 14336
    s_lshl_b32 s40, s2, 6
    s_add_u32 s41, s40, 657408
    s_add_u32 s42, s40, 1314816
    s_add_u32 s43, s40, 1972224
    s_add_u32 s44, s40, 2629632
    s_add_u32 s45, s40, 3287040
    s_add_u32 s46, s40, 3944448
    s_add_u32 s47, s40, 4601856
    s_lshl_b32 s28, s2, 13
    v_lshlrev_b32 v1, 3, v0
    v_lshrrev_b32 v2, 3, v0
    v_mul_u32_u24 v2, 20544, v2
    v_and_b32 v3, 7, v0
    v_lshl_add_u32 v2, v3, 3, v2
    v_lshlrev_b32 v3, 5, v0
    buffer_load_dwordx2 v[4:5], v1, s[8:11], s20 offen
    buffer_load_dwordx2 v[6:7], v1, s[8:11], s21 offen
    buffer_load_dwordx2 v[8:9], v1, s[8:11], s22 offen
    buffer_load_dwordx2 v[10:11], v1, s[8:11], s23 offen
    buffer_load_dwordx2 v[12:13], v1, s[8:11], s24 offen
    buffer_load_dwordx2 v[14:15], v1, s[8:11], s25 offen
    buffer_load_dwordx2 v[16:17], v1, s[8:11], s26 offen
    buffer_load_dwordx2 v[18:19], v1, s[8:11], s27 offen
    buffer_load_dwordx4 v[20:23], v3, s[16:19], s28 offen
    buffer_load_dwordx4 v[24:27], v3, s[16:19], s28 offen offset:16
    v_mov_b32 v28, 0x3f3504f3
    v_mov_b32 v29, 0x3f3504f3
    v_cvt_f32_u32 v31, v0
    v_mul_f32 v31, 0xba000000, v31
    v_cos_f32 v32, v31
    v_sin_f32 v33, v31
    s_nop 0
    v_pk_mul_f32 v[46:47], v[32:33], v[32:33] op_sel:[0,0] op_sel_hi:[1,0]
    v_pk_fma_f32 v[34:35], v[32:33], v[32:33], v[46:47] op_sel:[1,1,0] op_sel_hi:[0,1,1] neg_lo:[1,0,0]
    v_pk_mul_f32 v[46:47], v[34:35], v[32:33] op_sel:[0,0] op_sel_hi:[1,0]
    v_pk_fma_f32 v[36:37], v[34:35], v[32:33], v[46:47] op_sel:[1,1,0] op_sel_hi:[0,1,1] neg_lo:[1,0,0]
    v_pk_mul_f32 v[46:47], v[34:35], v[34:35] op_sel:[0,0] op_sel_hi:[1,0]
    v_pk_fma_f32 v[38:39], v[34:35], v[34:35], v[46:47] op_sel:[1,1,0] op_sel_hi:[0,1,1] neg_lo:[1,0,0]
    v_pk_mul_f32 v[46:47], v[38:39], v[32:33] op_sel:[0,0] op_sel_hi:[1,0]
    v_pk_fma_f32 v[40:41], v[38:39], v[32:33], v[46:47] op_sel:[1,1,0] op_sel_hi:[0,1,1] neg_lo:[1,0,0]
    v_pk_mul_f32 v[46:47], v[36:37], v[36:37] op_sel:[0,0] op_sel_hi:[1,0]
    v_pk_fma_f32 v[42:43], v[36:37], v[36:37], v[46:47] op_sel:[1,1,0] op_sel_hi:[0,1,1] neg_lo:[1,0,0]
    v_pk_mul_f32 v[46:47], v[38:39], v[36:37] op_sel:[0,0] op_sel_hi:[1,0]
    v_pk_fma_f32 v[44:45], v[38:39], v[36:37], v[46:47] op_sel:[1,1,0] op_sel_hi:[0,1,1] neg_lo:[1,0,0]
    v_and_b32 v30, 31, v0
    v_cvt_f32_u32 v31, v30
    v_mul_f32 v31, 0xbb800000, v31
    v_cos_f32 v46, v31
    v_sin_f32 v47, v31
    s_nop 0
    v_pk_mul_f32 v[60:61], v[46:47], v[46:47] op_sel:[0,0] op_sel_hi:[1,0]
    v_pk_fma_f32 v[48:49], v[46:47], v[46:47], v[60:61] op_sel:[1,1,0] op_sel_hi:[0,1,1] neg_lo:[1,0,0]
    v_pk_mul_f32 v[60:61], v[48:49], v[46:47] op_sel:[0,0] op_sel_hi:[1,0]
    v_pk_fma_f32 v[50:51], v[48:49], v[46:47], v[60:61] op_sel:[1,1,0] op_sel_hi:[0,1,1] neg_lo:[1,0,0]
    v_pk_mul_f32 v[60:61], v[48:49], v[48:49] op_sel:[0,0] op_sel_hi:[1,0]
    v_pk_fma_f32 v[52:53], v[48:49], v[48:49], v[60:61] op_sel:[1,1,0] op_sel_hi:[0,1,1] neg_lo:[1,0,0]
    v_pk_mul_f32 v[60:61], v[52:53], v[46:47] op_sel:[0,0] op_sel_hi:[1,0]
    v_pk_fma_f32 v[54:55], v[52:53], v[46:47], v[60:61] op_sel:[1,1,0] op_sel_hi:[0,1,1] neg_lo:[1,0,0]
    v_pk_mul_f32 v[60:61], v[50:51], v[50:51] op_sel:[0,0] op_sel_hi:[1,0]
    v_pk_fma_f32 v[56:57], v[50:51], v[50:51], v[60:61] op_sel:[1,1,0] op_sel_hi:[0,1,1] neg_lo:[1,0,0]
    v_pk_mul_f32 v[60:61], v[52:53], v[50:51] op_sel:[0,0] op_sel_hi:[1,0]
    v_pk_fma_f32 v[58:59], v[52:53], v[50:51], v[60:61] op_sel:[1,1,0] op_sel_hi:[0,1,1] neg_lo:[1,0,0]
    v_and_b32 v30, 3, v0
    v_cvt_f32_u32 v31, v30
    v_mul_f32 v31, 0xbd000000, v31
    v_cos_f32 v60, v31
    v_sin_f32 v61, v31
    s_nop 0
    v_pk_mul_f32 v[74:75], v[60:61], v[60:61] op_sel:[0,0] op_sel_hi:[1,0]
    v_pk_fma_f32 v[62:63], v[60:61], v[60:61], v[74:75] op_sel:[1,1,0] op_sel_hi:[0,1,1] neg_lo:[1,0,0]
    v_pk_mul_f32 v[74:75], v[62:63], v[60:61] op_sel:[0,0] op_sel_hi:[1,0]
    v_pk_fma_f32 v[64:65], v[62:63], v[60:61], v[74:75] op_sel:[1,1,0] op_sel_hi:[0,1,1] neg_lo:[1,0,0]
    v_pk_mul_f32 v[74:75], v[62:63], v[62:63] op_sel:[0,0] op_sel_hi:[1,0]
    v_pk_fma_f32 v[66:67], v[62:63], v[62:63], v[74:75] op_sel:[1,1,0] op_sel_hi:[0,1,1] neg_lo:[1,0,0]
    v_pk_mul_f32 v[74:75], v[66:67], v[60:61] op_sel:[0,0] op_sel_hi:[1,0]
    v_pk_fma_f32 v[68:69], v[66:67], v[60:61], v[74:75] op_sel:[1,1,0] op_sel_hi:[0,1,1] neg_lo:[1,0,0]
    v_pk_mul_f32 v[74:75], v[64:65], v[64:65] op_sel:[0,0] op_sel_hi:[1,0]
    v_pk_fma_f32 v[70:71], v[64:65], v[64:65], v[74:75] op_sel:[1,1,0] op_sel_hi:[0,1,1] neg_lo:[1,0,0]
    v_pk_mul_f32 v[74:75], v[66:67], v[64:65] op_sel:[0,0] op_sel_hi:[1,0]
    v_pk_fma_f32 v[72:73], v[66:67], v[64:65], v[74:75] op_sel:[1,1,0] op_sel_hi:[0,1,1] neg_lo:[1,0,0]
    v_lshrrev_b32 v31, 5, v0
    v_lshlrev_b32 v31, 8, v31
    v_and_b32 v30, 31, v0
    v_add_u32 v31, v31, v30
    v_lshlrev_b32 v31, 3, v31
    v_lshrrev_b32 v74, 5, v0
    v_mul_u32_u24 v74, 288, v74
    v_add_u32 v74, v74, v30
    v_lshlrev_b32 v74, 3, v74
    v_lshrrev_b32 v75, 2, v0
    v_mul_u32_u24 v75, 36, v75
    v_and_b32 v30, 3, v0
    v_add_u32 v76, v75, v30
    v_lshlrev_b32 v76, 3, v76
    v_lshlrev_b32 v30, 3, v30
    v_add_u32 v77, v75, v30
    v_lshlrev_b32 v77, 3, v77
    s_waitcnt vmcnt(2)
    v_pk_add_f32 v[78:79], v[4:5], v[12:13] neg_lo:[0,1] neg_hi:[0,1]
    v_pk_add_f32 v[4:5], v[4:5], v[12:13]
    v_pk_add_f32 v[12:13], v[6:7], v[14:15] neg_lo:[0,1] neg_hi:[0,1]
    v_pk_add_f32 v[6:7], v[6:7], v[14:15]
    v_pk_add_f32 v[14:15], v[8:9], v[16:17] neg_lo:[0,1] neg_hi:[0,1]
    v_pk_add_f32 v[8:9], v[8:9], v[16:17]
    v_pk_add_f32 v[16:17], v[10:11], v[18:19] neg_lo:[0,1] neg_hi:[0,1]
    v_pk_add_f32 v[10:11], v[10:11], v[18:19]
    v_pk_add_f32 v[18:19], v[4:5], v[8:9] neg_lo:[0,1] neg_hi:[0,1]
    v_pk_add_f32 v[4:5], v[4:5], v[8:9]
    v_pk_add_f32 v[8:9], v[6:7], v[10:11] neg_lo:[0,1] neg_hi:[0,1]
    v_pk_add_f32 v[6:7], v[6:7], v[10:11]
    v_pk_add_f32 v[10:11], v[4:5], v[6:7] neg_lo:[0,1] neg_hi:[0,1]
    v_pk_add_f32 v[4:5], v[4:5], v[6:7]
    v_pk_add_f32 v[6:7], v[18:19], v[8:9] op_sel:[0,1] op_sel_hi:[1,0] neg_hi:[0,1]
    v_pk_add_f32 v[8:9], v[18:19], v[8:9] op_sel:[0,1] op_sel_hi:[1,0] neg_lo:[0,1]
    v_pk_add_f32 v[18:19], v[78:79], v[14:15] op_sel:[0,1] op_sel_hi:[1,0] neg_hi:[0,1]
    v_pk_add_f32 v[78:79], v[78:79], v[14:15] op_sel:[0,1] op_sel_hi:[1,0] neg_lo:[0,1]
    v_pk_add_f32 v[14:15], v[12:13], v[12:13] op_sel:[0,1] op_sel_hi:[1,0] neg_hi:[0,1]
    v_pk_add_f32 v[12:13], v[16:17], v[16:17] op_sel:[0,1] op_sel_hi:[1,0] neg_lo:[0,1]
    v_pk_add_f32 v[16:17], v[14:15], v[12:13] neg_lo:[0,1] neg_hi:[0,1]
    v_pk_add_f32 v[14:15], v[14:15], v[12:13]
    v_pk_fma_f32 v[12:13], v[16:17], v[28:29], v[18:19] op_sel:[0,0,0] op_sel_hi:[1,0,1]
    v_pk_fma_f32 v[18:19], v[16:17], v[28:29], v[18:19] op_sel:[0,0,0] op_sel_hi:[1,0,1] neg_lo:[1,0,0] neg_hi:[1,0,0]
    v_pk_fma_f32 v[16:17], v[14:15], v[28:29], v[78:79] op_sel:[1,0,0] op_sel_hi:[0,0,1] neg_hi:[1,0,0]
    v_pk_fma_f32 v[14:15], v[14:15], v[28:29], v[78:79] op_sel:[1,0,0] op_sel_hi:[0,0,1] neg_lo:[1,0,0]
    v_pk_mul_f32 v[78:79], v[12:13], v[32:33] op_sel:[0,0] op_sel_hi:[1,0]
    v_pk_fma_f32 v[12:13], v[12:13], v[32:33], v[78:79] op_sel:[1,1,0] op_sel_hi:[0,1,1] neg_lo:[1,0,0]
    v_pk_mul_f32 v[78:79], v[6:7], v[34:35] op_sel:[0,0] op_sel_hi:[1,0]
    v_pk_fma_f32 v[6:7], v[6:7], v[34:35], v[78:79] op_sel:[1,1,0] op_sel_hi:[0,1,1] neg_lo:[1,0,0]
    v_pk_mul_f32 v[78:79], v[16:17], v[36:37] op_sel:[0,0] op_sel_hi:[1,0]
    v_pk_fma_f32 v[16:17], v[16:17], v[36:37], v[78:79] op_sel:[1,1,0] op_sel_hi:[0,1,1] neg_lo:[1,0,0]
    v_pk_mul_f32 v[78:79], v[10:11], v[38:39] op_sel:[0,0] op_sel_hi:[1,0]
    v_pk_fma_f32 v[10:11], v[10:11], v[38:39], v[78:79] op_sel:[1,1,0] op_sel_hi:[0,1,1] neg_lo:[1,0,0]
    v_pk_mul_f32 v[78:79], v[18:19], v[40:41] op_sel:[0,0] op_sel_hi:[1,0]
    v_pk_fma_f32 v[18:19], v[18:19], v[40:41], v[78:79] op_sel:[1,1,0] op_sel_hi:[0,1,1] neg_lo:[1,0,0]
    v_pk_mul_f32 v[78:79], v[8:9], v[42:43] op_sel:[0,0] op_sel_hi:[1,0]
    v_pk_fma_f32 v[8:9], v[8:9], v[42:43], v[78:79] op_sel:[1,1,0] op_sel_hi:[0,1,1] neg_lo:[1,0,0]
    v_pk_mul_f32 v[78:79], v[14:15], v[44:45] op_sel:[0,0] op_sel_hi:[1,0]
    v_pk_fma_f32 v[14:15], v[14:15], v[44:45], v[78:79] op_sel:[1,1,0] op_sel_hi:[0,1,1] neg_lo:[1,0,0]
    ds_write_b64 v1, v[4:5] offset:0
    ds_write_b64 v1, v[12:13] offset:2048
    ds_write_b64 v1, v[6:7] offset:4096
    ds_write_b64 v1, v[16:17] offset:6144
    ds_write_b64 v1, v[10:11] offset:8192
    ds_write_b64 v1, v[18:19] offset:10240
    ds_write_b64 v1, v[8:9] offset:12288
    ds_write_b64 v1, v[14:15] offset:14336
    s_waitcnt lgkmcnt(0)
    s_barrier
    ds_read_b64 v[4:5], v31 offset:0
    ds_read_b64 v[12:13], v31 offset:256
    ds_read_b64 v[6:7], v31 offset:512
    ds_read_b64 v[16:17], v31 offset:768
    ds_read_b64 v[10:11], v31 offset:1024
    ds_read_b64 v[18:19], v31 offset:1280
    ds_read_b64 v[8:9], v31 offset:1536
    ds_read_b64 v[14:15], v31 offset:1792
    s_waitcnt lgkmcnt(0)
    v_pk_add_f32 v[78:79], v[4:5], v[10:11] neg_lo:[0,1] neg_hi:[0,1]
    v_pk_add_f32 v[4:5], v[4:5], v[10:11]
    v_pk_add_f32 v[10:11], v[12:13], v[18:19] neg_lo:[0,1] neg_hi:[0,1]
    v_pk_add_f32 v[12:13], v[12:13], v[18:19]
    v_pk_add_f32 v[18:19], v[6:7], v[8:9] neg_lo:[0,1] neg_hi:[0,1]
    v_pk_add_f32 v[6:7], v[6:7], v[8:9]
    v_pk_add_f32 v[8:9], v[16:17], v[14:15] neg_lo:[0,1] neg_hi:[0,1]
    v_pk_add_f32 v[16:17], v[16:17], v[14:15]
    v_pk_add_f32 v[14:15], v[4:5], v[6:7] neg_lo:[0,1] neg_hi:[0,1]
    v_pk_add_f32 v[4:5], v[4:5], v[6:7]
    v_pk_add_f32 v[6:7], v[12:13], v[16:17] neg_lo:[0,1] neg_hi:[0,1]
    v_pk_add_f32 v[12:13], v[12:13], v[16:17]
    v_pk_add_f32 v[16:17], v[4:5], v[12:13] neg_lo:[0,1] neg_hi:[0,1]
    v_pk_add_f32 v[4:5], v[4:5], v[12:13]
    v_pk_add_f32 v[12:13], v[14:15], v[6:7] op_sel:[0,1] op_sel_hi:[1,0] neg_hi:[0,1]
    v_pk_add_f32 v[6:7], v[14:15], v[6:7] op_sel:[0,1] op_sel_hi:[1,0] neg_lo:[0,1]
    v_pk_add_f32 v[14:15], v[78:79], v[18:19] op_sel:[0,1] op_sel_hi:[1,0] neg_hi:[0,1]
    v_pk_add_f32 v[78:79], v[78:79], v[18:19] op_sel:[0,1] op_sel_hi:[1,0] neg_lo:[0,1]
    v_pk_add_f32 v[18:19], v[10:11], v[10:11] op_sel:[0,1] op_sel_hi:[1,0] neg_hi:[0,1]
    v_pk_add_f32 v[10:11], v[8:9], v[8:9] op_sel:[0,1] op_sel_hi:[1,0] neg_lo:[0,1]
    v_pk_add_f32 v[8:9], v[18:19], v[10:11] neg_lo:[0,1] neg_hi:[0,1]
    v_pk_add_f32 v[18:19], v[18:19], v[10:11]
    v_pk_fma_f32 v[10:11], v[8:9], v[28:29], v[14:15] op_sel:[0,0,0] op_sel_hi:[1,0,1]
    v_pk_fma_f32 v[14:15], v[8:9], v[28:29], v[14:15] op_sel:[0,0,0] op_sel_hi:[1,0,1] neg_lo:[1,0,0] neg_hi:[1,0,0]
    v_pk_fma_f32 v[8:9], v[18:19], v[28:29], v[78:79] op_sel:[1,0,0] op_sel_hi:[0,0,1] neg_hi:[1,0,0]
    v_pk_fma_f32 v[18:19], v[18:19], v[28:29], v[78:79] op_sel:[1,0,0] op_sel_hi:[0,0,1] neg_lo:[1,0,0]
    v_pk_mul_f32 v[78:79], v[10:11], v[46:47] op_sel:[0,0] op_sel_hi:[1,0]
    v_pk_fma_f32 v[10:11], v[10:11], v[46:47], v[78:79] op_sel:[1,1,0] op_sel_hi:[0,1,1] neg_lo:[1,0,0]
    v_pk_mul_f32 v[78:79], v[12:13], v[48:49] op_sel:[0,0] op_sel_hi:[1,0]
    v_pk_fma_f32 v[12:13], v[12:13], v[48:49], v[78:79] op_sel:[1,1,0] op_sel_hi:[0,1,1] neg_lo:[1,0,0]
    v_pk_mul_f32 v[78:79], v[8:9], v[50:51] op_sel:[0,0] op_sel_hi:[1,0]
    v_pk_fma_f32 v[8:9], v[8:9], v[50:51], v[78:79] op_sel:[1,1,0] op_sel_hi:[0,1,1] neg_lo:[1,0,0]
    v_pk_mul_f32 v[78:79], v[16:17], v[52:53] op_sel:[0,0] op_sel_hi:[1,0]
    v_pk_fma_f32 v[16:17], v[16:17], v[52:53], v[78:79] op_sel:[1,1,0] op_sel_hi:[0,1,1] neg_lo:[1,0,0]
    v_pk_mul_f32 v[78:79], v[14:15], v[54:55] op_sel:[0,0] op_sel_hi:[1,0]
    v_pk_fma_f32 v[14:15], v[14:15], v[54:55], v[78:79] op_sel:[1,1,0] op_sel_hi:[0,1,1] neg_lo:[1,0,0]
    v_pk_mul_f32 v[78:79], v[6:7], v[56:57] op_sel:[0,0] op_sel_hi:[1,0]
    v_pk_fma_f32 v[6:7], v[6:7], v[56:57], v[78:79] op_sel:[1,1,0] op_sel_hi:[0,1,1] neg_lo:[1,0,0]
    v_pk_mul_f32 v[78:79], v[18:19], v[58:59] op_sel:[0,0] op_sel_hi:[1,0]
    v_pk_fma_f32 v[18:19], v[18:19], v[58:59], v[78:79] op_sel:[1,1,0] op_sel_hi:[0,1,1] neg_lo:[1,0,0]
    ds_write_b64 v74, v[4:5] offset:18432
    ds_write_b64 v74, v[10:11] offset:18720
    ds_write_b64 v74, v[12:13] offset:19008
    ds_write_b64 v74, v[8:9] offset:19296
    ds_write_b64 v74, v[16:17] offset:19584
    ds_write_b64 v74, v[14:15] offset:19872
    ds_write_b64 v74, v[6:7] offset:20160
    ds_write_b64 v74, v[18:19] offset:20448
    s_waitcnt lgkmcnt(0)
    s_barrier
    ds_read_b64 v[4:5], v76 offset:18432
    ds_read_b64 v[10:11], v76 offset:18464
    ds_read_b64 v[12:13], v76 offset:18496
    ds_read_b64 v[8:9], v76 offset:18528
    ds_read_b64 v[16:17], v76 offset:18560
    ds_read_b64 v[14:15], v76 offset:18592
    ds_read_b64 v[6:7], v76 offset:18624
    ds_read_b64 v[18:19], v76 offset:18656
    s_waitcnt lgkmcnt(0)
    v_pk_add_f32 v[78:79], v[4:5], v[16:17] neg_lo:[0,1] neg_hi:[0,1]
    v_pk_add_f32 v[4:5], v[4:5], v[16:17]
    v_pk_add_f32 v[16:17], v[10:11], v[14:15] neg_lo:[0,1] neg_hi:[0,1]
    v_pk_add_f32 v[10:11], v[10:11], v[14:15]
    v_pk_add_f32 v[14:15], v[12:13], v[6:7] neg_lo:[0,1] neg_hi:[0,1]
    v_pk_add_f32 v[12:13], v[12:13], v[6:7]
    v_pk_add_f32 v[6:7], v[8:9], v[18:19] neg_lo:[0,1] neg_hi:[0,1]
    v_pk_add_f32 v[8:9], v[8:9], v[18:19]
    v_pk_add_f32 v[18:19], v[4:5], v[12:13] neg_lo:[0,1] neg_hi:[0,1]
    v_pk_add_f32 v[4:5], v[4:5], v[12:13]
    v_pk_add_f32 v[12:13], v[10:11], v[8:9] neg_lo:[0,1] neg_hi:[0,1]
    v_pk_add_f32 v[10:11], v[10:11], v[8:9]
    v_pk_add_f32 v[8:9], v[4:5], v[10:11] neg_lo:[0,1] neg_hi:[0,1]
    v_pk_add_f32 v[4:5], v[4:5], v[10:11]
    v_pk_add_f32 v[10:11], v[18:19], v[12:13] op_sel:[0,1] op_sel_hi:[1,0] neg_hi:[0,1]
    v_pk_add_f32 v[12:13], v[18:19], v[12:13] op_sel:[0,1] op_sel_hi:[1,0] neg_lo:[0,1]
    v_pk_add_f32 v[18:19], v[78:79], v[14:15] op_sel:[0,1] op_sel_hi:[1,0] neg_hi:[0,1]
    v_pk_add_f32 v[78:79], v[78:79], v[14:15] op_sel:[0,1] op_sel_hi:[1,0] neg_lo:[0,1]
    v_pk_add_f32 v[14:15], v[16:17], v[16:17] op_sel:[0,1] op_sel_hi:[1,0] neg_hi:[0,1]
    v_pk_add_f32 v[16:17], v[6:7], v[6:7] op_sel:[0,1] op_sel_hi:[1,0] neg_lo:[0,1]
    v_pk_add_f32 v[6:7], v[14:15], v[16:17] neg_lo:[0,1] neg_hi:[0,1]
    v_pk_add_f32 v[14:15], v[14:15], v[16:17]
    v_pk_fma_f32 v[16:17], v[6:7], v[28:29], v[18:19] op_sel:[0,0,0] op_sel_hi:[1,0,1]
    v_pk_fma_f32 v[18:19], v[6:7], v[28:29], v[18:19] op_sel:[0,0,0] op_sel_hi:[1,0,1] neg_lo:[1,0,0] neg_hi:[1,0,0]
    v_pk_fma_f32 v[6:7], v[14:15], v[28:29], v[78:79] op_sel:[1,0,0] op_sel_hi:[0,0,1] neg_hi:[1,0,0]
    v_pk_fma_f32 v[14:15], v[14:15], v[28:29], v[78:79] op_sel:[1,0,0] op_sel_hi:[0,0,1] neg_lo:[1,0,0]
    v_pk_mul_f32 v[78:79], v[16:17], v[60:61] op_sel:[0,0] op_sel_hi:[1,0]
    v_pk_fma_f32 v[16:17], v[16:17], v[60:61], v[78:79] op_sel:[1,1,0] op_sel_hi:[0,1,1] neg_lo:[1,0,0]
    v_pk_mul_f32 v[78:79], v[10:11], v[62:63] op_sel:[0,0] op_sel_hi:[1,0]
    v_pk_fma_f32 v[10:11], v[10:11], v[62:63], v[78:79] op_sel:[1,1,0] op_sel_hi:[0,1,1] neg_lo:[1,0,0]
    v_pk_mul_f32 v[78:79], v[6:7], v[64:65] op_sel:[0,0] op_sel_hi:[1,0]
    v_pk_fma_f32 v[6:7], v[6:7], v[64:65], v[78:79] op_sel:[1,1,0] op_sel_hi:[0,1,1] neg_lo:[1,0,0]
    v_pk_mul_f32 v[78:79], v[8:9], v[66:67] op_sel:[0,0] op_sel_hi:[1,0]
    v_pk_fma_f32 v[8:9], v[8:9], v[66:67], v[78:79] op_sel:[1,1,0] op_sel_hi:[0,1,1] neg_lo:[1,0,0]
    v_pk_mul_f32 v[78:79], v[18:19], v[68:69] op_sel:[0,0] op_sel_hi:[1,0]
    v_pk_fma_f32 v[18:19], v[18:19], v[68:69], v[78:79] op_sel:[1,1,0] op_sel_hi:[0,1,1] neg_lo:[1,0,0]
    v_pk_mul_f32 v[78:79], v[12:13], v[70:71] op_sel:[0,0] op_sel_hi:[1,0]
    v_pk_fma_f32 v[12:13], v[12:13], v[70:71], v[78:79] op_sel:[1,1,0] op_sel_hi:[0,1,1] neg_lo:[1,0,0]
    v_pk_mul_f32 v[78:79], v[14:15], v[72:73] op_sel:[0,0] op_sel_hi:[1,0]
    v_pk_fma_f32 v[14:15], v[14:15], v[72:73], v[78:79] op_sel:[1,1,0] op_sel_hi:[0,1,1] neg_lo:[1,0,0]
    ds_write_b64 v76, v[4:5] offset:0
    ds_write_b64 v76, v[16:17] offset:32
    ds_write_b64 v76, v[10:11] offset:64
    ds_write_b64 v76, v[6:7] offset:96
    ds_write_b64 v76, v[8:9] offset:128
    ds_write_b64 v76, v[18:19] offset:160
    ds_write_b64 v76, v[12:13] offset:192
    ds_write_b64 v76, v[14:15] offset:224
    s_waitcnt lgkmcnt(0)
    s_barrier
    ds_read_b64 v[4:5], v77 offset:0
    ds_read_b64 v[16:17], v77 offset:8
    ds_read_b64 v[10:11], v77 offset:16
    ds_read_b64 v[6:7], v77 offset:24
    ds_read_b64 v[8:9], v77 offset:32
    ds_read_b64 v[18:19], v77 offset:40
    ds_read_b64 v[12:13], v77 offset:48
    ds_read_b64 v[14:15], v77 offset:56
    s_waitcnt lgkmcnt(0)
    v_pk_add_f32 v[78:79], v[4:5], v[10:11] neg_lo:[0,1] neg_hi:[0,1]
    v_pk_add_f32 v[4:5], v[4:5], v[10:11]
    v_pk_add_f32 v[10:11], v[16:17], v[6:7] neg_lo:[0,1] neg_hi:[0,1]
    v_pk_add_f32 v[16:17], v[16:17], v[6:7]
    v_pk_add_f32 v[6:7], v[4:5], v[16:17] neg_lo:[0,1] neg_hi:[0,1]
    v_pk_add_f32 v[4:5], v[4:5], v[16:17]
    v_pk_add_f32 v[16:17], v[78:79], v[10:11] op_sel:[0,1] op_sel_hi:[1,0] neg_hi:[0,1]
    v_pk_add_f32 v[10:11], v[78:79], v[10:11] op_sel:[0,1] op_sel_hi:[1,0] neg_lo:[0,1]
    v_pk_add_f32 v[78:79], v[8:9], v[12:13] neg_lo:[0,1] neg_hi:[0,1]
    v_pk_add_f32 v[8:9], v[8:9], v[12:13]
    v_pk_add_f32 v[12:13], v[18:19], v[14:15] neg_lo:[0,1] neg_hi:[0,1]
    v_pk_add_f32 v[18:19], v[18:19], v[14:15]
    v_pk_add_f32 v[14:15], v[8:9], v[18:19] neg_lo:[0,1] neg_hi:[0,1]
    v_pk_add_f32 v[8:9], v[8:9], v[18:19]
    v_pk_add_f32 v[18:19], v[78:79], v[12:13] op_sel:[0,1] op_sel_hi:[1,0] neg_hi:[0,1]
    v_pk_add_f32 v[12:13], v[78:79], v[12:13] op_sel:[0,1] op_sel_hi:[1,0] neg_lo:[0,1]
    s_waitcnt vmcnt(0)
    v_lshlrev_b32 v78, 16, v20
    v_and_b32 v79, 0xffff0000, v20
    v_pk_mul_f32 v[80:81], v[4:5], v[78:79] op_sel:[0,0] op_sel_hi:[1,0]
    v_pk_fma_f32 v[4:5], v[4:5], v[78:79], v[80:81] op_sel:[1,1,0] op_sel_hi:[0,1,1] neg_lo:[1,0,0]
    v_lshlrev_b32 v78, 16, v21
    v_and_b32 v79, 0xffff0000, v21
    v_pk_mul_f32 v[80:81], v[16:17], v[78:79] op_sel:[0,0] op_sel_hi:[1,0]
    v_pk_fma_f32 v[16:17], v[16:17], v[78:79], v[80:81] op_sel:[1,1,0] op_sel_hi:[0,1,1] neg_lo:[1,0,0]
    v_lshlrev_b32 v78, 16, v22
    v_and_b32 v79, 0xffff0000, v22
    v_pk_mul_f32 v[80:81], v[6:7], v[78:79] op_sel:[0,0] op_sel_hi:[1,0]
    v_pk_fma_f32 v[6:7], v[6:7], v[78:79], v[80:81] op_sel:[1,1,0] op_sel_hi:[0,1,1] neg_lo:[1,0,0]
    v_lshlrev_b32 v78, 16, v23
    v_and_b32 v79, 0xffff0000, v23
    v_pk_mul_f32 v[80:81], v[10:11], v[78:79] op_sel:[0,0] op_sel_hi:[1,0]
    v_pk_fma_f32 v[10:11], v[10:11], v[78:79], v[80:81] op_sel:[1,1,0] op_sel_hi:[0,1,1] neg_lo:[1,0,0]
    v_lshlrev_b32 v78, 16, v24
    v_and_b32 v79, 0xffff0000, v24
    v_pk_mul_f32 v[80:81], v[8:9], v[78:79] op_sel:[0,0] op_sel_hi:[1,0]
    v_pk_fma_f32 v[8:9], v[8:9], v[78:79], v[80:81] op_sel:[1,1,0] op_sel_hi:[0,1,1] neg_lo:[1,0,0]
    v_lshlrev_b32 v78, 16, v25
    v_and_b32 v79, 0xffff0000, v25
    v_pk_mul_f32 v[80:81], v[18:19], v[78:79] op_sel:[0,0] op_sel_hi:[1,0]
    v_pk_fma_f32 v[18:19], v[18:19], v[78:79], v[80:81] op_sel:[1,1,0] op_sel_hi:[0,1,1] neg_lo:[1,0,0]
    v_lshlrev_b32 v78, 16, v26
    v_and_b32 v79, 0xffff0000, v26
    v_pk_mul_f32 v[80:81], v[14:15], v[78:79] op_sel:[0,0] op_sel_hi:[1,0]
    v_pk_fma_f32 v[14:15], v[14:15], v[78:79], v[80:81] op_sel:[1,1,0] op_sel_hi:[0,1,1] neg_lo:[1,0,0]
    v_lshlrev_b32 v78, 16, v27
    v_and_b32 v79, 0xffff0000, v27
    v_pk_mul_f32 v[80:81], v[12:13], v[78:79] op_sel:[0,0] op_sel_hi:[1,0]
    v_pk_fma_f32 v[12:13], v[12:13], v[78:79], v[80:81] op_sel:[1,1,0] op_sel_hi:[0,1,1] neg_lo:[1,0,0]
    v_pk_add_f32 v[78:79], v[4:5], v[6:7] neg_lo:[0,1] neg_hi:[0,1]
    v_pk_add_f32 v[4:5], v[4:5], v[6:7]
    v_pk_add_f32 v[6:7], v[16:17], v[10:11] neg_lo:[0,1] neg_hi:[0,1]
    v_pk_add_f32 v[16:17], v[16:17], v[10:11]
    v_pk_add_f32 v[10:11], v[4:5], v[16:17] neg_lo:[0,1] neg_hi:[0,1]
    v_pk_add_f32 v[4:5], v[4:5], v[16:17]
    v_pk_add_f32 v[16:17], v[78:79], v[6:7] op_sel:[0,1] op_sel_hi:[1,0] neg_lo:[0,1]
    v_pk_add_f32 v[6:7], v[78:79], v[6:7] op_sel:[0,1] op_sel_hi:[1,0] neg_hi:[0,1]
    v_pk_add_f32 v[78:79], v[8:9], v[14:15] neg_lo:[0,1] neg_hi:[0,1]
    v_pk_add_f32 v[8:9], v[8:9], v[14:15]
    v_pk_add_f32 v[14:15], v[18:19], v[12:13] neg_lo:[0,1] neg_hi:[0,1]
    v_pk_add_f32 v[18:19], v[18:19], v[12:13]
    v_pk_add_f32 v[12:13], v[8:9], v[18:19] neg_lo:[0,1] neg_hi:[0,1]
    v_pk_add_f32 v[8:9], v[8:9], v[18:19]
    v_pk_add_f32 v[18:19], v[78:79], v[14:15] op_sel:[0,1] op_sel_hi:[1,0] neg_lo:[0,1]
    v_pk_add_f32 v[14:15], v[78:79], v[14:15] op_sel:[0,1] op_sel_hi:[1,0] neg_hi:[0,1]
    ds_write_b64 v77, v[4:5] offset:18432
    ds_write_b64 v77, v[16:17] offset:18440
    ds_write_b64 v77, v[10:11] offset:18448
    ds_write_b64 v77, v[6:7] offset:18456
    ds_write_b64 v77, v[8:9] offset:18464
    ds_write_b64 v77, v[18:19] offset:18472
    ds_write_b64 v77, v[12:13] offset:18480
    ds_write_b64 v77, v[14:15] offset:18488
    s_waitcnt lgkmcnt(0)
    s_barrier
    ds_read_b64 v[4:5], v76 offset:18432
    ds_read_b64 v[16:17], v76 offset:18464
    ds_read_b64 v[10:11], v76 offset:18496
    ds_read_b64 v[6:7], v76 offset:18528
    ds_read_b64 v[8:9], v76 offset:18560
    ds_read_b64 v[18:19], v76 offset:18592
    ds_read_b64 v[12:13], v76 offset:18624
    ds_read_b64 v[14:15], v76 offset:18656
    s_waitcnt lgkmcnt(0)
    v_pk_mul_f32 v[78:79], v[16:17], v[60:61] op_sel:[0,0] op_sel_hi:[1,0]
    v_pk_fma_f32 v[16:17], v[16:17], v[60:61], v[78:79] op_sel:[1,1,0] op_sel_hi:[0,1,1] neg_hi:[1,0,0]
    v_pk_mul_f32 v[78:79], v[10:11], v[62:63] op_sel:[0,0] op_sel_hi:[1,0]
    v_pk_fma_f32 v[10:11], v[10:11], v[62:63], v[78:79] op_sel:[1,1,0] op_sel_hi:[0,1,1] neg_hi:[1,0,0]
    v_pk_mul_f32 v[78:79], v[6:7], v[64:65] op_sel:[0,0] op_sel_hi:[1,0]
    v_pk_fma_f32 v[6:7], v[6:7], v[64:65], v[78:79] op_sel:[1,1,0] op_sel_hi:[0,1,1] neg_hi:[1,0,0]
    v_pk_mul_f32 v[78:79], v[8:9], v[66:67] op_sel:[0,0] op_sel_hi:[1,0]
    v_pk_fma_f32 v[8:9], v[8:9], v[66:67], v[78:79] op_sel:[1,1,0] op_sel_hi:[0,1,1] neg_hi:[1,0,0]
    v_pk_mul_f32 v[78:79], v[18:19], v[68:69] op_sel:[0,0] op_sel_hi:[1,0]
    v_pk_fma_f32 v[18:19], v[18:19], v[68:69], v[78:79] op_sel:[1,1,0] op_sel_hi:[0,1,1] neg_hi:[1,0,0]
    v_pk_mul_f32 v[78:79], v[12:13], v[70:71] op_sel:[0,0] op_sel_hi:[1,0]
    v_pk_fma_f32 v[12:13], v[12:13], v[70:71], v[78:79] op_sel:[1,1,0] op_sel_hi:[0,1,1] neg_hi:[1,0,0]
    v_pk_mul_f32 v[78:79], v[14:15], v[72:73] op_sel:[0,0] op_sel_hi:[1,0]
    v_pk_fma_f32 v[14:15], v[14:15], v[72:73], v[78:79] op_sel:[1,1,0] op_sel_hi:[0,1,1] neg_hi:[1,0,0]
    v_pk_add_f32 v[78:79], v[4:5], v[8:9] neg_lo:[0,1] neg_hi:[0,1]
    v_pk_add_f32 v[4:5], v[4:5], v[8:9]
    v_pk_add_f32 v[8:9], v[16:17], v[18:19] neg_lo:[0,1] neg_hi:[0,1]
    v_pk_add_f32 v[16:17], v[16:17], v[18:19]
    v_pk_add_f32 v[18:19], v[10:11], v[12:13] neg_lo:[0,1] neg_hi:[0,1]
    v_pk_add_f32 v[10:11], v[10:11], v[12:13]
    v_pk_add_f32 v[12:13], v[6:7], v[14:15] neg_lo:[0,1] neg_hi:[0,1]
    v_pk_add_f32 v[6:7], v[6:7], v[14:15]
    v_pk_add_f32 v[14:15], v[4:5], v[10:11] neg_lo:[0,1] neg_hi:[0,1]
    v_pk_add_f32 v[4:5], v[4:5], v[10:11]
    v_pk_add_f32 v[10:11], v[16:17], v[6:7] neg_lo:[0,1] neg_hi:[0,1]
    v_pk_add_f32 v[16:17], v[16:17], v[6:7]
    v_pk_add_f32 v[6:7], v[4:5], v[16:17] neg_lo:[0,1] neg_hi:[0,1]
    v_pk_add_f32 v[4:5], v[4:5], v[16:17]
    v_pk_add_f32 v[16:17], v[14:15], v[10:11] op_sel:[0,1] op_sel_hi:[1,0] neg_lo:[0,1]
    v_pk_add_f32 v[10:11], v[14:15], v[10:11] op_sel:[0,1] op_sel_hi:[1,0] neg_hi:[0,1]
    v_pk_add_f32 v[14:15], v[78:79], v[18:19] op_sel:[0,1] op_sel_hi:[1,0] neg_lo:[0,1]
    v_pk_add_f32 v[78:79], v[78:79], v[18:19] op_sel:[0,1] op_sel_hi:[1,0] neg_hi:[0,1]
    v_pk_add_f32 v[18:19], v[8:9], v[8:9] op_sel:[0,1] op_sel_hi:[1,0] neg_lo:[0,1]
    v_pk_add_f32 v[8:9], v[12:13], v[12:13] op_sel:[0,1] op_sel_hi:[1,0] neg_hi:[0,1]
    v_pk_add_f32 v[12:13], v[18:19], v[8:9] neg_lo:[0,1] neg_hi:[0,1]
    v_pk_add_f32 v[18:19], v[18:19], v[8:9]
    v_pk_fma_f32 v[8:9], v[12:13], v[28:29], v[14:15] op_sel:[0,0,0] op_sel_hi:[1,0,1]
    v_pk_fma_f32 v[14:15], v[12:13], v[28:29], v[14:15] op_sel:[0,0,0] op_sel_hi:[1,0,1] neg_lo:[1,0,0] neg_hi:[1,0,0]
    v_pk_fma_f32 v[12:13], v[18:19], v[28:29], v[78:79] op_sel:[1,0,0] op_sel_hi:[0,0,1] neg_lo:[1,0,0]
    v_pk_fma_f32 v[18:19], v[18:19], v[28:29], v[78:79] op_sel:[1,0,0] op_sel_hi:[0,0,1] neg_hi:[1,0,0]
    ds_write_b64 v76, v[4:5] offset:0
    ds_write_b64 v76, v[8:9] offset:32
    ds_write_b64 v76, v[16:17] offset:64
    ds_write_b64 v76, v[12:13] offset:96
    ds_write_b64 v76, v[6:7] offset:128
    ds_write_b64 v76, v[14:15] offset:160
    ds_write_b64 v76, v[10:11] offset:192
    ds_write_b64 v76, v[18:19] offset:224
    s_waitcnt lgkmcnt(0)
    s_barrier
    ds_read_b64 v[4:5], v74 offset:0
    ds_read_b64 v[8:9], v74 offset:288
    ds_read_b64 v[16:17], v74 offset:576
    ds_read_b64 v[12:13], v74 offset:864
    ds_read_b64 v[6:7], v74 offset:1152
    ds_read_b64 v[14:15], v74 offset:1440
    ds_read_b64 v[10:11], v74 offset:1728
    ds_read_b64 v[18:19], v74 offset:2016
    s_waitcnt lgkmcnt(0)
    v_pk_mul_f32 v[78:79], v[8:9], v[46:47] op_sel:[0,0] op_sel_hi:[1,0]
    v_pk_fma_f32 v[8:9], v[8:9], v[46:47], v[78:79] op_sel:[1,1,0] op_sel_hi:[0,1,1] neg_hi:[1,0,0]
    v_pk_mul_f32 v[78:79], v[16:17], v[48:49] op_sel:[0,0] op_sel_hi:[1,0]
    v_pk_fma_f32 v[16:17], v[16:17], v[48:49], v[78:79] op_sel:[1,1,0] op_sel_hi:[0,1,1] neg_hi:[1,0,0]
    v_pk_mul_f32 v[78:79], v[12:13], v[50:51] op_sel:[0,0] op_sel_hi:[1,0]
    v_pk_fma_f32 v[12:13], v[12:13], v[50:51], v[78:79] op_sel:[1,1,0] op_sel_hi:[0,1,1] neg_hi:[1,0,0]
    v_pk_mul_f32 v[78:79], v[6:7], v[52:53] op_sel:[0,0] op_sel_hi:[1,0]
    v_pk_fma_f32 v[6:7], v[6:7], v[52:53], v[78:79] op_sel:[1,1,0] op_sel_hi:[0,1,1] neg_hi:[1,0,0]
    v_pk_mul_f32 v[78:79], v[14:15], v[54:55] op_sel:[0,0] op_sel_hi:[1,0]
    v_pk_fma_f32 v[14:15], v[14:15], v[54:55], v[78:79] op_sel:[1,1,0] op_sel_hi:[0,1,1] neg_hi:[1,0,0]
    v_pk_mul_f32 v[78:79], v[10:11], v[56:57] op_sel:[0,0] op_sel_hi:[1,0]
    v_pk_fma_f32 v[10:11], v[10:11], v[56:57], v[78:79] op_sel:[1,1,0] op_sel_hi:[0,1,1] neg_hi:[1,0,0]
    v_pk_mul_f32 v[78:79], v[18:19], v[58:59] op_sel:[0,0] op_sel_hi:[1,0]
    v_pk_fma_f32 v[18:19], v[18:19], v[58:59], v[78:79] op_sel:[1,1,0] op_sel_hi:[0,1,1] neg_hi:[1,0,0]
    v_pk_add_f32 v[78:79], v[4:5], v[6:7] neg_lo:[0,1] neg_hi:[0,1]
    v_pk_add_f32 v[4:5], v[4:5], v[6:7]
    v_pk_add_f32 v[6:7], v[8:9], v[14:15] neg_lo:[0,1] neg_hi:[0,1]
    v_pk_add_f32 v[8:9], v[8:9], v[14:15]
    v_pk_add_f32 v[14:15], v[16:17], v[10:11] neg_lo:[0,1] neg_hi:[0,1]
    v_pk_add_f32 v[16:17], v[16:17], v[10:11]
    v_pk_add_f32 v[10:11], v[12:13], v[18:19] neg_lo:[0,1] neg_hi:[0,1]
    v_pk_add_f32 v[12:13], v[12:13], v[18:19]
    v_pk_add_f32 v[18:19], v[4:5], v[16:17] neg_lo:[0,1] neg_hi:[0,1]
    v_pk_add_f32 v[4:5], v[4:5], v[16:17]
    v_pk_add_f32 v[16:17], v[8:9], v[12:13] neg_lo:[0,1] neg_hi:[0,1]
    v_pk_add_f32 v[8:9], v[8:9], v[12:13]
    v_pk_add_f32 v[12:13], v[4:5], v[8:9] neg_lo:[0,1] neg_hi:[0,1]
    v_pk_add_f32 v[4:5], v[4:5], v[8:9]
    v_pk_add_f32 v[8:9], v[18:19], v[16:17] op_sel:[0,1] op_sel_hi:[1,0] neg_lo:[0,1]
    v_pk_add_f32 v[16:17], v[18:19], v[16:17] op_sel:[0,1] op_sel_hi:[1,0] neg_hi:[0,1]
    v_pk_add_f32 v[18:19], v[78:79], v[14:15] op_sel:[0,1] op_sel_hi:[1,0] neg_lo:[0,1]
    v_pk_add_f32 v[78:79], v[78:79], v[14:15] op_sel:[0,1] op_sel_hi:[1,0] neg_hi:[0,1]
    v_pk_add_f32 v[14:15], v[6:7], v[6:7] op_sel:[0,1] op_sel_hi:[1,0] neg_lo:[0,1]
    v_pk_add_f32 v[6:7], v[10:11], v[10:11] op_sel:[0,1] op_sel_hi:[1,0] neg_hi:[0,1]
    v_pk_add_f32 v[10:11], v[14:15], v[6:7] neg_lo:[0,1] neg_hi:[0,1]
    v_pk_add_f32 v[14:15], v[14:15], v[6:7]
    v_pk_fma_f32 v[6:7], v[10:11], v[28:29], v[18:19] op_sel:[0,0,0] op_sel_hi:[1,0,1]
    v_pk_fma_f32 v[18:19], v[10:11], v[28:29], v[18:19] op_sel:[0,0,0] op_sel_hi:[1,0,1] neg_lo:[1,0,0] neg_hi:[1,0,0]
    v_pk_fma_f32 v[10:11], v[14:15], v[28:29], v[78:79] op_sel:[1,0,0] op_sel_hi:[0,0,1] neg_lo:[1,0,0]
    v_pk_fma_f32 v[14:15], v[14:15], v[28:29], v[78:79] op_sel:[1,0,0] op_sel_hi:[0,0,1] neg_hi:[1,0,0]
    ds_write_b64 v31, v[4:5] offset:18432
    ds_write_b64 v31, v[6:7] offset:18688
    ds_write_b64 v31, v[8:9] offset:18944
    ds_write_b64 v31, v[10:11] offset:19200
    ds_write_b64 v31, v[12:13] offset:19456
    ds_write_b64 v31, v[18:19] offset:19712
    ds_write_b64 v31, v[16:17] offset:19968
    ds_write_b64 v31, v[14:15] offset:20224
    s_waitcnt lgkmcnt(0)
    s_barrier
    ds_read_b64 v[4:5], v1 offset:18432
    ds_read_b64 v[6:7], v1 offset:20480
    ds_read_b64 v[8:9], v1 offset:22528
    ds_read_b64 v[10:11], v1 offset:24576
    ds_read_b64 v[12:13], v1 offset:26624
    ds_read_b64 v[18:19], v1 offset:28672
    ds_read_b64 v[16:17], v1 offset:30720
    ds_read_b64 v[14:15], v1 offset:32768
    s_waitcnt lgkmcnt(0)
    v_pk_mul_f32 v[78:79], v[6:7], v[32:33] op_sel:[0,0] op_sel_hi:[1,0]
    v_pk_fma_f32 v[6:7], v[6:7], v[32:33], v[78:79] op_sel:[1,1,0] op_sel_hi:[0,1,1] neg_hi:[1,0,0]
    v_pk_mul_f32 v[78:79], v[8:9], v[34:35] op_sel:[0,0] op_sel_hi:[1,0]
    v_pk_fma_f32 v[8:9], v[8:9], v[34:35], v[78:79] op_sel:[1,1,0] op_sel_hi:[0,1,1] neg_hi:[1,0,0]
    v_pk_mul_f32 v[78:79], v[10:11], v[36:37] op_sel:[0,0] op_sel_hi:[1,0]
    v_pk_fma_f32 v[10:11], v[10:11], v[36:37], v[78:79] op_sel:[1,1,0] op_sel_hi:[0,1,1] neg_hi:[1,0,0]
    v_pk_mul_f32 v[78:79], v[12:13], v[38:39] op_sel:[0,0] op_sel_hi:[1,0]
    v_pk_fma_f32 v[12:13], v[12:13], v[38:39], v[78:79] op_sel:[1,1,0] op_sel_hi:[0,1,1] neg_hi:[1,0,0]
    v_pk_mul_f32 v[78:79], v[18:19], v[40:41] op_sel:[0,0] op_sel_hi:[1,0]
    v_pk_fma_f32 v[18:19], v[18:19], v[40:41], v[78:79] op_sel:[1,1,0] op_sel_hi:[0,1,1] neg_hi:[1,0,0]
    v_pk_mul_f32 v[78:79], v[16:17], v[42:43] op_sel:[0,0] op_sel_hi:[1,0]
    v_pk_fma_f32 v[16:17], v[16:17], v[42:43], v[78:79] op_sel:[1,1,0] op_sel_hi:[0,1,1] neg_hi:[1,0,0]
    v_pk_mul_f32 v[78:79], v[14:15], v[44:45] op_sel:[0,0] op_sel_hi:[1,0]
    v_pk_fma_f32 v[14:15], v[14:15], v[44:45], v[78:79] op_sel:[1,1,0] op_sel_hi:[0,1,1] neg_hi:[1,0,0]
    v_pk_add_f32 v[78:79], v[4:5], v[12:13] neg_lo:[0,1] neg_hi:[0,1]
    v_pk_add_f32 v[4:5], v[4:5], v[12:13]
    v_pk_add_f32 v[12:13], v[6:7], v[18:19] neg_lo:[0,1] neg_hi:[0,1]
    v_pk_add_f32 v[6:7], v[6:7], v[18:19]
    v_pk_add_f32 v[18:19], v[8:9], v[16:17] neg_lo:[0,1] neg_hi:[0,1]
    v_pk_add_f32 v[8:9], v[8:9], v[16:17]
    v_pk_add_f32 v[16:17], v[10:11], v[14:15] neg_lo:[0,1] neg_hi:[0,1]
    v_pk_add_f32 v[10:11], v[10:11], v[14:15]
    v_pk_add_f32 v[14:15], v[4:5], v[8:9] neg_lo:[0,1] neg_hi:[0,1]
    v_pk_add_f32 v[4:5], v[4:5], v[8:9]
    v_pk_add_f32 v[8:9], v[6:7], v[10:11] neg_lo:[0,1] neg_hi:[0,1]
    v_pk_add_f32 v[6:7], v[6:7], v[10:11]
    v_pk_add_f32 v[10:11], v[4:5], v[6:7] neg_lo:[0,1] neg_hi:[0,1]
    v_pk_add_f32 v[4:5], v[4:5], v[6:7]
    v_pk_add_f32 v[6:7], v[14:15], v[8:9] op_sel:[0,1] op_sel_hi:[1,0] neg_lo:[0,1]
    v_pk_add_f32 v[8:9], v[14:15], v[8:9] op_sel:[0,1] op_sel_hi:[1,0] neg_hi:[0,1]
    v_pk_add_f32 v[14:15], v[78:79], v[18:19] op_sel:[0,1] op_sel_hi:[1,0] neg_lo:[0,1]
    v_pk_add_f32 v[78:79], v[78:79], v[18:19] op_sel:[0,1] op_sel_hi:[1,0] neg_hi:[0,1]
    v_pk_add_f32 v[18:19], v[12:13], v[12:13] op_sel:[0,1] op_sel_hi:[1,0] neg_lo:[0,1]
    v_pk_add_f32 v[12:13], v[16:17], v[16:17] op_sel:[0,1] op_sel_hi:[1,0] neg_hi:[0,1]
    v_pk_add_f32 v[16:17], v[18:19], v[12:13] neg_lo:[0,1] neg_hi:[0,1]
    v_pk_add_f32 v[18:19], v[18:19], v[12:13]
    v_pk_fma_f32 v[12:13], v[16:17], v[28:29], v[14:15] op_sel:[0,0,0] op_sel_hi:[1,0,1]
    v_pk_fma_f32 v[14:15], v[16:17], v[28:29], v[14:15] op_sel:[0,0,0] op_sel_hi:[1,0,1] neg_lo:[1,0,0] neg_hi:[1,0,0]
    v_pk_fma_f32 v[16:17], v[18:19], v[28:29], v[78:79] op_sel:[1,0,0] op_sel_hi:[0,0,1] neg_lo:[1,0,0]
    v_pk_fma_f32 v[18:19], v[18:19], v[28:29], v[78:79] op_sel:[1,0,0] op_sel_hi:[0,0,1] neg_hi:[1,0,0]
    buffer_store_dwordx2 v[4:5], v2, s[12:15], s40 offen
    buffer_store_dwordx2 v[12:13], v2, s[12:15], s41 offen
    buffer_store_dwordx2 v[6:7], v2, s[12:15], s42 offen
    buffer_store_dwordx2 v[16:17], v2, s[12:15], s43 offen
    buffer_store_dwordx2 v[10:11], v2, s[12:15], s44 offen
    buffer_store_dwordx2 v[14:15], v2, s[12:15], s45 offen
    buffer_store_dwordx2 v[8:9], v2, s[12:15], s46 offen
    buffer_store_dwordx2 v[18:19], v2, s[12:15], s47 offen
    s_waitcnt vmcnt(0)
k2_end:
    s_endpgm
.globl k3_kernel
.p2align 8
.type k3_kernel,@function
k3_kernel:
    s_load_dwordx2 s[4:5], s[0:1], 80
    s_load_dwordx2 s[6:7], s[0:1], 0
    s_cmp_ge_u32 s2, 531
    s_cbranch_scc1 k3_end
    v_lshrrev_b32 v1, 6, v0
    v_and_b32 v0, 63, v0
    s_nop 0
    v_readfirstlane_b32 s3, v1
    s_cmp_ge_u32 s2, 256
    s_cbranch_scc1 k3_tr
    s_waitcnt lgkmcnt(0)
    s_mov_b32 s8, s6
    s_mov_b32 s9, s7
    s_mov_b32 s10, 0x280000
    s_mov_b32 s11, 0x00020000
    s_add_u32 s12, s4, 0x600000
    s_addc_u32 s13, s5, 0
    s_mov_b32 s14, 0x504000
    s_mov_b32 s15, 0x00020000
    s_add_u32 s28, s4, 0x1000000
    s_addc_u32 s29, s5, 0
    s_mov_b32 s30, 0x280000
    s_mov_b32 s31, 0x00020000
    s_add_u32 s32, s4, 0x1400000
    s_addc_u32 s33, s5, 0
    s_mov_b32 s34, 0x280000
    s_mov_b32 s35, 0x00020000
    s_lshl_b32 s16, s2, 2
    s_add_u32 s16, s16, s3
    s_mul_i32 s17, s16, 2560
    s_mul_i32 s18, s3, 5760
    s_mul_i32 s19, s2, 20544
    s_lshl_b32 s20, s3, 4
    s_add_u32 s19, s19, s20
    v_lshlrev_b32 v1, 6, v0
    s_add_u32 s36, s19, 0
    buffer_load_dwordx4 v[4:7], v1, s[12:15], s36 offen
    s_add_u32 s37, s19, 4096
    buffer_load_dwordx4 v[8:11], v1, s[12:15], s37 offen
    s_add_u32 s38, s19, 8192
    buffer_load_dwordx4 v[12:15], v1, s[12:15], s38 offen
    s_add_u32 s39, s19, 12288
    buffer_load_dwordx4 v[16:19], v1, s[12:15], s39 offen
    s_add_u32 s40, s19, 16384
    buffer_load_dwordx4 v[20:23], v1, s[12:15], s40 offen
    s_mov_b64 exec, 1
    s_add_u32 s41, s19, 20480
    buffer_load_dwordx4 v[24:27], v1, s[12:15], s41 offen
    s_mov_b64 exec, -1
    v_lshlrev_b32 v1, 1, v0
    v_mov_b32 v2, 0
    v_mov_b32 v3, 0
    v_mov_b32 v28, 0
    v_mov_b32 v29, 0
    v_mov_b32 v30, 0
    v_mov_b32 v31, 0
    v_mov_b32 v32, 0
    v_mov_b32 v33, 0
    v_mov_b32 v34, 0
    v_mov_b32 v35, 0
    v_mov_b32 v36, 0
    v_mov_b32 v37, 0
    v_mov_b32 v38, 0
    v_mov_b32 v39, 0
    v_mov_b32 v40, 0
    v_mov_b32 v41, 0
    v_mov_b32 v42, 0
    v_mov_b32 v43, 0
    v_mov_b32 v44, 0
    v_mov_b32 v45, 0
    buffer_load_short_d16_hi v2, v1, s[8:11], s17 offen offset:0
    buffer_load_short_d16_hi v3, v1, s[8:11], s17 offen offset:1280
    buffer_load_short_d16_hi v28, v1, s[8:11], s17 offen offset:128
    buffer_load_short_d16_hi v29, v1, s[8:11], s17 offen offset:1408
    buffer_load_short_d16_hi v30, v1, s[8:11], s17 offen offset:256
    buffer_load_short_d16_hi v31, v1, s[8:11], s17 offen offset:1536
    buffer_load_short_d16_hi v32, v1, s[8:11], s17 offen offset:384
    buffer_load_short_d16_hi v33, v1, s[8:11], s17 offen offset:1664
    buffer_load_short_d16_hi v34, v1, s[8:11], s17 offen offset:512
    buffer_load_short_d16_hi v35, v1, s[8:11], s17 offen offset:1792
    buffer_load_short_d16_hi v36, v1, s[8:11], s17 offen offset:640
    buffer_load_short_d16_hi v37, v1, s[8:11], s17 offen offset:1920
    buffer_load_short_d16_hi v38, v1, s[8:11], s17 offen offset:768
    buffer_load_short_d16_hi v39, v1, s[8:11], s17 offen offset:2048
    buffer_load_short_d16_hi v40, v1, s[8:11], s17 offen offset:896
    buffer_load_short_d16_hi v41, v1, s[8:11], s17 offen offset:2176
    buffer_load_short_d16_hi v42, v1, s[8:11], s17 offen offset:1024
    buffer_load_short_d16_hi v43, v1, s[8:11], s17 offen offset:2304
    buffer_load_short_d16_hi v44, v1, s[8:11], s17 offen offset:1152
    buffer_load_short_d16_hi v45, v1, s[8:11], s17 offen offset:2432
    v_mov_b32 v46, 0x3f3504f3
    v_mov_b32 v47, 0x3f3504f3
    v_mov_b32 v48, 0x3e9e377a
    v_mov_b32 v49, 0xbf4f1bbd
    v_mov_b32 v50, 0x3f737871
    v_mov_b32 v51, 0x3f167918
    v_cvt_f32_u32 v52, v0
    v_mul_f32 v52, 0xbacccccd, v52
    v_cos_f32 v54, v52
    v_sin_f32 v55, v52
    s_nop 0
    v_pk_mul_f32 v[52:53], v[54:55], v[54:55] op_sel:[0,0] op_sel_hi:[1,0]
    v_pk_fma_f32 v[56:57], v[54:55], v[54:55], v[52:53] op_sel:[1,1,0] op_sel_hi:[0,1,1] neg_lo:[1,0,0]
    v_pk_mul_f32 v[52:53], v[56:57], v[54:55] op_sel:[0,0] op_sel_hi:[1,0]
    v_pk_fma_f32 v[58:59], v[56:57], v[54:55], v[52:53] op_sel:[1,1,0] op_sel_hi:[0,1,1] neg_lo:[1,0,0]
    v_pk_mul_f32 v[52:53], v[56:57], v[56:57] op_sel:[0,0] op_sel_hi:[1,0]
    v_pk_fma_f32 v[60:61], v[56:57], v[56:57], v[52:53] op_sel:[1,1,0] op_sel_hi:[0,1,1] neg_lo:[1,0,0]
    v_pk_mul_f32 v[52:53], v[60:61], v[54:55] op_sel:[0,0] op_sel_hi:[1,0]
    v_pk_fma_f32 v[62:63], v[60:61], v[54:55], v[52:53] op_sel:[1,1,0] op_sel_hi:[0,1,1] neg_lo:[1,0,0]
    v_pk_mul_f32 v[52:53], v[58:59], v[58:59] op_sel:[0,0] op_sel_hi:[1,0]
    v_pk_fma_f32 v[64:65], v[58:59], v[58:59], v[52:53] op_sel:[1,1,0] op_sel_hi:[0,1,1] neg_lo:[1,0,0]
    v_pk_mul_f32 v[52:53], v[60:61], v[58:59] op_sel:[0,0] op_sel_hi:[1,0]
    v_pk_fma_f32 v[66:67], v[60:61], v[58:59], v[52:53] op_sel:[1,1,0] op_sel_hi:[0,1,1] neg_lo:[1,0,0]
    v_pk_mul_f32 v[52:53], v[60:61], v[60:61] op_sel:[0,0] op_sel_hi:[1,0]
    v_pk_fma_f32 v[68:69], v[60:61], v[60:61], v[52:53] op_sel:[1,1,0] op_sel_hi:[0,1,1] neg_lo:[1,0,0]
    v_pk_mul_f32 v[52:53], v[68:69], v[54:55] op_sel:[0,0] op_sel_hi:[1,0]
    v_pk_fma_f32 v[70:71], v[68:69], v[54:55], v[52:53] op_sel:[1,1,0] op_sel_hi:[0,1,1] neg_lo:[1,0,0]
    v_and_b32 v52, 7, v0
    v_cvt_f32_u32 v53, v52
    v_mul_f32 v53, 0xbc800000, v53
    v_cos_f32 v72, v53
    v_sin_f32 v73, v53
    s_nop 0
    v_pk_mul_f32 v[86:87], v[72:73], v[72:73] op_sel:[0,0] op_sel_hi:[1,0]
    v_pk_fma_f32 v[74:75], v[72:73], v[72:73], v[86:87] op_sel:[1,1,0] op_sel_hi:[0,1,1] neg_lo:[1,0,0]
    v_pk_mul_f32 v[86:87], v[74:75], v[72:73] op_sel:[0,0] op_sel_hi:[1,0]
    v_pk_fma_f32 v[76:77], v[74:75], v[72:73], v[86:87] op_sel:[1,1,0] op_sel_hi:[0,1,1] neg_lo:[1,0,0]
    v_pk_mul_f32 v[86:87], v[74:75], v[74:75] op_sel:[0,0] op_sel_hi:[1,0]
    v_pk_fma_f32 v[78:79], v[74:75], v[74:75], v[86:87] op_sel:[1,1,0] op_sel_hi:[0,1,1] neg_lo:[1,0,0]
    v_pk_mul_f32 v[86:87], v[78:79], v[72:73] op_sel:[0,0] op_sel_hi:[1,0]
    v_pk_fma_f32 v[80:81], v[78:79], v[72:73], v[86:87] op_sel:[1,1,0] op_sel_hi:[0,1,1] neg_lo:[1,0,0]
    v_pk_mul_f32 v[86:87], v[76:77], v[76:77] op_sel:[0,0] op_sel_hi:[1,0]
    v_pk_fma_f32 v[82:83], v[76:77], v[76:77], v[86:87] op_sel:[1,1,0] op_sel_hi:[0,1,1] neg_lo:[1,0,0]
    v_pk_mul_f32 v[86:87], v[78:79], v[76:77] op_sel:[0,0] op_sel_hi:[1,0]
    v_pk_fma_f32 v[84:85], v[78:79], v[76:77], v[86:87] op_sel:[1,1,0] op_sel_hi:[0,1,1] neg_lo:[1,0,0]
    v_lshrrev_b32 v53, 3, v0
    v_lshlrev_b32 v86, 3, v0
    v_add_u32 v86, s18, v86
    v_mul_u32_u24 v87, 72, v53
    v_add_u32 v87, v87, v52
    v_lshlrev_b32 v87, 3, v87
    v_add_u32 v87, s18, v87
    v_mul_u32_u24 v88, 72, v53
    v_mad_u32_u24 v88, v52, 9, v88
    v_lshlrev_b32 v88, 3, v88
    v_add_u32 v88, s18, v88
    v_mad_u32_u24 v89, v52, 10, v53
    v_lshlrev_b32 v89, 3, v89
    v_add_u32 v89, s18, v89
    v_sub_u32 v90, 320, v0
    v_lshlrev_b32 v90, 3, v90
    v_add_u32 v90, s18, v90
    s_waitcnt vmcnt(20)
    s_mov_b64 exec, 1
    v_mov_b32 v5, 0
    v_mov_b32 v7, 0
    s_mov_b64 exec, -1
    v_pk_add_f32 v[52:53], v[4:5], v[6:7] op_sel:[0,1] op_sel_hi:[1,0] neg_lo:[0,1]
    v_pk_add_f32 v[92:93], v[4:5], v[6:7] op_sel:[0,1] op_sel_hi:[1,0] neg_hi:[1,0]
    ds_write_b64 v86, v[52:53] offset:0
    ds_write_b64 v90, v[92:93] offset:2560
    v_pk_add_f32 v[52:53], v[8:9], v[10:11] op_sel:[0,1] op_sel_hi:[1,0] neg_lo:[0,1]
    v_pk_add_f32 v[92:93], v[8:9], v[10:11] op_sel:[0,1] op_sel_hi:[1,0] neg_hi:[1,0]
    ds_write_b64 v86, v[52:53] offset:512
    ds_write_b64 v90, v[92:93] offset:2048
    v_pk_add_f32 v[52:53], v[12:13], v[14:15] op_sel:[0,1] op_sel_hi:[1,0] neg_lo:[0,1]
    v_pk_add_f32 v[92:93], v[12:13], v[14:15] op_sel:[0,1] op_sel_hi:[1,0] neg_hi:[1,0]
    ds_write_b64 v86, v[52:53] offset:1024
    ds_write_b64 v90, v[92:93] offset:1536
    v_pk_add_f32 v[52:53], v[16:17], v[18:19] op_sel:[0,1] op_sel_hi:[1,0] neg_lo:[0,1]
    v_pk_add_f32 v[92:93], v[16:17], v[18:19] op_sel:[0,1] op_sel_hi:[1,0] neg_hi:[1,0]
    ds_write_b64 v86, v[52:53] offset:1536
    ds_write_b64 v90, v[92:93] offset:1024
    v_pk_add_f32 v[52:53], v[20:21], v[22:23] op_sel:[0,1] op_sel_hi:[1,0] neg_lo:[0,1]
    v_pk_add_f32 v[92:93], v[20:21], v[22:23] op_sel:[0,1] op_sel_hi:[1,0] neg_hi:[1,0]
    ds_write_b64 v86, v[52:53] offset:2048
    ds_write_b64 v90, v[92:93] offset:512
    s_mov_b64 exec, 1
    v_mov_b32 v25, 0
    v_mov_b32 v27, 0
    v_pk_add_f32 v[52:53], v[24:25], v[26:27] op_sel:[0,1] op_sel_hi:[1,0] neg_lo:[0,1]
    v_pk_add_f32 v[92:93], v[24:25], v[26:27] op_sel:[0,1] op_sel_hi:[1,0] neg_hi:[1,0]
    ds_write_b64 v86, v[52:53] offset:2560
    ds_write_b64 v90, v[92:93] offset:0
    s_mov_b64 exec, -1
    ds_read_b64 v[4:5], v89 offset:0
    ds_read_b64 v[6:7], v89 offset:640
    ds_read_b64 v[8:9], v89 offset:1280
    ds_read_b64 v[10:11], v89 offset:1920
    ds_read_b64 v[12:13], v89 offset:2560
    ds_read_b64 v[14:15], v89 offset:3200
    ds_read_b64 v[16:17], v89 offset:3840
    ds_read_b64 v[18:19], v89 offset:4480
    s_mov_b64 exec, 0xffff
    ds_read_b64 v[20:21], v89 offset:64
    ds_read_b64 v[22:23], v89 offset:704
    ds_read_b64 v[24:25], v89 offset:1344
    ds_read_b64 v[26:27], v89 offset:1984
    ds_read_b64 v[52:53], v89 offset:2624
    ds_read_b64 v[92:93], v89 offset:3264
    ds_read_b64 v[94:95], v89 offset:3904
    ds_read_b64 v[96:97], v89 offset:4544
    s_mov_b64 exec, -1
    s_waitcnt lgkmcnt(0)
    v_pk_add_f32 v[98:99], v[4:5], v[12:13] neg_lo:[0,1] neg_hi:[0,1]
    v_pk_add_f32 v[4:5], v[4:5], v[12:13]
    v_pk_add_f32 v[12:13], v[6:7], v[14:15] neg_lo:[0,1] neg_hi:[0,1]
    v_pk_add_f32 v[6:7], v[6:7], v[14:15]
    v_pk_add_f32 v[14:15], v[8:9], v[16:17] neg_lo:[0,1] neg_hi:[0,1]
    v_pk_add_f32 v[8:9], v[8:9], v[16:17]
    v_pk_add_f32 v[16:17], v[10:11], v[18:19] neg_lo:[0,1] neg_hi:[0,1]
    v_pk_add_f32 v[10:11], v[10:11], v[18:19]
    v_pk_add_f32 v[18:19], v[4:5], v[8:9] neg_lo:[0,1] neg_hi:[0,1]
    v_pk_add_f32 v[4:5], v[4:5], v[8:9]
    v_pk_add_f32 v[8:9], v[6:7], v[10:11] neg_lo:[0,1] neg_hi:[0,1]
    v_pk_add_f32 v[6:7], v[6:7], v[10:11]
    v_pk_add_f32 v[10:11], v[4:5], v[6:7] neg_lo:[0,1] neg_hi:[0,1]
    v_pk_add_f32 v[4:5], v[4:5], v[6:7]
    v_pk_add_f32 v[6:7], v[18:19], v[8:9] op_sel:[0,1] op_sel_hi:[1,0] neg_lo:[0,1]
    v_pk_add_f32 v[8:9], v[18:19], v[8:9] op_sel:[0,1] op_sel_hi:[1,0] neg_hi:[0,1]
    v_pk_add_f32 v[18:19], v[98:99], v[14:15] op_sel:[0,1] op_sel_hi:[1,0] neg_lo:[0,1]
    v_pk_add_f32 v[98:99], v[98:99], v[14:15] op_sel:[0,1] op_sel_hi:[1,0] neg_hi:[0,1]
    v_pk_add_f32 v[14:15], v[12:13], v[12:13] op_sel:[0,1] op_sel_hi:[1,0] neg_lo:[0,1]
    v_pk_add_f32 v[12:13], v[16:17], v[16:17] op_sel:[0,1] op_sel_hi:[1,0] neg_hi:[0,1]
    v_pk_add_f32 v[16:17], v[14:15], v[12:13] neg_lo:[0,1] neg_hi:[0,1]
    v_pk_add_f32 v[14:15], v[14:15], v[12:13]
    v_pk_fma_f32 v[12:13], v[16:17], v[46:47], v[18:19] op_sel:[0,0,0] op_sel_hi:[1,0,1]
    v_pk_fma_f32 v[18:19], v[16:17], v[46:47], v[18:19] op_sel:[0,0,0] op_sel_hi:[1,0,1] neg_lo:[1,0,0] neg_hi:[1,0,0]
    v_pk_fma_f32 v[16:17], v[14:15], v[46:47], v[98:99] op_sel:[1,0,0] op_sel_hi:[0,0,1] neg_lo:[1,0,0]
    v_pk_fma_f32 v[14:15], v[14:15], v[46:47], v[98:99] op_sel:[1,0,0] op_sel_hi:[0,0,1] neg_hi:[1,0,0]
    v_pk_mul_f32 v[98:99], v[12:13], v[72:73] op_sel:[0,0] op_sel_hi:[1,0]
    v_pk_fma_f32 v[12:13], v[12:13], v[72:73], v[98:99] op_sel:[1,1,0] op_sel_hi:[0,1,1] neg_hi:[1,0,0]
    v_pk_mul_f32 v[98:99], v[6:7], v[74:75] op_sel:[0,0] op_sel_hi:[1,0]
    v_pk_fma_f32 v[6:7], v[6:7], v[74:75], v[98:99] op_sel:[1,1,0] op_sel_hi:[0,1,1] neg_hi:[1,0,0]
    v_pk_mul_f32 v[98:99], v[16:17], v[76:77] op_sel:[0,0] op_sel_hi:[1,0]
    v_pk_fma_f32 v[16:17], v[16:17], v[76:77], v[98:99] op_sel:[1,1,0] op_sel_hi:[0,1,1] neg_hi:[1,0,0]
    v_pk_mul_f32 v[98:99], v[10:11], v[78:79] op_sel:[0,0] op_sel_hi:[1,0]
    v_pk_fma_f32 v[10:11], v[10:11], v[78:79], v[98:99] op_sel:[1,1,0] op_sel_hi:[0,1,1] neg_hi:[1,0,0]
    v_pk_mul_f32 v[98:99], v[18:19], v[80:81] op_sel:[0,0] op_sel_hi:[1,0]
    v_pk_fma_f32 v[18:19], v[18:19], v[80:81], v[98:99] op_sel:[1,1,0] op_sel_hi:[0,1,1] neg_hi:[1,0,0]
    v_pk_mul_f32 v[98:99], v[8:9], v[82:83] op_sel:[0,0] op_sel_hi:[1,0]
    v_pk_fma_f32 v[8:9], v[8:9], v[82:83], v[98:99] op_sel:[1,1,0] op_sel_hi:[0,1,1] neg_hi:[1,0,0]
    v_pk_mul_f32 v[98:99], v[14:15], v[84:85] op_sel:[0,0] op_sel_hi:[1,0]
    v_pk_fma_f32 v[14:15], v[14:15], v[84:85], v[98:99] op_sel:[1,1,0] op_sel_hi:[0,1,1] neg_hi:[1,0,0]
    v_pk_add_f32 v[98:99], v[20:21], v[52:53] neg_lo:[0,1] neg_hi:[0,1]
    v_pk_add_f32 v[20:21], v[20:21], v[52:53]
    v_pk_add_f32 v[52:53], v[22:23], v[92:93] neg_lo:[0,1] neg_hi:[0,1]
    v_pk_add_f32 v[22:23], v[22:23], v[92:93]
    v_pk_add_f32 v[92:93], v[24:25], v[94:95] neg_lo:[0,1] neg_hi:[0,1]
    v_pk_add_f32 v[24:25], v[24:25], v[94:95]
    v_pk_add_f32 v[94:95], v[26:27], v[96:97] neg_lo:[0,1] neg_hi:[0,1]
    v_pk_add_f32 v[26:27], v[26:27], v[96:97]
    v_pk_add_f32 v[96:97], v[20:21], v[24:25] neg_lo:[0,1] neg_hi:[0,1]
    v_pk_add_f32 v[20:21], v[20:21], v[24:25]
    v_pk_add_f32 v[24:25], v[22:23], v[26:27] neg_lo:[0,1] neg_hi:[0,1]
    v_pk_add_f32 v[22:23], v[22:23], v[26:27]
    v_pk_add_f32 v[26:27], v[20:21], v[22:23] neg_lo:[0,1] neg_hi:[0,1]
    v_pk_add_f32 v[20:21], v[20:21], v[22:23]
    v_pk_add_f32 v[22:23], v[96:97], v[24:25] op_sel:[0,1] op_sel_hi:[1,0] neg_lo:[0,1]
    v_pk_add_f32 v[24:25], v[96:97], v[24:25] op_sel:[0,1] op_sel_hi:[1,0] neg_hi:[0,1]
    v_pk_add_f32 v[96:97], v[98:99], v[92:93] op_sel:[0,1] op_sel_hi:[1,0] neg_lo:[0,1]
    v_pk_add_f32 v[98:99], v[98:99], v[92:93] op_sel:[0,1] op_sel_hi:[1,0] neg_hi:[0,1]
    v_pk_add_f32 v[92:93], v[52:53], v[52:53] op_sel:[0,1] op_sel_hi:[1,0] neg_lo:[0,1]
    v_pk_add_f32 v[52:53], v[94:95], v[94:95] op_sel:[0,1] op_sel_hi:[1,0] neg_hi:[0,1]
    v_pk_add_f32 v[94:95], v[92:93], v[52:53] neg_lo:[0,1] neg_hi:[0,1]
    v_pk_add_f32 v[92:93], v[92:93], v[52:53]
    v_pk_fma_f32 v[52:53], v[94:95], v[46:47], v[96:97] op_sel:[0,0,0] op_sel_hi:[1,0,1]
    v_pk_fma_f32 v[96:97], v[94:95], v[46:47], v[96:97] op_sel:[0,0,0] op_sel_hi:[1,0,1] neg_lo:[1,0,0] neg_hi:[1,0,0]
    v_pk_fma_f32 v[94:95], v[92:93], v[46:47], v[98:99] op_sel:[1,0,0] op_sel_hi:[0,0,1] neg_lo:[1,0,0]
    v_pk_fma_f32 v[92:93], v[92:93], v[46:47], v[98:99] op_sel:[1,0,0] op_sel_hi:[0,0,1] neg_hi:[1,0,0]
    v_pk_mul_f32 v[98:99], v[52:53], v[72:73] op_sel:[0,0] op_sel_hi:[1,0]
    v_pk_fma_f32 v[52:53], v[52:53], v[72:73], v[98:99] op_sel:[1,1,0] op_sel_hi:[0,1,1] neg_hi:[1,0,0]
    v_pk_mul_f32 v[98:99], v[22:23], v[74:75] op_sel:[0,0] op_sel_hi:[1,0]
    v_pk_fma_f32 v[22:23], v[22:23], v[74:75], v[98:99] op_sel:[1,1,0] op_sel_hi:[0,1,1] neg_hi:[1,0,0]
    v_pk_mul_f32 v[98:99], v[94:95], v[76:77] op_sel:[0,0] op_sel_hi:[1,0]
    v_pk_fma_f32 v[94:95], v[94:95], v[76:77], v[98:99] op_sel:[1,1,0] op_sel_hi:[0,1,1] neg_hi:[1,0,0]
    v_pk_mul_f32 v[98:99], v[26:27], v[78:79] op_sel:[0,0] op_sel_hi:[1,0]
    v_pk_fma_f32 v[26:27], v[26:27], v[78:79], v[98:99] op_sel:[1,1,0] op_sel_hi:[0,1,1] neg_hi:[1,0,0]
    v_pk_mul_f32 v[98:99], v[96:97], v[80:81] op_sel:[0,0] op_sel_hi:[1,0]
    v_pk_fma_f32 v[96:97], v[96:97], v[80:81], v[98:99] op_sel:[1,1,0] op_sel_hi:[0,1,1] neg_hi:[1,0,0]
    v_pk_mul_f32 v[98:99], v[24:25], v[82:83] op_sel:[0,0] op_sel_hi:[1,0]
    v_pk_fma_f32 v[24:25], v[24:25], v[82:83], v[98:99] op_sel:[1,1,0] op_sel_hi:[0,1,1] neg_hi:[1,0,0]
    v_pk_mul_f32 v[98:99], v[92:93], v[84:85] op_sel:[0,0] op_sel_hi:[1,0]
    v_pk_fma_f32 v[92:93], v[92:93], v[84:85], v[98:99] op_sel:[1,1,0] op_sel_hi:[0,1,1] neg_hi:[1,0,0]
    ds_write_b64 v87, v[4:5] offset:0
    ds_write_b64 v87, v[12:13] offset:72
    ds_write_b64 v87, v[6:7] offset:144
    ds_write_b64 v87, v[16:17] offset:216
    ds_write_b64 v87, v[10:11] offset:288
    ds_write_b64 v87, v[18:19] offset:360
    ds_write_b64 v87, v[8:9] offset:432
    ds_write_b64 v87, v[14:15] offset:504
    s_mov_b64 exec, 0xffff
    ds_write_b64 v87, v[20:21] offset:4608
    ds_write_b64 v87, v[52:53] offset:4680
    ds_write_b64 v87, v[22:23] offset:4752
    ds_write_b64 v87, v[94:95] offset:4824
    ds_write_b64 v87, v[26:27] offset:4896
    ds_write_b64 v87, v[96:97] offset:4968
    ds_write_b64 v87, v[24:25] offset:5040
    ds_write_b64 v87, v[92:93] offset:5112
    s_mov_b64 exec, -1
    ds_read_b64 v[4:5], v88 offset:0
    ds_read_b64 v[12:13], v88 offset:8
    ds_read_b64 v[6:7], v88 offset:16
    ds_read_b64 v[16:17], v88 offset:24
    ds_read_b64 v[10:11], v88 offset:32
    ds_read_b64 v[18:19], v88 offset:40
    ds_read_b64 v[8:9], v88 offset:48
    ds_read_b64 v[14:15], v88 offset:56
    s_mov_b64 exec, 0xffff
    ds_read_b64 v[20:21], v88 offset:4608
    ds_read_b64 v[52:53], v88 offset:4616
    ds_read_b64 v[22:23], v88 offset:4624
    ds_read_b64 v[94:95], v88 offset:4632
    ds_read_b64 v[26:27], v88 offset:4640
    ds_read_b64 v[96:97], v88 offset:4648
    ds_read_b64 v[24:25], v88 offset:4656
    ds_read_b64 v[92:93], v88 offset:4664
    s_mov_b64 exec, -1
    s_waitcnt lgkmcnt(0)
    v_pk_add_f32 v[98:99], v[4:5], v[10:11] neg_lo:[0,1] neg_hi:[0,1]
    v_pk_add_f32 v[4:5], v[4:5], v[10:11]
    v_pk_add_f32 v[10:11], v[12:13], v[18:19] neg_lo:[0,1] neg_hi:[0,1]
    v_pk_add_f32 v[12:13], v[12:13], v[18:19]
    v_pk_add_f32 v[18:19], v[6:7], v[8:9] neg_lo:[0,1] neg_hi:[0,1]
    v_pk_add_f32 v[6:7], v[6:7], v[8:9]
    v_pk_add_f32 v[8:9], v[16:17], v[14:15] neg_lo:[0,1] neg_hi:[0,1]
    v_pk_add_f32 v[16:17], v[16:17], v[14:15]
    v_pk_add_f32 v[14:15], v[4:5], v[6:7] neg_lo:[0,1] neg_hi:[0,1]
    v_pk_add_f32 v[4:5], v[4:5], v[6:7]
    v_pk_add_f32 v[6:7], v[12:13], v[16:17] neg_lo:[0,1] neg_hi:[0,1]
    v_pk_add_f32 v[12:13], v[12:13], v[16:17]
    v_pk_add_f32 v[16:17], v[4:5], v[12:13] neg_lo:[0,1] neg_hi:[0,1]
    v_pk_add_f32 v[4:5], v[4:5], v[12:13]
    v_pk_add_f32 v[12:13], v[14:15], v[6:7] op_sel:[0,1] op_sel_hi:[1,0] neg_lo:[0,1]
    v_pk_add_f32 v[6:7], v[14:15], v[6:7] op_sel:[0,1] op_sel_hi:[1,0] neg_hi:[0,1]
    v_pk_add_f32 v[14:15], v[98:99], v[18:19] op_sel:[0,1] op_sel_hi:[1,0] neg_lo:[0,1]
    v_pk_add_f32 v[98:99], v[98:99], v[18:19] op_sel:[0,1] op_sel_hi:[1,0] neg_hi:[0,1]
    v_pk_add_f32 v[18:19], v[10:11], v[10:11] op_sel:[0,1] op_sel_hi:[1,0] neg_lo:[0,1]
    v_pk_add_f32 v[10:11], v[8:9], v[8:9] op_sel:[0,1] op_sel_hi:[1,0] neg_hi:[0,1]
    v_pk_add_f32 v[8:9], v[18:19], v[10:11] neg_lo:[0,1] neg_hi:[0,1]
    v_pk_add_f32 v[18:19], v[18:19], v[10:11]
    v_pk_fma_f32 v[10:11], v[8:9], v[46:47], v[14:15] op_sel:[0,0,0] op_sel_hi:[1,0,1]
    v_pk_fma_f32 v[14:15], v[8:9], v[46:47], v[14:15] op_sel:[0,0,0] op_sel_hi:[1,0,1] neg_lo:[1,0,0] neg_hi:[1,0,0]
    v_pk_fma_f32 v[8:9], v[18:19], v[46:47], v[98:99] op_sel:[1,0,0] op_sel_hi:[0,0,1] neg_lo:[1,0,0]
    v_pk_fma_f32 v[18:19], v[18:19], v[46:47], v[98:99] op_sel:[1,0,0] op_sel_hi:[0,0,1] neg_hi:[1,0,0]
    v_pk_add_f32 v[98:99], v[20:21], v[26:27] neg_lo:[0,1] neg_hi:[0,1]
    v_pk_add_f32 v[20:21], v[20:21], v[26:27]
    v_pk_add_f32 v[26:27], v[52:53], v[96:97] neg_lo:[0,1] neg_hi:[0,1]
    v_pk_add_f32 v[52:53], v[52:53], v[96:97]
    v_pk_add_f32 v[96:97], v[22:23], v[24:25] neg_lo:[0,1] neg_hi:[0,1]
    v_pk_add_f32 v[22:23], v[22:23], v[24:25]
    v_pk_add_f32 v[24:25], v[94:95], v[92:93] neg_lo:[0,1] neg_hi:[0,1]
    v_pk_add_f32 v[94:95], v[94:95], v[92:93]
    v_pk_add_f32 v[92:93], v[20:21], v[22:23] neg_lo:[0,1] neg_hi:[0,1]
    v_pk_add_f32 v[20:21], v[20:21], v[22:23]
    v_pk_add_f32 v[22:23], v[52:53], v[94:95] neg_lo:[0,1] neg_hi:[0,1]
    v_pk_add_f32 v[52:53], v[52:53], v[94:95]
    v_pk_add_f32 v[94:95], v[20:21], v[52:53] neg_lo:[0,1] neg_hi:[0,1]
    v_pk_add_f32 v[20:21], v[20:21], v[52:53]
    v_pk_add_f32 v[52:53], v[92:93], v[22:23] op_sel:[0,1] op_sel_hi:[1,0] neg_lo:[0,1]
    v_pk_add_f32 v[22:23], v[92:93], v[22:23] op_sel:[0,1] op_sel_hi:[1,0] neg_hi:[0,1]
    v_pk_add_f32 v[92:93], v[98:99], v[96:97] op_sel:[0,1] op_sel_hi:[1,0] neg_lo:[0,1]
    v_pk_add_f32 v[98:99], v[98:99], v[96:97] op_sel:[0,1] op_sel_hi:[1,0] neg_hi:[0,1]
    v_pk_add_f32 v[96:97], v[26:27], v[26:27] op_sel:[0,1] op_sel_hi:[1,0] neg_lo:[0,1]
    v_pk_add_f32 v[26:27], v[24:25], v[24:25] op_sel:[0,1] op_sel_hi:[1,0] neg_hi:[0,1]
    v_pk_add_f32 v[24:25], v[96:97], v[26:27] neg_lo:[0,1] neg_hi:[0,1]
    v_pk_add_f32 v[96:97], v[96:97], v[26:27]
    v_pk_fma_f32 v[26:27], v[24:25], v[46:47], v[92:93] op_sel:[0,0,0] op_sel_hi:[1,0,1]
    v_pk_fma_f32 v[92:93], v[24:25], v[46:47], v[92:93] op_sel:[0,0,0] op_sel_hi:[1,0,1] neg_lo:[1,0,0] neg_hi:[1,0,0]
    v_pk_fma_f32 v[24:25], v[96:97], v[46:47], v[98:99] op_sel:[1,0,0] op_sel_hi:[0,0,1] neg_lo:[1,0,0]
    v_pk_fma_f32 v[96:97], v[96:97], v[46:47], v[98:99] op_sel:[1,0,0] op_sel_hi:[0,0,1] neg_hi:[1,0,0]
    ds_write_b64 v87, v[4:5] offset:0
    ds_write_b64 v87, v[10:11] offset:64
    ds_write_b64 v87, v[12:13] offset:128
    ds_write_b64 v87, v[8:9] offset:192
    ds_write_b64 v87, v[16:17] offset:256
    ds_write_b64 v87, v[14:15] offset:320
    ds_write_b64 v87, v[6:7] offset:384
    ds_write_b64 v87, v[18:19] offset:448
    s_mov_b64 exec, 0xffff
    ds_write_b64 v87, v[20:21] offset:4608
    ds_write_b64 v87, v[26:27] offset:4672
    ds_write_b64 v87, v[52:53] offset:4736
    ds_write_b64 v87, v[24:25] offset:4800
    ds_write_b64 v87, v[94:95] offset:4864
    ds_write_b64 v87, v[92:93] offset:4928
    ds_write_b64 v87, v[22:23] offset:4992
    ds_write_b64 v87, v[96:97] offset:5056
    s_mov_b64 exec, -1
    ds_read_b64 v[4:5], v86 offset:0
    ds_read_b64 v[10:11], v86 offset:576
    ds_read_b64 v[12:13], v86 offset:1152
    ds_read_b64 v[8:9], v86 offset:1728
    ds_read_b64 v[16:17], v86 offset:2304
    ds_read_b64 v[14:15], v86 offset:2880
    ds_read_b64 v[6:7], v86 offset:3456
    ds_read_b64 v[18:19], v86 offset:4032
    ds_read_b64 v[20:21], v86 offset:4608
    ds_read_b64 v[26:27], v86 offset:5184
    s_waitcnt lgkmcnt(0)
    v_pk_mul_f32 v[22:23], v[10:11], v[54:55] op_sel:[0,0] op_sel_hi:[1,0]
    v_pk_fma_f32 v[10:11], v[10:11], v[54:55], v[22:23] op_sel:[1,1,0] op_sel_hi:[0,1,1] neg_hi:[1,0,0]
    v_pk_mul_f32 v[22:23], v[12:13], v[56:57] op_sel:[0,0] op_sel_hi:[1,0]
    v_pk_fma_f32 v[12:13], v[12:13], v[56:57], v[22:23] op_sel:[1,1,0] op_sel_hi:[0,1,1] neg_hi:[1,0,0]
    v_pk_mul_f32 v[22:23], v[8:9], v[58:59] op_sel:[0,0] op_sel_hi:[1,0]
    v_pk_fma_f32 v[8:9], v[8:9], v[58:59], v[22:23] op_sel:[1,1,0] op_sel_hi:[0,1,1] neg_hi:[1,0,0]
    v_pk_mul_f32 v[22:23], v[16:17], v[60:61] op_sel:[0,0] op_sel_hi:[1,0]
    v_pk_fma_f32 v[16:17], v[16:17], v[60:61], v[22:23] op_sel:[1,1,0] op_sel_hi:[0,1,1] neg_hi:[1,0,0]
    v_pk_mul_f32 v[22:23], v[14:15], v[62:63] op_sel:[0,0] op_sel_hi:[1,0]
    v_pk_fma_f32 v[14:15], v[14:15], v[62:63], v[22:23] op_sel:[1,1,0] op_sel_hi:[0,1,1] neg_hi:[1,0,0]
    v_pk_mul_f32 v[22:23], v[6:7], v[64:65] op_sel:[0,0] op_sel_hi:[1,0]
    v_pk_fma_f32 v[6:7], v[6:7], v[64:65], v[22:23] op_sel:[1,1,0] op_sel_hi:[0,1,1] neg_hi:[1,0,0]
    v_pk_mul_f32 v[22:23], v[18:19], v[66:67] op_sel:[0,0] op_sel_hi:[1,0]
    v_pk_fma_f32 v[18:19], v[18:19], v[66:67], v[22:23] op_sel:[1,1,0] op_sel_hi:[0,1,1] neg_hi:[1,0,0]
    v_pk_mul_f32 v[22:23], v[20:21], v[68:69] op_sel:[0,0] op_sel_hi:[1,0]
    v_pk_fma_f32 v[20:21], v[20:21], v[68:69], v[22:23] op_sel:[1,1,0] op_sel_hi:[0,1,1] neg_hi:[1,0,0]
    v_pk_mul_f32 v[22:23], v[26:27], v[70:71] op_sel:[0,0] op_sel_hi:[1,0]
    v_pk_fma_f32 v[26:27], v[26:27], v[70:71], v[22:23] op_sel:[1,1,0] op_sel_hi:[0,1,1] neg_hi:[1,0,0]
    v_pk_add_f32 v[22:23], v[4:5], v[14:15] neg_lo:[0,1] neg_hi:[0,1]
    v_pk_add_f32 v[4:5], v[4:5], v[14:15]
    v_pk_add_f32 v[14:15], v[12:13], v[18:19] neg_lo:[0,1] neg_hi:[0,1]
    v_pk_add_f32 v[12:13], v[12:13], v[18:19]
    v_pk_add_f32 v[18:19], v[16:17], v[26:27] neg_lo:[0,1] neg_hi:[0,1]
    v_pk_add_f32 v[16:17], v[16:17], v[26:27]
    v_pk_add_f32 v[24:25], v[6:7], v[10:11] neg_lo:[0,1] neg_hi:[0,1]
    v_pk_add_f32 v[6:7], v[6:7], v[10:11]
    v_pk_add_f32 v[10:11], v[20:21], v[8:9] neg_lo:[0,1] neg_hi:[0,1]
    v_pk_add_f32 v[20:21], v[20:21], v[8:9]
    v_pk_add_f32 v[8:9], v[12:13], v[20:21]
    v_pk_add_f32 v[26:27], v[16:17], v[6:7]
    v_pk_add_f32 v[12:13], v[12:13], v[20:21] neg_lo:[0,1] neg_hi:[0,1]
    v_pk_add_f32 v[16:17], v[16:17], v[6:7] neg_lo:[0,1] neg_hi:[0,1]
    v_pk_fma_f32 v[20:21], v[8:9], v[48:49], v[4:5] op_sel:[0,0,0] op_sel_hi:[1,0,1]
    v_pk_fma_f32 v[20:21], v[26:27], v[48:49], v[20:21] op_sel:[0,1,0] op_sel_hi:[1,1,1]
    v_pk_fma_f32 v[6:7], v[8:9], v[48:49], v[4:5] op_sel:[0,1,0] op_sel_hi:[1,1,1]
    v_pk_fma_f32 v[6:7], v[26:27], v[48:49], v[6:7] op_sel:[0,0,0] op_sel_hi:[1,0,1]
    v_pk_add_f32 v[8:9], v[8:9], v[26:27]
    v_pk_add_f32 v[4:5], v[4:5], v[8:9]
    v_pk_mul_f32 v[8:9], v[12:13], v[50:51] op_sel:[0,0] op_sel_hi:[1,0]
    v_pk_fma_f32 v[8:9], v[16:17], v[50:51], v[8:9] op_sel:[0,1,0] op_sel_hi:[1,1,1]
    v_pk_mul_f32 v[26:27], v[12:13], v[50:51] op_sel:[0,1] op_sel_hi:[1,1]
    v_pk_fma_f32 v[26:27], v[16:17], v[50:51], v[26:27] op_sel:[0,0,0] op_sel_hi:[1,0,1] neg_lo:[1,0,0] neg_hi:[1,0,0]
    v_pk_add_f32 v[12:13], v[20:21], v[8:9] op_sel:[0,1] op_sel_hi:[1,0] neg_lo:[0,1]
    v_pk_add_f32 v[20:21], v[20:21], v[8:9] op_sel:[0,1] op_sel_hi:[1,0] neg_hi:[0,1]
    v_pk_add_f32 v[16:17], v[6:7], v[26:27] op_sel:[0,1] op_sel_hi:[1,0] neg_lo:[0,1]
    v_pk_add_f32 v[6:7], v[6:7], v[26:27] op_sel:[0,1] op_sel_hi:[1,0] neg_hi:[0,1]
    v_pk_add_f32 v[8:9], v[14:15], v[10:11]
    v_pk_add_f32 v[26:27], v[18:19], v[24:25]
    v_pk_add_f32 v[14:15], v[14:15], v[10:11] neg_lo:[0,1] neg_hi:[0,1]
    v_pk_add_f32 v[18:19], v[18:19], v[24:25] neg_lo:[0,1] neg_hi:[0,1]
    v_pk_fma_f32 v[10:11], v[8:9], v[48:49], v[22:23] op_sel:[0,0,0] op_sel_hi:[1,0,1]
    v_pk_fma_f32 v[10:11], v[26:27], v[48:49], v[10:11] op_sel:[0,1,0] op_sel_hi:[1,1,1]
    v_pk_fma_f32 v[24:25], v[8:9], v[48:49], v[22:23] op_sel:[0,1,0] op_sel_hi:[1,1,1]
    v_pk_fma_f32 v[24:25], v[26:27], v[48:49], v[24:25] op_sel:[0,0,0] op_sel_hi:[1,0,1]
    v_pk_add_f32 v[8:9], v[8:9], v[26:27]
    v_pk_add_f32 v[22:23], v[22:23], v[8:9]
    v_pk_mul_f32 v[8:9], v[14:15], v[50:51] op_sel:[0,0] op_sel_hi:[1,0]
    v_pk_fma_f32 v[8:9], v[18:19], v[50:51], v[8:9] op_sel:[0,1,0] op_sel_hi:[1,1,1]
    v_pk_mul_f32 v[26:27], v[14:15], v[50:51] op_sel:[0,1] op_sel_hi:[1,1]
    v_pk_fma_f32 v[26:27], v[18:19], v[50:51], v[26:27] op_sel:[0,0,0] op_sel_hi:[1,0,1] neg_lo:[1,0,0] neg_hi:[1,0,0]
    v_pk_add_f32 v[14:15], v[10:11], v[8:9] op_sel:[0,1] op_sel_hi:[1,0] neg_lo:[0,1]
    v_pk_add_f32 v[10:11], v[10:11], v[8:9] op_sel:[0,1] op_sel_hi:[1,0] neg_hi:[0,1]
    v_pk_add_f32 v[18:19], v[24:25], v[26:27] op_sel:[0,1] op_sel_hi:[1,0] neg_lo:[0,1]
    v_pk_add_f32 v[24:25], v[24:25], v[26:27] op_sel:[0,1] op_sel_hi:[1,0] neg_hi:[0,1]
    v_mov_b32 v8, 0x34cccccd
    v_mov_b32 v9, 0x34cccccd
    s_waitcnt vmcnt(0)
    v_pk_mul_f32 v[4:5], v[4:5], v[8:9] op_sel:[0,0] op_sel_hi:[1,0]
    v_cvt_pk_bf16_f32 v26, v4, v5
    v_lshlrev_b32 v4, 16, v26
    v_and_b32 v5, 0xffff0000, v26
    v_pk_add_f32 v[4:5], v[4:5], v[2:3]
    v_cvt_pk_bf16_f32 v26, v4, v5
    v_lshlrev_b32 v4, 16, v26
    v_and_b32 v5, 0xffff0000, v26
    v_pk_mul_f32 v[14:15], v[14:15], v[8:9] op_sel:[0,0] op_sel_hi:[1,0]
    v_cvt_pk_bf16_f32 v26, v14, v15
    v_lshlrev_b32 v14, 16, v26
    v_and_b32 v15, 0xffff0000, v26
    v_pk_add_f32 v[14:15], v[14:15], v[28:29]
    v_cvt_pk_bf16_f32 v26, v14, v15
    v_lshlrev_b32 v14, 16, v26
    v_and_b32 v15, 0xffff0000, v26
    v_pk_mul_f32 v[16:17], v[16:17], v[8:9] op_sel:[0,0] op_sel_hi:[1,0]
    v_cvt_pk_bf16_f32 v26, v16, v17
    v_lshlrev_b32 v16, 16, v26
    v_and_b32 v17, 0xffff0000, v26
    v_pk_add_f32 v[16:17], v[16:17], v[30:31]
    v_cvt_pk_bf16_f32 v26, v16, v17
    v_lshlrev_b32 v16, 16, v26
    v_and_b32 v17, 0xffff0000, v26
    v_pk_mul_f32 v[24:25], v[24:25], v[8:9] op_sel:[0,0] op_sel_hi:[1,0]
    v_cvt_pk_bf16_f32 v26, v24, v25
    v_lshlrev_b32 v24, 16, v26
    v_and_b32 v25, 0xffff0000, v26
    v_pk_add_f32 v[24:25], v[24:25], v[32:33]
    v_cvt_pk_bf16_f32 v26, v24, v25
    v_lshlrev_b32 v24, 16, v26
    v_and_b32 v25, 0xffff0000, v26
    v_pk_mul_f32 v[20:21], v[20:21], v[8:9] op_sel:[0,0] op_sel_hi:[1,0]
    v_cvt_pk_bf16_f32 v26, v20, v21
    v_lshlrev_b32 v20, 16, v26
    v_and_b32 v21, 0xffff0000, v26
    v_pk_add_f32 v[20:21], v[20:21], v[34:35]
    v_cvt_pk_bf16_f32 v26, v20, v21
    v_lshlrev_b32 v20, 16, v26
    v_and_b32 v21, 0xffff0000, v26
    v_pk_mul_f32 v[22:23], v[22:23], v[8:9] op_sel:[0,0] op_sel_hi:[1,0]
    v_cvt_pk_bf16_f32 v26, v22, v23
    v_lshlrev_b32 v22, 16, v26
    v_and_b32 v23, 0xffff0000, v26
    v_pk_add_f32 v[22:23], v[22:23], v[36:37]
    v_cvt_pk_bf16_f32 v26, v22, v23
    v_lshlrev_b32 v22, 16, v26
    v_and_b32 v23, 0xffff0000, v26
    v_pk_mul_f32 v[12:13], v[12:13], v[8:9] op_sel:[0,0] op_sel_hi:[1,0]
    v_cvt_pk_bf16_f32 v26, v12, v13
    v_lshlrev_b32 v12, 16, v26
    v_and_b32 v13, 0xffff0000, v26
    v_pk_add_f32 v[12:13], v[12:13], v[38:39]
    v_cvt_pk_bf16_f32 v26, v12, v13
    v_lshlrev_b32 v12, 16, v26
    v_and_b32 v13, 0xffff0000, v26
    v_pk_mul_f32 v[18:19], v[18:19], v[8:9] op_sel:[0,0] op_sel_hi:[1,0]
    v_cvt_pk_bf16_f32 v26, v18, v19
    v_lshlrev_b32 v18, 16, v26
    v_and_b32 v19, 0xffff0000, v26
    v_pk_add_f32 v[18:19], v[18:19], v[40:41]
    v_cvt_pk_bf16_f32 v26, v18, v19
    v_lshlrev_b32 v18, 16, v26
    v_and_b32 v19, 0xffff0000, v26
    v_pk_mul_f32 v[6:7], v[6:7], v[8:9] op_sel:[0,0] op_sel_hi:[1,0]
    v_cvt_pk_bf16_f32 v26, v6, v7
    v_lshlrev_b32 v6, 16, v26
    v_and_b32 v7, 0xffff0000, v26
    v_pk_add_f32 v[6:7], v[6:7], v[42:43]
    v_cvt_pk_bf16_f32 v26, v6, v7
    v_lshlrev_b32 v6, 16, v26
    v_and_b32 v7, 0xffff0000, v26
    v_pk_mul_f32 v[10:11], v[10:11], v[8:9] op_sel:[0,0] op_sel_hi:[1,0]
    v_cvt_pk_bf16_f32 v26, v10, v11
    v_lshlrev_b32 v10, 16, v26
    v_and_b32 v11, 0xffff0000, v26
    v_pk_add_f32 v[10:11], v[10:11], v[44:45]
    v_cvt_pk_bf16_f32 v26, v10, v11
    v_lshlrev_b32 v10, 16, v26
    v_and_b32 v11, 0xffff0000, v26
    buffer_store_short_d16_hi v4, v1, s[28:31], s17 offen offset:0
    buffer_store_short_d16_hi v5, v1, s[28:31], s17 offen offset:1280
    buffer_store_short_d16_hi v14, v1, s[28:31], s17 offen offset:128
    buffer_store_short_d16_hi v15, v1, s[28:31], s17 offen offset:1408
    buffer_store_short_d16_hi v16, v1, s[28:31], s17 offen offset:256
    buffer_store_short_d16_hi v17, v1, s[28:31], s17 offen offset:1536
    buffer_store_short_d16_hi v24, v1, s[28:31], s17 offen offset:384
    buffer_store_short_d16_hi v25, v1, s[28:31], s17 offen offset:1664
    buffer_store_short_d16_hi v20, v1, s[28:31], s17 offen offset:512
    buffer_store_short_d16_hi v21, v1, s[28:31], s17 offen offset:1792
    buffer_store_short_d16_hi v22, v1, s[28:31], s17 offen offset:640
    buffer_store_short_d16_hi v23, v1, s[28:31], s17 offen offset:1920
    buffer_store_short_d16_hi v12, v1, s[28:31], s17 offen offset:768
    buffer_store_short_d16_hi v13, v1, s[28:31], s17 offen offset:2048
    buffer_store_short_d16_hi v18, v1, s[28:31], s17 offen offset:896
    buffer_store_short_d16_hi v19, v1, s[28:31], s17 offen offset:2176
    buffer_store_short_d16_hi v6, v1, s[28:31], s17 offen offset:1024
    buffer_store_short_d16_hi v7, v1, s[28:31], s17 offen offset:2304
    buffer_store_short_d16_hi v10, v1, s[28:31], s17 offen offset:1152
    buffer_store_short_d16_hi v11, v1, s[28:31], s17 offen offset:2432
    v_mov_b32 v30, 0x3acccccd
    v_mov_b32 v31, 0x3acccccd
    v_pk_add_f32 v[2:3], v[4:5], v[14:15]
    v_pk_add_f32 v[2:3], v[2:3], v[16:17]
    v_pk_add_f32 v[2:3], v[2:3], v[24:25]
    v_pk_add_f32 v[2:3], v[2:3], v[20:21]
    v_pk_add_f32 v[2:3], v[2:3], v[22:23]
    v_pk_add_f32 v[2:3], v[2:3], v[12:13]
    v_pk_add_f32 v[2:3], v[2:3], v[18:19]
    v_pk_add_f32 v[2:3], v[2:3], v[6:7]
    v_pk_add_f32 v[2:3], v[2:3], v[10:11]
    s_nop 1
    v_add_f32_dpp v2, v2, v2 quad_perm:[1,0,3,2] row_mask:0xf bank_mask:0xf
    v_add_f32_dpp v3, v3, v3 quad_perm:[1,0,3,2] row_mask:0xf bank_mask:0xf
    s_nop 1
    v_add_f32_dpp v2, v2, v2 quad_perm:[2,3,0,1] row_mask:0xf bank_mask:0xf
    v_add_f32_dpp v3, v3, v3 quad_perm:[2,3,0,1] row_mask:0xf bank_mask:0xf
    s_nop 1
    v_add_f32_dpp v2, v2, v2 row_half_mirror row_mask:0xf bank_mask:0xf
    v_add_f32_dpp v3, v3, v3 row_half_mirror row_mask:0xf bank_mask:0xf
    s_nop 1
    v_add_f32_dpp v2, v2, v2 row_mirror row_mask:0xf bank_mask:0xf
    v_add_f32_dpp v3, v3, v3 row_mirror row_mask:0xf bank_mask:0xf
    s_nop 1
    v_readlane_b32 s20, v2, 0
    v_readlane_b32 s21, v2, 16
    v_readlane_b32 s22, v2, 32
    v_readlane_b32 s23, v2, 48
    v_readlane_b32 s24, v3, 0
    v_readlane_b32 s25, v3, 16
    v_readlane_b32 s26, v3, 32
    v_readlane_b32 s27, v3, 48
    s_nop 1
    v_mov_b32 v2, s20
    v_add_f32 v2, s21, v2
    v_add_f32 v2, s22, v2
    v_add_f32 v2, s23, v2
    v_mov_b32 v3, s24
    v_add_f32 v3, s25, v3
    v_add_f32 v3, s26, v3
    v_add_f32 v3, s27, v3
    v_pk_mul_f32 v[2:3], v[2:3], v[30:31] op_sel:[0,0] op_sel_hi:[1,0]
    v_pk_add_f32 v[26:27], v[4:5], v[2:3] neg_lo:[0,1] neg_hi:[0,1]
    v_pk_mul_f32 v[8:9], v[26:27], v[26:27]
    v_pk_add_f32 v[26:27], v[14:15], v[2:3] neg_lo:[0,1] neg_hi:[0,1]
    v_pk_fma_f32 v[8:9], v[26:27], v[26:27], v[8:9]
    v_pk_add_f32 v[26:27], v[16:17], v[2:3] neg_lo:[0,1] neg_hi:[0,1]
    v_pk_fma_f32 v[8:9], v[26:27], v[26:27], v[8:9]
    v_pk_add_f32 v[26:27], v[24:25], v[2:3] neg_lo:[0,1] neg_hi:[0,1]
    v_pk_fma_f32 v[8:9], v[26:27], v[26:27], v[8:9]
    v_pk_add_f32 v[26:27], v[20:21], v[2:3] neg_lo:[0,1] neg_hi:[0,1]
    v_pk_fma_f32 v[8:9], v[26:27], v[26:27], v[8:9]
    v_pk_add_f32 v[26:27], v[22:23], v[2:3] neg_lo:[0,1] neg_hi:[0,1]
    v_pk_fma_f32 v[8:9], v[26:27], v[26:27], v[8:9]
    v_pk_add_f32 v[26:27], v[12:13], v[2:3] neg_lo:[0,1] neg_hi:[0,1]
    v_pk_fma_f32 v[8:9], v[26:27], v[26:27], v[8:9]
    v_pk_add_f32 v[26:27], v[18:19], v[2:3] neg_lo:[0,1] neg_hi:[0,1]
    v_pk_fma_f32 v[8:9], v[26:27], v[26:27], v[8:9]
    v_pk_add_f32 v[26:27], v[6:7], v[2:3] neg_lo:[0,1] neg_hi:[0,1]
    v_pk_fma_f32 v[8:9], v[26:27], v[26:27], v[8:9]
    v_pk_add_f32 v[26:27], v[10:11], v[2:3] neg_lo:[0,1] neg_hi:[0,1]
    v_pk_fma_f32 v[8:9], v[26:27], v[26:27], v[8:9]
    s_nop 1
    v_add_f32_dpp v8, v8, v8 quad_perm:[1,0,3,2] row_mask:0xf bank_mask:0xf
    v_add_f32_dpp v9, v9, v9 quad_perm:[1,0,3,2] row_mask:0xf bank_mask:0xf
    s_nop 1
    v_add_f32_dpp v8, v8, v8 quad_perm:[2,3,0,1] row_mask:0xf bank_mask:0xf
    v_add_f32_dpp v9, v9, v9 quad_perm:[2,3,0,1] row_mask:0xf bank_mask:0xf
    s_nop 1
    v_add_f32_dpp v8, v8, v8 row_half_mirror row_mask:0xf bank_mask:0xf
    v_add_f32_dpp v9, v9, v9 row_half_mirror row_mask:0xf bank_mask:0xf
    s_nop 1
    v_add_f32_dpp v8, v8, v8 row_mirror row_mask:0xf bank_mask:0xf
    v_add_f32_dpp v9, v9, v9 row_mirror row_mask:0xf bank_mask:0xf
    s_nop 1
    v_readlane_b32 s20, v8, 0
    v_readlane_b32 s21, v8, 16
    v_readlane_b32 s22, v8, 32
    v_readlane_b32 s23, v8, 48
    v_readlane_b32 s24, v9, 0
    v_readlane_b32 s25, v9, 16
    v_readlane_b32 s26, v9, 32
    v_readlane_b32 s27, v9, 48
    s_nop 1
    v_mov_b32 v8, s20
    v_add_f32 v8, s21, v8
    v_add_f32 v8, s22, v8
    v_add_f32 v8, s23, v8
    v_mov_b32 v9, s24
    v_add_f32 v9, s25, v9
    v_add_f32 v9, s26, v9
    v_add_f32 v9, s27, v9
    v_pk_mul_f32 v[8:9], v[8:9], v[30:31] op_sel:[0,0] op_sel_hi:[1,0]
    v_cvt_pk_bf16_f32 v28, v2, v3
    v_lshlrev_b32 v2, 16, v28
    v_and_b32 v3, 0xffff0000, v28
    v_cvt_pk_bf16_f32 v28, v8, v9
    v_lshlrev_b32 v8, 16, v28
    v_and_b32 v9, 0xffff0000, v28
    v_add_f32 v8, 0x3727c5ac, v8
    v_add_f32 v9, 0x3727c5ac, v9
    v_cvt_pk_bf16_f32 v28, v8, v9
    v_lshlrev_b32 v8, 16, v28
    v_and_b32 v9, 0xffff0000, v28
    v_sqrt_f32 v8, v8
    v_sqrt_f32 v9, v9
    s_nop 0
    v_cvt_pk_bf16_f32 v28, v8, v9
    v_lshlrev_b32 v8, 16, v28
    v_and_b32 v9, 0xffff0000, v28
    v_rcp_f32 v30, v8
    v_rcp_f32 v31, v9
    s_nop 0
    v_pk_add_f32 v[26:27], v[4:5], v[2:3] neg_lo:[0,1] neg_hi:[0,1]
    v_cvt_pk_bf16_f32 v28, v26, v27
    v_lshlrev_b32 v26, 16, v28
    v_and_b32 v27, 0xffff0000, v28
    v_pk_mul_f32 v[32:33], v[26:27], v[30:31]
    v_pk_fma_f32 v[34:35], v[32:33], v[8:9], v[26:27] neg_lo:[1,0,0] neg_hi:[1,0,0]
    v_pk_fma_f32 v[32:33], v[34:35], v[30:31], v[32:33]
    v_cvt_pk_bf16_f32 v28, v32, v33
    v_lshlrev_b32 v4, 16, v28
    v_and_b32 v5, 0xffff0000, v28
    v_pk_add_f32 v[26:27], v[14:15], v[2:3] neg_lo:[0,1] neg_hi:[0,1]
    v_cvt_pk_bf16_f32 v28, v26, v27
    v_lshlrev_b32 v26, 16, v28
    v_and_b32 v27, 0xffff0000, v28
    v_pk_mul_f32 v[32:33], v[26:27], v[30:31]
    v_pk_fma_f32 v[34:35], v[32:33], v[8:9], v[26:27] neg_lo:[1,0,0] neg_hi:[1,0,0]
    v_pk_fma_f32 v[32:33], v[34:35], v[30:31], v[32:33]
    v_cvt_pk_bf16_f32 v28, v32, v33
    v_lshlrev_b32 v14, 16, v28
    v_and_b32 v15, 0xffff0000, v28
    v_pk_add_f32 v[26:27], v[16:17], v[2:3] neg_lo:[0,1] neg_hi:[0,1]
    v_cvt_pk_bf16_f32 v28, v26, v27
    v_lshlrev_b32 v26, 16, v28
    v_and_b32 v27, 0xffff0000, v28
    v_pk_mul_f32 v[32:33], v[26:27], v[30:31]
    v_pk_fma_f32 v[34:35], v[32:33], v[8:9], v[26:27] neg_lo:[1,0,0] neg_hi:[1,0,0]
    v_pk_fma_f32 v[32:33], v[34:35], v[30:31], v[32:33]
    v_cvt_pk_bf16_f32 v28, v32, v33
    v_lshlrev_b32 v16, 16, v28
    v_and_b32 v17, 0xffff0000, v28
    v_pk_add_f32 v[26:27], v[24:25], v[2:3] neg_lo:[0,1] neg_hi:[0,1]
    v_cvt_pk_bf16_f32 v28, v26, v27
    v_lshlrev_b32 v26, 16, v28
    v_and_b32 v27, 0xffff0000, v28
    v_pk_mul_f32 v[32:33], v[26:27], v[30:31]
    v_pk_fma_f32 v[34:35], v[32:33], v[8:9], v[26:27] neg_lo:[1,0,0] neg_hi:[1,0,0]
    v_pk_fma_f32 v[32:33], v[34:35], v[30:31], v[32:33]
    v_cvt_pk_bf16_f32 v28, v32, v33
    v_lshlrev_b32 v24, 16, v28
    v_and_b32 v25, 0xffff0000, v28
    v_pk_add_f32 v[26:27], v[20:21], v[2:3] neg_lo:[0,1] neg_hi:[0,1]
    v_cvt_pk_bf16_f32 v28, v26, v27
    v_lshlrev_b32 v26, 16, v28
    v_and_b32 v27, 0xffff0000, v28
    v_pk_mul_f32 v[32:33], v[26:27], v[30:31]
    v_pk_fma_f32 v[34:35], v[32:33], v[8:9], v[26:27] neg_lo:[1,0,0] neg_hi:[1,0,0]
    v_pk_fma_f32 v[32:33], v[34:35], v[30:31], v[32:33]
    v_cvt_pk_bf16_f32 v28, v32, v33
    v_lshlrev_b32 v20, 16, v28
    v_and_b32 v21, 0xffff0000, v28
    v_pk_add_f32 v[26:27], v[22:23], v[2:3] neg_lo:[0,1] neg_hi:[0,1]
    v_cvt_pk_bf16_f32 v28, v26, v27
    v_lshlrev_b32 v26, 16, v28
    v_and_b32 v27, 0xffff0000, v28
    v_pk_mul_f32 v[32:33], v[26:27], v[30:31]
    v_pk_fma_f32 v[34:35], v[32:33], v[8:9], v[26:27] neg_lo:[1,0,0] neg_hi:[1,0,0]
    v_pk_fma_f32 v[32:33], v[34:35], v[30:31], v[32:33]
    v_cvt_pk_bf16_f32 v28, v32, v33
    v_lshlrev_b32 v22, 16, v28
    v_and_b32 v23, 0xffff0000, v28
    v_pk_add_f32 v[26:27], v[12:13], v[2:3] neg_lo:[0,1] neg_hi:[0,1]
    v_cvt_pk_bf16_f32 v28, v26, v27
    v_lshlrev_b32 v26, 16, v28
    v_and_b32 v27, 0xffff0000, v28
    v_pk_mul_f32 v[32:33], v[26:27], v[30:31]
    v_pk_fma_f32 v[34:35], v[32:33], v[8:9], v[26:27] neg_lo:[1,0,0] neg_hi:[1,0,0]
    v_pk_fma_f32 v[32:33], v[34:35], v[30:31], v[32:33]
    v_cvt_pk_bf16_f32 v28, v32, v33
    v_lshlrev_b32 v12, 16, v28
    v_and_b32 v13, 0xffff0000, v28
    v_pk_add_f32 v[26:27], v[18:19], v[2:3] neg_lo:[0,1] neg_hi:[0,1]
    v_cvt_pk_bf16_f32 v28, v26, v27
    v_lshlrev_b32 v26, 16, v28
    v_and_b32 v27, 0xffff0000, v28
    v_pk_mul_f32 v[32:33], v[26:27], v[30:31]
    v_pk_fma_f32 v[34:35], v[32:33], v[8:9], v[26:27] neg_lo:[1,0,0] neg_hi:[1,0,0]
    v_pk_fma_f32 v[32:33], v[34:35], v[30:31], v[32:33]
    v_cvt_pk_bf16_f32 v28, v32, v33
    v_lshlrev_b32 v18, 16, v28
    v_and_b32 v19, 0xffff0000, v28
    v_pk_add_f32 v[26:27], v[6:7], v[2:3] neg_lo:[0,1] neg_hi:[0,1]
    v_cvt_pk_bf16_f32 v28, v26, v27
    v_lshlrev_b32 v26, 16, v28
    v_and_b32 v27, 0xffff0000, v28
    v_pk_mul_f32 v[32:33], v[26:27], v[30:31]
    v_pk_fma_f32 v[34:35], v[32:33], v[8:9], v[26:27] neg_lo:[1,0,0] neg_hi:[1,0,0]
    v_pk_fma_f32 v[32:33], v[34:35], v[30:31], v[32:33]
    v_cvt_pk_bf16_f32 v28, v32, v33
    v_lshlrev_b32 v6, 16, v28
    v_and_b32 v7, 0xffff0000, v28
    v_pk_add_f32 v[26:27], v[10:11], v[2:3] neg_lo:[0,1] neg_hi:[0,1]
    v_cvt_pk_bf16_f32 v28, v26, v27
    v_lshlrev_b32 v26, 16, v28
    v_and_b32 v27, 0xffff0000, v28
    v_pk_mul_f32 v[32:33], v[26:27], v[30:31]
    v_pk_fma_f32 v[34:35], v[32:33], v[8:9], v[26:27] neg_lo:[1,0,0] neg_hi:[1,0,0]
    v_pk_fma_f32 v[32:33], v[34:35], v[30:31], v[32:33]
    v_cvt_pk_bf16_f32 v28, v32, v33
    v_lshlrev_b32 v10, 16, v28
    v_and_b32 v11, 0xffff0000, v28
    v_mov_b32 v30, 0x3acccccd
    v_mov_b32 v31, 0x3acccccd
    v_pk_add_f32 v[2:3], v[4:5], v[14:15]
    v_pk_add_f32 v[2:3], v[2:3], v[16:17]
    v_pk_add_f32 v[2:3], v[2:3], v[24:25]
    v_pk_add_f32 v[2:3], v[2:3], v[20:21]
    v_pk_add_f32 v[2:3], v[2:3], v[22:23]
    v_pk_add_f32 v[2:3], v[2:3], v[12:13]
    v_pk_add_f32 v[2:3], v[2:3], v[18:19]
    v_pk_add_f32 v[2:3], v[2:3], v[6:7]
    v_pk_add_f32 v[2:3], v[2:3], v[10:11]
    s_nop 1
    v_add_f32_dpp v2, v2, v2 quad_perm:[1,0,3,2] row_mask:0xf bank_mask:0xf
    v_add_f32_dpp v3, v3, v3 quad_perm:[1,0,3,2] row_mask:0xf bank_mask:0xf
    s_nop 1
    v_add_f32_dpp v2, v2, v2 quad_perm:[2,3,0,1] row_mask:0xf bank_mask:0xf
    v_add_f32_dpp v3, v3, v3 quad_perm:[2,3,0,1] row_mask:0xf bank_mask:0xf
    s_nop 1
    v_add_f32_dpp v2, v2, v2 row_half_mirror row_mask:0xf bank_mask:0xf
    v_add_f32_dpp v3, v3, v3 row_half_mirror row_mask:0xf bank_mask:0xf
    s_nop 1
    v_add_f32_dpp v2, v2, v2 row_mirror row_mask:0xf bank_mask:0xf
    v_add_f32_dpp v3, v3, v3 row_mirror row_mask:0xf bank_mask:0xf
    s_nop 1
    v_readlane_b32 s20, v2, 0
    v_readlane_b32 s21, v2, 16
    v_readlane_b32 s22, v2, 32
    v_readlane_b32 s23, v2, 48
    v_readlane_b32 s24, v3, 0
    v_readlane_b32 s25, v3, 16
    v_readlane_b32 s26, v3, 32
    v_readlane_b32 s27, v3, 48
    s_nop 1
    v_mov_b32 v2, s20
    v_add_f32 v2, s21, v2
    v_add_f32 v2, s22, v2
    v_add_f32 v2, s23, v2
    v_mov_b32 v3, s24
    v_add_f32 v3, s25, v3
    v_add_f32 v3, s26, v3
    v_add_f32 v3, s27, v3
    v_pk_mul_f32 v[2:3], v[2:3], v[30:31] op_sel:[0,0] op_sel_hi:[1,0]
    v_pk_add_f32 v[26:27], v[4:5], v[2:3] neg_lo:[0,1] neg_hi:[0,1]
    v_pk_mul_f32 v[8:9], v[26:27], v[26:27]
    v_pk_add_f32 v[26:27], v[14:15], v[2:3] neg_lo:[0,1] neg_hi:[0,1]
    v_pk_fma_f32 v[8:9], v[26:27], v[26:27], v[8:9]
    v_pk_add_f32 v[26:27], v[16:17], v[2:3] neg_lo:[0,1] neg_hi:[0,1]
    v_pk_fma_f32 v[8:9], v[26:27], v[26:27], v[8:9]
    v_pk_add_f32 v[26:27], v[24:25], v[2:3] neg_lo:[0,1] neg_hi:[0,1]
    v_pk_fma_f32 v[8:9], v[26:27], v[26:27], v[8:9]
    v_pk_add_f32 v[26:27], v[20:21], v[2:3] neg_lo:[0,1] neg_hi:[0,1]
    v_pk_fma_f32 v[8:9], v[26:27], v[26:27], v[8:9]
    v_pk_add_f32 v[26:27], v[22:23], v[2:3] neg_lo:[0,1] neg_hi:[0,1]
    v_pk_fma_f32 v[8:9], v[26:27], v[26:27], v[8:9]
    v_pk_add_f32 v[26:27], v[12:13], v[2:3] neg_lo:[0,1] neg_hi:[0,1]
    v_pk_fma_f32 v[8:9], v[26:27], v[26:27], v[8:9]
    v_pk_add_f32 v[26:27], v[18:19], v[2:3] neg_lo:[0,1] neg_hi:[0,1]
    v_pk_fma_f32 v[8:9], v[26:27], v[26:27], v[8:9]
    v_pk_add_f32 v[26:27], v[6:7], v[2:3] neg_lo:[0,1] neg_hi:[0,1]
    v_pk_fma_f32 v[8:9], v[26:27], v[26:27], v[8:9]
    v_pk_add_f32 v[26:27], v[10:11], v[2:3] neg_lo:[0,1] neg_hi:[0,1]
    v_pk_fma_f32 v[8:9], v[26:27], v[26:27], v[8:9]
    s_nop 1
    v_add_f32_dpp v8, v8, v8 quad_perm:[1,0,3,2] row_mask:0xf bank_mask:0xf
    v_add_f32_dpp v9, v9, v9 quad_perm:[1,0,3,2] row_mask:0xf bank_mask:0xf
    s_nop 1
    v_add_f32_dpp v8, v8, v8 quad_perm:[2,3,0,1] row_mask:0xf bank_mask:0xf
    v_add_f32_dpp v9, v9, v9 quad_perm:[2,3,0,1] row_mask:0xf bank_mask:0xf
    s_nop 1
    v_add_f32_dpp v8, v8, v8 row_half_mirror row_mask:0xf bank_mask:0xf
    v_add_f32_dpp v9, v9, v9 row_half_mirror row_mask:0xf bank_mask:0xf
    s_nop 1
    v_add_f32_dpp v8, v8, v8 row_mirror row_mask:0xf bank_mask:0xf
    v_add_f32_dpp v9, v9, v9 row_mirror row_mask:0xf bank_mask:0xf
    s_nop 1
    v_readlane_b32 s20, v8, 0
    v_readlane_b32 s21, v8, 16
    v_readlane_b32 s22, v8, 32
    v_readlane_b32 s23, v8, 48
    v_readlane_b32 s24, v9, 0
    v_readlane_b32 s25, v9, 16
    v_readlane_b32 s26, v9, 32
    v_readlane_b32 s27, v9, 48
    s_nop 1
    v_mov_b32 v8, s20
    v_add_f32 v8, s21, v8
    v_add_f32 v8, s22, v8
    v_add_f32 v8, s23, v8
    v_mov_b32 v9, s24
    v_add_f32 v9, s25, v9
    v_add_f32 v9, s26, v9
    v_add_f32 v9, s27, v9
    v_pk_mul_f32 v[8:9], v[8:9], v[30:31] op_sel:[0,0] op_sel_hi:[1,0]
    v_cvt_pk_bf16_f32 v28, v2, v3
    v_lshlrev_b32 v2, 16, v28
    v_and_b32 v3, 0xffff0000, v28
    v_cvt_pk_bf16_f32 v28, v8, v9
    v_lshlrev_b32 v8, 16, v28
    v_and_b32 v9, 0xffff0000, v28
    v_add_f32 v8, 0x3727c5ac, v8
    v_add_f32 v9, 0x3727c5ac, v9
    v_cvt_pk_bf16_f32 v28, v8, v9
    v_lshlrev_b32 v8, 16, v28
    v_and_b32 v9, 0xffff0000, v28
    v_sqrt_f32 v8, v8
    v_sqrt_f32 v9, v9
    s_nop 0
    v_cvt_pk_bf16_f32 v28, v8, v9
    v_lshlrev_b32 v8, 16, v28
    v_and_b32 v9, 0xffff0000, v28
    v_rcp_f32 v30, v8
    v_rcp_f32 v31, v9
    s_nop 0
    v_pk_add_f32 v[26:27], v[4:5], v[2:3] neg_lo:[0,1] neg_hi:[0,1]
    v_cvt_pk_bf16_f32 v28, v26, v27
    v_lshlrev_b32 v26, 16, v28
    v_and_b32 v27, 0xffff0000, v28
    v_pk_mul_f32 v[32:33], v[26:27], v[30:31]
    v_pk_fma_f32 v[34:35], v[32:33], v[8:9], v[26:27] neg_lo:[1,0,0] neg_hi:[1,0,0]
    v_pk_fma_f32 v[32:33], v[34:35], v[30:31], v[32:33]
    v_cvt_pk_bf16_f32 v28, v32, v33
    v_lshlrev_b32 v4, 16, v28
    v_and_b32 v5, 0xffff0000, v28
    v_pk_add_f32 v[26:27], v[14:15], v[2:3] neg_lo:[0,1] neg_hi:[0,1]
    v_cvt_pk_bf16_f32 v28, v26, v27
    v_lshlrev_b32 v26, 16, v28
    v_and_b32 v27, 0xffff0000, v28
    v_pk_mul_f32 v[32:33], v[26:27], v[30:31]
    v_pk_fma_f32 v[34:35], v[32:33], v[8:9], v[26:27] neg_lo:[1,0,0] neg_hi:[1,0,0]
    v_pk_fma_f32 v[32:33], v[34:35], v[30:31], v[32:33]
    v_cvt_pk_bf16_f32 v28, v32, v33
    v_lshlrev_b32 v14, 16, v28
    v_and_b32 v15, 0xffff0000, v28
    v_pk_add_f32 v[26:27], v[16:17], v[2:3] neg_lo:[0,1] neg_hi:[0,1]
    v_cvt_pk_bf16_f32 v28, v26, v27
    v_lshlrev_b32 v26, 16, v28
    v_and_b32 v27, 0xffff0000, v28
    v_pk_mul_f32 v[32:33], v[26:27], v[30:31]
    v_pk_fma_f32 v[34:35], v[32:33], v[8:9], v[26:27] neg_lo:[1,0,0] neg_hi:[1,0,0]
    v_pk_fma_f32 v[32:33], v[34:35], v[30:31], v[32:33]
    v_cvt_pk_bf16_f32 v28, v32, v33
    v_lshlrev_b32 v16, 16, v28
    v_and_b32 v17, 0xffff0000, v28
    v_pk_add_f32 v[26:27], v[24:25], v[2:3] neg_lo:[0,1] neg_hi:[0,1]
    v_cvt_pk_bf16_f32 v28, v26, v27
    v_lshlrev_b32 v26, 16, v28
    v_and_b32 v27, 0xffff0000, v28
    v_pk_mul_f32 v[32:33], v[26:27], v[30:31]
    v_pk_fma_f32 v[34:35], v[32:33], v[8:9], v[26:27] neg_lo:[1,0,0] neg_hi:[1,0,0]
    v_pk_fma_f32 v[32:33], v[34:35], v[30:31], v[32:33]
    v_cvt_pk_bf16_f32 v28, v32, v33
    v_lshlrev_b32 v24, 16, v28
    v_and_b32 v25, 0xffff0000, v28
    v_pk_add_f32 v[26:27], v[20:21], v[2:3] neg_lo:[0,1] neg_hi:[0,1]
    v_cvt_pk_bf16_f32 v28, v26, v27
    v_lshlrev_b32 v26, 16, v28
    v_and_b32 v27, 0xffff0000, v28
    v_pk_mul_f32 v[32:33], v[26:27], v[30:31]
    v_pk_fma_f32 v[34:35], v[32:33], v[8:9], v[26:27] neg_lo:[1,0,0] neg_hi:[1,0,0]
    v_pk_fma_f32 v[32:33], v[34:35], v[30:31], v[32:33]
    v_cvt_pk_bf16_f32 v28, v32, v33
    v_lshlrev_b32 v20, 16, v28
    v_and_b32 v21, 0xffff0000, v28
    v_pk_add_f32 v[26:27], v[22:23], v[2:3] neg_lo:[0,1] neg_hi:[0,1]
    v_cvt_pk_bf16_f32 v28, v26, v27
    v_lshlrev_b32 v26, 16, v28
    v_and_b32 v27, 0xffff0000, v28
    v_pk_mul_f32 v[32:33], v[26:27], v[30:31]
    v_pk_fma_f32 v[34:35], v[32:33], v[8:9], v[26:27] neg_lo:[1,0,0] neg_hi:[1,0,0]
    v_pk_fma_f32 v[32:33], v[34:35], v[30:31], v[32:33]
    v_cvt_pk_bf16_f32 v28, v32, v33
    v_lshlrev_b32 v22, 16, v28
    v_and_b32 v23, 0xffff0000, v28
    v_pk_add_f32 v[26:27], v[12:13], v[2:3] neg_lo:[0,1] neg_hi:[0,1]
    v_cvt_pk_bf16_f32 v28, v26, v27
    v_lshlrev_b32 v26, 16, v28
    v_and_b32 v27, 0xffff0000, v28
    v_pk_mul_f32 v[32:33], v[26:27], v[30:31]
    v_pk_fma_f32 v[34:35], v[32:33], v[8:9], v[26:27] neg_lo:[1,0,0] neg_hi:[1,0,0]
    v_pk_fma_f32 v[32:33], v[34:35], v[30:31], v[32:33]
    v_cvt_pk_bf16_f32 v28, v32, v33
    v_lshlrev_b32 v12, 16, v28
    v_and_b32 v13, 0xffff0000, v28
    v_pk_add_f32 v[26:27], v[18:19], v[2:3] neg_lo:[0,1] neg_hi:[0,1]
    v_cvt_pk_bf16_f32 v28, v26, v27
    v_lshlrev_b32 v26, 16, v28
    v_and_b32 v27, 0xffff0000, v28
    v_pk_mul_f32 v[32:33], v[26:27], v[30:31]
    v_pk_fma_f32 v[34:35], v[32:33], v[8:9], v[26:27] neg_lo:[1,0,0] neg_hi:[1,0,0]
    v_pk_fma_f32 v[32:33], v[34:35], v[30:31], v[32:33]
    v_cvt_pk_bf16_f32 v28, v32, v33
    v_lshlrev_b32 v18, 16, v28
    v_and_b32 v19, 0xffff0000, v28
    v_pk_add_f32 v[26:27], v[6:7], v[2:3] neg_lo:[0,1] neg_hi:[0,1]
    v_cvt_pk_bf16_f32 v28, v26, v27
    v_lshlrev_b32 v26, 16, v28
    v_and_b32 v27, 0xffff0000, v28
    v_pk_mul_f32 v[32:33], v[26:27], v[30:31]
    v_pk_fma_f32 v[34:35], v[32:33], v[8:9], v[26:27] neg_lo:[1,0,0] neg_hi:[1,0,0]
    v_pk_fma_f32 v[32:33], v[34:35], v[30:31], v[32:33]
    v_cvt_pk_bf16_f32 v28, v32, v33
    v_lshlrev_b32 v6, 16, v28
    v_and_b32 v7, 0xffff0000, v28
    v_pk_add_f32 v[26:27], v[10:11], v[2:3] neg_lo:[0,1] neg_hi:[0,1]
    v_cvt_pk_bf16_f32 v28, v26, v27
    v_lshlrev_b32 v26, 16, v28
    v_and_b32 v27, 0xffff0000, v28
    v_pk_mul_f32 v[32:33], v[26:27], v[30:31]
    v_pk_fma_f32 v[34:35], v[32:33], v[8:9], v[26:27] neg_lo:[1,0,0] neg_hi:[1,0,0]
    v_pk_fma_f32 v[32:33], v[34:35], v[30:31], v[32:33]
    v_cvt_pk_bf16_f32 v28, v32, v33
    v_lshlrev_b32 v10, 16, v28
    v_and_b32 v11, 0xffff0000, v28
    buffer_store_short_d16_hi v4, v1, s[32:35], s17 offen offset:0
    buffer_store_short_d16_hi v5, v1, s[32:35], s17 offen offset:1280
    buffer_store_short_d16_hi v14, v1, s[32:35], s17 offen offset:128
    buffer_store_short_d16_hi v15, v1, s[32:35], s17 offen offset:1408
    buffer_store_short_d16_hi v16, v1, s[32:35], s17 offen offset:256
    buffer_store_short_d16_hi v17, v1, s[32:35], s17 offen offset:1536
    buffer_store_short_d16_hi v24, v1, s[32:35], s17 offen offset:384
    buffer_store_short_d16_hi v25, v1, s[32:35], s17 offen offset:1664
    buffer_store_short_d16_hi v20, v1, s[32:35], s17 offen offset:512
    buffer_store_short_d16_hi v21, v1, s[32:35], s17 offen offset:1792
    buffer_store_short_d16_hi v22, v1, s[32:35], s17 offen offset:640
    buffer_store_short_d16_hi v23, v1, s[32:35], s17 offen offset:1920
    buffer_store_short_d16_hi v12, v1, s[32:35], s17 offen offset:768
    buffer_store_short_d16_hi v13, v1, s[32:35], s17 offen offset:2048
    buffer_store_short_d16_hi v18, v1, s[32:35], s17 offen offset:896
    buffer_store_short_d16_hi v19, v1, s[32:35], s17 offen offset:2176
    buffer_store_short_d16_hi v6, v1, s[32:35], s17 offen offset:1024
    buffer_store_short_d16_hi v7, v1, s[32:35], s17 offen offset:2304
    buffer_store_short_d16_hi v10, v1, s[32:35], s17 offen offset:1152
    buffer_store_short_d16_hi v11, v1, s[32:35], s17 offen offset:2432
    s_waitcnt vmcnt(0)
    s_endpgm
k3_tr:
    s_load_dwordx2 s[8:9], s[0:1], 32
    s_load_dwordx2 s[10:11], s[0:1], 48
    s_sub_u32 s16, s2, 256
    s_lshl_b32 s16, s16, 2
    s_add_u32 s16, s16, s3
    s_waitcnt lgkmcnt(0)
    s_cmp_ge_u32 s16, 560
    s_cbranch_scc1 k3_w2set
    s_mov_b32 s12, s8
    s_mov_b32 s13, s9
    s_mov_b32 s14, 0x21c000
    s_mov_b32 s15, 0x00020000
    s_add_u32 s24, s4, 0x2000000
    s_addc_u32 s25, s5, 0
    s_mov_b32 s26, 0x21c000
    s_mov_b32 s27, 0x00020000
    s_mul_hi_u32 s17, s16, 0x6666667
    s_mul_i32 s18, s17, 40
    s_sub_u32 s18, s16, s18
    s_mov_b32 s19, 3456
    s_mov_b32 s20, 1280
    s_mov_b32 s21, 1728
    s_branch k3_trc
k3_w2set:
    s_sub_u32 s16, s16, 560
    s_mov_b32 s12, s10
    s_mov_b32 s13, s11
    s_mov_b32 s14, 0x21c000
    s_mov_b32 s15, 0x00020000
    s_add_u32 s24, s4, 0x2400000
    s_addc_u32 s25, s5, 0
    s_mov_b32 s26, 0x21c000
    s_mov_b32 s27, 0x00020000
    s_mul_hi_u32 s17, s16, 0x25ed098
    s_mul_i32 s18, s17, 108
    s_sub_u32 s18, s16, s18
    s_mov_b32 s19, 1280
    s_mov_b32 s20, 3456
    s_mov_b32 s21, 640
k3_trc:
    s_lshl_b32 s22, s17, 7
    v_lshl_add_u32 v2, v0, 1, s22
    v_cmp_gt_u32 vcc, s21, v2
    s_and_saveexec_b64 s[28:29], vcc
    s_cbranch_execz k3_end
    v_lshlrev_b32 v3, 1, v2
    v_mul_lo_u32 v8, v2, s20
    s_lshl_b32 s23, s18, 4
    s_mul_i32 s23, s23, s19
    buffer_load_dword v9, v3, s[12:15], s23 offen
    s_add_u32 s23, s23, s19
    buffer_load_dword v26, v3, s[12:15], s23 offen
    s_add_u32 s23, s23, s19
    buffer_load_dword v27, v3, s[12:15], s23 offen
    s_add_u32 s23, s23, s19
    buffer_load_dword v28, v3, s[12:15], s23 offen
    s_add_u32 s23, s23, s19
    buffer_load_dword v29, v3, s[12:15], s23 offen
    s_add_u32 s23, s23, s19
    buffer_load_dword v30, v3, s[12:15], s23 offen
    s_add_u32 s23, s23, s19
    buffer_load_dword v31, v3, s[12:15], s23 offen
    s_add_u32 s23, s23, s19
    buffer_load_dword v32, v3, s[12:15], s23 offen
    s_add_u32 s23, s23, s19
    buffer_load_dword v33, v3, s[12:15], s23 offen
    s_add_u32 s23, s23, s19
    buffer_load_dword v34, v3, s[12:15], s23 offen
    s_add_u32 s23, s23, s19
    buffer_load_dword v35, v3, s[12:15], s23 offen
    s_add_u32 s23, s23, s19
    buffer_load_dword v36, v3, s[12:15], s23 offen
    s_add_u32 s23, s23, s19
    buffer_load_dword v37, v3, s[12:15], s23 offen
    s_add_u32 s23, s23, s19
    buffer_load_dword v38, v3, s[12:15], s23 offen
    s_add_u32 s23, s23, s19
    buffer_load_dword v39, v3, s[12:15], s23 offen
    s_add_u32 s23, s23, s19
    buffer_load_dword v40, v3, s[12:15], s23 offen
    s_add_u32 s23, s23, s19
    s_mov_b32 s30, 0x05040100
    s_mov_b32 s31, 0x07060302
    s_waitcnt vmcnt(0)
    v_perm_b32 v52, v26, v9, s30
    v_perm_b32 v60, v26, v9, s31
    v_perm_b32 v53, v28, v27, s30
    v_perm_b32 v61, v28, v27, s31
    v_perm_b32 v54, v30, v29, s30
    v_perm_b32 v62, v30, v29, s31
    v_perm_b32 v55, v32, v31, s30
    v_perm_b32 v63, v32, v31, s31
    v_perm_b32 v56, v34, v33, s30
    v_perm_b32 v64, v34, v33, s31
    v_perm_b32 v57, v36, v35, s30
    v_perm_b32 v65, v36, v35, s31
    v_perm_b32 v58, v38, v37, s30
    v_perm_b32 v66, v38, v37, s31
    v_perm_b32 v59, v40, v39, s30
    v_perm_b32 v67, v40, v39, s31
    s_lshl_b32 s23, s18, 5
    s_add_u32 s32, s23, s20
    buffer_store_dwordx4 v[52:55], v8, s[24:27], s23 offen offset:0
    buffer_store_dwordx4 v[60:63], v8, s[24:27], s32 offen offset:0
    buffer_store_dwordx4 v[56:59], v8, s[24:27], s23 offen offset:16
    buffer_store_dwordx4 v[64:67], v8, s[24:27], s32 offen offset:16
k3_end:
    s_endpgm
.globl k4_kernel
.p2align 8
.type k4_kernel,@function
k4_kernel:
    s_load_dwordx2 s[4:5], s[0:1], 80
    s_load_dwordx2 s[6:7], s[0:1], 40
    s_cmp_ge_u32 s2, 256
    s_cbranch_scc1 k4_end
    v_lshrrev_b32 v1, 6, v0
    v_and_b32 v2, 63, v0
    v_readfirstlane_b32 s3, v1
    s_lshr_b32 s70, s3, 2
    s_and_b32 s3, s3, 3
    s_waitcnt lgkmcnt(0)
    s_add_u32 s8, s4, 0x1400000
    s_addc_u32 s9, s5, 0
    s_mov_b32 s10, 0x280000
    s_mov_b32 s11, 0x00020000
    s_add_u32 s12, s4, 0x2000000
    s_addc_u32 s13, s5, 0
    s_mov_b32 s14, 0x21c000
    s_mov_b32 s15, 0x00020000
    s_add_u32 s20, s4, 0x1800000
    s_addc_u32 s21, s5, 0
    s_mov_b32 s22, 0x6c0000
    s_mov_b32 s23, 0x00020000
    s_mov_b32 s16, s6
    s_mov_b32 s17, s7
    s_mov_b32 s18, 0xd80
    s_mov_b32 s19, 0x00020000
    s_and_b32 s33, s2, 7
    s_lshr_b32 s34, s2, 3
    s_and_b32 s29, s33, 3
    s_lshl_b32 s29, s29, 2
    s_and_b32 s30, s34, 3
    s_add_u32 s29, s29, s30
    s_lshr_b32 s30, s33, 2
    s_mul_i32 s30, s30, 8
    s_lshr_b32 s34, s34, 2
    s_add_u32 s30, s30, s34
    s_mul_i32 s31, s29, 128
    s_mul_i32 s32, s30, 112
    v_lshrrev_b32 v3, 3, v2
    v_lshrrev_b32 v5, 4, v2
    s_and_b32 s33, s3, 1
    s_lshl_b32 s33, s33, 2
    v_add_u32 v5, s33, v5
    v_and_b32 v4, 7, v2
    v_xor_b32 v4, v4, v5
    s_lshl_b32 s33, s3, 3
    s_add_u32 s34, s33, s31
    v_add_u32 v6, s34, v3
    v_mul_u32_u24 v6, 1280, v6
    v_lshl_add_u32 v6, v4, 4, v6
    s_add_u32 s34, s33, s32
    v_add_u32 v7, s34, v3
    v_mul_u32_u24 v7, 1280, v7
    v_lshl_add_u32 v7, v4, 4, v7
    s_lshl_b32 s35, s3, 10
    s_cmp_eq_u32 s70, 0
    s_cbranch_scc1 k4_cons
    s_cmp_ge_u32 s3, 2
    s_cbranch_scc1 k4_ld2
    s_add_u32 m0, s35, 0
    s_mov_b32 s40, 0
    buffer_load_dwordx4 v6, s[8:11], s40 offen lds
    s_add_u32 m0, s35, 4096
    s_mov_b32 s40, 40960
    buffer_load_dwordx4 v6, s[8:11], s40 offen lds
    s_add_u32 m0, s35, 8192
    s_mov_b32 s40, 81920
    buffer_load_dwordx4 v6, s[8:11], s40 offen lds
    s_add_u32 m0, s35, 12288
    s_mov_b32 s40, 122880
    buffer_load_dwordx4 v6, s[8:11], s40 offen lds
    s_add_u32 m0, s35, 16384
    s_mov_b32 s41, 0
    buffer_load_dwordx4 v7, s[12:15], s41 offen lds
    s_add_u32 m0, s35, 20480
    s_mov_b32 s41, 40960
    buffer_load_dwordx4 v7, s[12:15], s41 offen lds
    s_add_u32 m0, s35, 24576
    s_mov_b32 s41, 81920
    buffer_load_dwordx4 v7, s[12:15], s41 offen lds
    s_add_u32 m0, s35, 28672
    s_mov_b32 s41, 122880
    buffer_load_dwordx4 v7, s[12:15], s41 offen lds
    s_add_u32 m0, s35, 32768
    s_mov_b32 s40, 128
    buffer_load_dwordx4 v6, s[8:11], s40 offen lds
    s_add_u32 m0, s35, 36864
    s_mov_b32 s40, 41088
    buffer_load_dwordx4 v6, s[8:11], s40 offen lds
    s_add_u32 m0, s35, 40960
    s_mov_b32 s40, 82048
    buffer_load_dwordx4 v6, s[8:11], s40 offen lds
    s_add_u32 m0, s35, 45056
    s_mov_b32 s40, 123008
    buffer_load_dwordx4 v6, s[8:11], s40 offen lds
    s_add_u32 m0, s35, 49152
    s_mov_b32 s41, 128
    buffer_load_dwordx4 v7, s[12:15], s41 offen lds
    s_add_u32 m0, s35, 53248
    s_mov_b32 s41, 41088
    buffer_load_dwordx4 v7, s[12:15], s41 offen lds
    s_add_u32 m0, s35, 57344
    s_mov_b32 s41, 82048
    buffer_load_dwordx4 v7, s[12:15], s41 offen lds
    s_add_u32 m0, s35, 61440
    s_mov_b32 s41, 123008
    buffer_load_dwordx4 v7, s[12:15], s41 offen lds
    s_waitcnt vmcnt(8)
    s_barrier
    s_waitcnt vmcnt(0)
    s_barrier
    s_add_u32 m0, s35, 65536
    s_mov_b32 s40, 256
    buffer_load_dwordx4 v6, s[8:11], s40 offen lds
    s_add_u32 m0, s35, 69632
    s_mov_b32 s40, 41216
    buffer_load_dwordx4 v6, s[8:11], s40 offen lds
    s_add_u32 m0, s35, 73728
    s_mov_b32 s40, 82176
    buffer_load_dwordx4 v6, s[8:11], s40 offen lds
    s_add_u32 m0, s35, 77824
    s_mov_b32 s40, 123136
    buffer_load_dwordx4 v6, s[8:11], s40 offen lds
    s_add_u32 m0, s35, 81920
    s_mov_b32 s41, 256
    buffer_load_dwordx4 v7, s[12:15], s41 offen lds
    s_add_u32 m0, s35, 86016
    s_mov_b32 s41, 41216
    buffer_load_dwordx4 v7, s[12:15], s41 offen lds
    s_add_u32 m0, s35, 90112
    s_mov_b32 s41, 82176
    buffer_load_dwordx4 v7, s[12:15], s41 offen lds
    s_add_u32 m0, s35, 94208
    s_mov_b32 s41, 123136
    buffer_load_dwordx4 v7, s[12:15], s41 offen lds
    s_add_u32 m0, s35, 98304
    s_mov_b32 s40, 384
    buffer_load_dwordx4 v6, s[8:11], s40 offen lds
    s_add_u32 m0, s35, 102400
    s_mov_b32 s40, 41344
    buffer_load_dwordx4 v6, s[8:11], s40 offen lds
    s_add_u32 m0, s35, 106496
    s_mov_b32 s40, 82304
    buffer_load_dwordx4 v6, s[8:11], s40 offen lds
    s_add_u32 m0, s35, 110592
    s_mov_b32 s40, 123264
    buffer_load_dwordx4 v6, s[8:11], s40 offen lds
    s_add_u32 m0, s35, 114688
    s_mov_b32 s41, 384
    buffer_load_dwordx4 v7, s[12:15], s41 offen lds
    s_add_u32 m0, s35, 118784
    s_mov_b32 s41, 41344
    buffer_load_dwordx4 v7, s[12:15], s41 offen lds
    s_add_u32 m0, s35, 122880
    s_mov_b32 s41, 82304
    buffer_load_dwordx4 v7, s[12:15], s41 offen lds
    s_add_u32 m0, s35, 126976
    s_mov_b32 s41, 123264
    buffer_load_dwordx4 v7, s[12:15], s41 offen lds
    s_waitcnt vmcnt(8)
    s_barrier
    s_add_u32 m0, s35, 0
    s_mov_b32 s40, 512
    buffer_load_dwordx4 v6, s[8:11], s40 offen lds
    s_add_u32 m0, s35, 4096
    s_mov_b32 s40, 41472
    buffer_load_dwordx4 v6, s[8:11], s40 offen lds
    s_add_u32 m0, s35, 8192
    s_mov_b32 s40, 82432
    buffer_load_dwordx4 v6, s[8:11], s40 offen lds
    s_add_u32 m0, s35, 12288
    s_mov_b32 s40, 123392
    buffer_load_dwordx4 v6, s[8:11], s40 offen lds
    s_add_u32 m0, s35, 16384
    s_mov_b32 s41, 512
    buffer_load_dwordx4 v7, s[12:15], s41 offen lds
    s_add_u32 m0, s35, 20480
    s_mov_b32 s41, 41472
    buffer_load_dwordx4 v7, s[12:15], s41 offen lds
    s_add_u32 m0, s35, 24576
    s_mov_b32 s41, 82432
    buffer_load_dwordx4 v7, s[12:15], s41 offen lds
    s_add_u32 m0, s35, 28672
    s_mov_b32 s41, 123392
    buffer_load_dwordx4 v7, s[12:15], s41 offen lds
    s_waitcnt vmcnt(8)
    s_barrier
    s_add_u32 m0, s35, 32768
    s_mov_b32 s40, 640
    buffer_load_dwordx4 v6, s[8:11], s40 offen lds
    s_add_u32 m0, s35, 36864
    s_mov_b32 s40, 41600
    buffer_load_dwordx4 v6, s[8:11], s40 offen lds
    s_add_u32 m0, s35, 40960
    s_mov_b32 s40, 82560
    buffer_load_dwordx4 v6, s[8:11], s40 offen lds
    s_add_u32 m0, s35, 45056
    s_mov_b32 s40, 123520
    buffer_load_dwordx4 v6, s[8:11], s40 offen lds
    s_add_u32 m0, s35, 49152
    s_mov_b32 s41, 640
    buffer_load_dwordx4 v7, s[12:15], s41 offen lds
    s_add_u32 m0, s35, 53248
    s_mov_b32 s41, 41600
    buffer_load_dwordx4 v7, s[12:15], s41 offen lds
    s_add_u32 m0, s35, 57344
    s_mov_b32 s41, 82560
    buffer_load_dwordx4 v7, s[12:15], s41 offen lds
    s_add_u32 m0, s35, 61440
    s_mov_b32 s41, 123520
    buffer_load_dwordx4 v7, s[12:15], s41 offen lds
    s_waitcnt vmcnt(8)
    s_barrier
    s_add_u32 m0, s35, 65536
    s_mov_b32 s40, 768
    buffer_load_dwordx4 v6, s[8:11], s40 offen lds
    s_add_u32 m0, s35, 69632
    s_mov_b32 s40, 41728
    buffer_load_dwordx4 v6, s[8:11], s40 offen lds
    s_add_u32 m0, s35, 73728
    s_mov_b32 s40, 82688
    buffer_load_dwordx4 v6, s[8:11], s40 offen lds
    s_add_u32 m0, s35, 77824
    s_mov_b32 s40, 123648
    buffer_load_dwordx4 v6, s[8:11], s40 offen lds
    s_add_u32 m0, s35, 81920
    s_mov_b32 s41, 768
    buffer_load_dwordx4 v7, s[12:15], s41 offen lds
    s_add_u32 m0, s35, 86016
    s_mov_b32 s41, 41728
    buffer_load_dwordx4 v7, s[12:15], s41 offen lds
    s_add_u32 m0, s35, 90112
    s_mov_b32 s41, 82688
    buffer_load_dwordx4 v7, s[12:15], s41 offen lds
    s_add_u32 m0, s35, 94208
    s_mov_b32 s41, 123648
    buffer_load_dwordx4 v7, s[12:15], s41 offen lds
    s_waitcnt vmcnt(8)
    s_barrier
    s_add_u32 m0, s35, 98304
    s_mov_b32 s40, 896
    buffer_load_dwordx4 v6, s[8:11], s40 offen lds
    s_add_u32 m0, s35, 102400
    s_mov_b32 s40, 41856
    buffer_load_dwordx4 v6, s[8:11], s40 offen lds
    s_add_u32 m0, s35, 106496
    s_mov_b32 s40, 82816
    buffer_load_dwordx4 v6, s[8:11], s40 offen lds
    s_add_u32 m0, s35, 110592
    s_mov_b32 s40, 123776
    buffer_load_dwordx4 v6, s[8:11], s40 offen lds
    s_add_u32 m0, s35, 114688
    s_mov_b32 s41, 896
    buffer_load_dwordx4 v7, s[12:15], s41 offen lds
    s_add_u32 m0, s35, 118784
    s_mov_b32 s41, 41856
    buffer_load_dwordx4 v7, s[12:15], s41 offen lds
    s_add_u32 m0, s35, 122880
    s_mov_b32 s41, 82816
    buffer_load_dwordx4 v7, s[12:15], s41 offen lds
    s_add_u32 m0, s35, 126976
    s_mov_b32 s41, 123776
    buffer_load_dwordx4 v7, s[12:15], s41 offen lds
    s_waitcnt vmcnt(8)
    s_barrier
    s_add_u32 m0, s35, 0
    s_mov_b32 s40, 1024
    buffer_load_dwordx4 v6, s[8:11], s40 offen lds
    s_add_u32 m0, s35, 4096
    s_mov_b32 s40, 41984
    buffer_load_dwordx4 v6, s[8:11], s40 offen lds
    s_add_u32 m0, s35, 8192
    s_mov_b32 s40, 82944
    buffer_load_dwordx4 v6, s[8:11], s40 offen lds
    s_add_u32 m0, s35, 12288
    s_mov_b32 s40, 123904
    buffer_load_dwordx4 v6, s[8:11], s40 offen lds
    s_add_u32 m0, s35, 16384
    s_mov_b32 s41, 1024
    buffer_load_dwordx4 v7, s[12:15], s41 offen lds
    s_add_u32 m0, s35, 20480
    s_mov_b32 s41, 41984
    buffer_load_dwordx4 v7, s[12:15], s41 offen lds
    s_add_u32 m0, s35, 24576
    s_mov_b32 s41, 82944
    buffer_load_dwordx4 v7, s[12:15], s41 offen lds
    s_add_u32 m0, s35, 28672
    s_mov_b32 s41, 123904
    buffer_load_dwordx4 v7, s[12:15], s41 offen lds
    s_waitcnt vmcnt(8)
    s_barrier
    s_add_u32 m0, s35, 32768
    s_mov_b32 s40, 1152
    buffer_load_dwordx4 v6, s[8:11], s40 offen lds
    s_add_u32 m0, s35, 36864
    s_mov_b32 s40, 42112
    buffer_load_dwordx4 v6, s[8:11], s40 offen lds
    s_add_u32 m0, s35, 40960
    s_mov_b32 s40, 83072
    buffer_load_dwordx4 v6, s[8:11], s40 offen lds
    s_add_u32 m0, s35, 45056
    s_mov_b32 s40, 124032
    buffer_load_dwordx4 v6, s[8:11], s40 offen lds
    s_add_u32 m0, s35, 49152
    s_mov_b32 s41, 1152
    buffer_load_dwordx4 v7, s[12:15], s41 offen lds
    s_add_u32 m0, s35, 53248
    s_mov_b32 s41, 42112
    buffer_load_dwordx4 v7, s[12:15], s41 offen lds
    s_add_u32 m0, s35, 57344
    s_mov_b32 s41, 83072
    buffer_load_dwordx4 v7, s[12:15], s41 offen lds
    s_add_u32 m0, s35, 61440
    s_mov_b32 s41, 124032
    buffer_load_dwordx4 v7, s[12:15], s41 offen lds
    s_waitcnt vmcnt(8)
    s_barrier
    s_waitcnt vmcnt(0)
    s_barrier
    s_barrier
    s_endpgm
k4_ld2:
    s_add_u32 m0, s35, 0
    s_mov_b32 s40, 0
    buffer_load_dwordx4 v6, s[8:11], s40 offen lds
    s_add_u32 m0, s35, 4096
    s_mov_b32 s40, 40960
    buffer_load_dwordx4 v6, s[8:11], s40 offen lds
    s_add_u32 m0, s35, 8192
    s_mov_b32 s40, 81920
    buffer_load_dwordx4 v6, s[8:11], s40 offen lds
    s_add_u32 m0, s35, 12288
    s_mov_b32 s40, 122880
    buffer_load_dwordx4 v6, s[8:11], s40 offen lds
    s_add_u32 m0, s35, 16384
    s_mov_b32 s41, 0
    buffer_load_dwordx4 v7, s[12:15], s41 offen lds
    s_add_u32 m0, s35, 20480
    s_mov_b32 s41, 40960
    buffer_load_dwordx4 v7, s[12:15], s41 offen lds
    s_add_u32 m0, s35, 24576
    s_mov_b32 s41, 81920
    buffer_load_dwordx4 v7, s[12:15], s41 offen lds
    s_add_u32 m0, s35, 32768
    s_mov_b32 s40, 128
    buffer_load_dwordx4 v6, s[8:11], s40 offen lds
    s_add_u32 m0, s35, 36864
    s_mov_b32 s40, 41088
    buffer_load_dwordx4 v6, s[8:11], s40 offen lds
    s_add_u32 m0, s35, 40960
    s_mov_b32 s40, 82048
    buffer_load_dwordx4 v6, s[8:11], s40 offen lds
    s_add_u32 m0, s35, 45056
    s_mov_b32 s40, 123008
    buffer_load_dwordx4 v6, s[8:11], s40 offen lds
    s_add_u32 m0, s35, 49152
    s_mov_b32 s41, 128
    buffer_load_dwordx4 v7, s[12:15], s41 offen lds
    s_add_u32 m0, s35, 53248
    s_mov_b32 s41, 41088
    buffer_load_dwordx4 v7, s[12:15], s41 offen lds
    s_add_u32 m0, s35, 57344
    s_mov_b32 s41, 82048
    buffer_load_dwordx4 v7, s[12:15], s41 offen lds
    s_waitcnt vmcnt(7)
    s_barrier
    s_waitcnt vmcnt(0)
    s_barrier
    s_add_u32 m0, s35, 65536
    s_mov_b32 s40, 256
    buffer_load_dwordx4 v6, s[8:11], s40 offen lds
    s_add_u32 m0, s35, 69632
    s_mov_b32 s40, 41216
    buffer_load_dwordx4 v6, s[8:11], s40 offen lds
    s_add_u32 m0, s35, 73728
    s_mov_b32 s40, 82176
    buffer_load_dwordx4 v6, s[8:11], s40 offen lds
    s_add_u32 m0, s35, 77824
    s_mov_b32 s40, 123136
    buffer_load_dwordx4 v6, s[8:11], s40 offen lds
    s_add_u32 m0, s35, 81920
    s_mov_b32 s41, 256
    buffer_load_dwordx4 v7, s[12:15], s41 offen lds
    s_add_u32 m0, s35, 86016
    s_mov_b32 s41, 41216
    buffer_load_dwordx4 v7, s[12:15], s41 offen lds
    s_add_u32 m0, s35, 90112
    s_mov_b32 s41, 82176
    buffer_load_dwordx4 v7, s[12:15], s41 offen lds
    s_add_u32 m0, s35, 98304
    s_mov_b32 s40, 384
    buffer_load_dwordx4 v6, s[8:11], s40 offen lds
    s_add_u32 m0, s35, 102400
    s_mov_b32 s40, 41344
    buffer_load_dwordx4 v6, s[8:11], s40 offen lds
    s_add_u32 m0, s35, 106496
    s_mov_b32 s40, 82304
    buffer_load_dwordx4 v6, s[8:11], s40 offen lds
    s_add_u32 m0, s35, 110592
    s_mov_b32 s40, 123264
    buffer_load_dwordx4 v6, s[8:11], s40 offen lds
    s_add_u32 m0, s35, 114688
    s_mov_b32 s41, 384
    buffer_load_dwordx4 v7, s[12:15], s41 offen lds
    s_add_u32 m0, s35, 118784
    s_mov_b32 s41, 41344
    buffer_load_dwordx4 v7, s[12:15], s41 offen lds
    s_add_u32 m0, s35, 122880
    s_mov_b32 s41, 82304
    buffer_load_dwordx4 v7, s[12:15], s41 offen lds
    s_waitcnt vmcnt(7)
    s_barrier
    s_add_u32 m0, s35, 0
    s_mov_b32 s40, 512
    buffer_load_dwordx4 v6, s[8:11], s40 offen lds
    s_add_u32 m0, s35, 4096
    s_mov_b32 s40, 41472
    buffer_load_dwordx4 v6, s[8:11], s40 offen lds
    s_add_u32 m0, s35, 8192
    s_mov_b32 s40, 82432
    buffer_load_dwordx4 v6, s[8:11], s40 offen lds
    s_add_u32 m0, s35, 12288
    s_mov_b32 s40, 123392
    buffer_load_dwordx4 v6, s[8:11], s40 offen lds
    s_add_u32 m0, s35, 16384
    s_mov_b32 s41, 512
    buffer_load_dwordx4 v7, s[12:15], s41 offen lds
    s_add_u32 m0, s35, 20480
    s_mov_b32 s41, 41472
    buffer_load_dwordx4 v7, s[12:15], s41 offen lds
    s_add_u32 m0, s35, 24576
    s_mov_b32 s41, 82432
    buffer_load_dwordx4 v7, s[12:15], s41 offen lds
    s_waitcnt vmcnt(7)
    s_barrier
    s_add_u32 m0, s35, 32768
    s_mov_b32 s40, 640
    buffer_load_dwordx4 v6, s[8:11], s40 offen lds
    s_add_u32 m0, s35, 36864
    s_mov_b32 s40, 41600
    buffer_load_dwordx4 v6, s[8:11], s40 offen lds
    s_add_u32 m0, s35, 40960
    s_mov_b32 s40, 82560
    buffer_load_dwordx4 v6, s[8:11], s40 offen lds
    s_add_u32 m0, s35, 45056
    s_mov_b32 s40, 123520
    buffer_load_dwordx4 v6, s[8:11], s40 offen lds
    s_add_u32 m0, s35, 49152
    s_mov_b32 s41, 640
    buffer_load_dwordx4 v7, s[12:15], s41 offen lds
    s_add_u32 m0, s35, 53248
    s_mov_b32 s41, 41600
    buffer_load_dwordx4 v7, s[12:15], s41 offen lds
    s_add_u32 m0, s35, 57344
    s_mov_b32 s41, 82560
    buffer_load_dwordx4 v7, s[12:15], s41 offen lds
    s_waitcnt vmcnt(7)
    s_barrier
    s_add_u32 m0, s35, 65536
    s_mov_b32 s40, 768
    buffer_load_dwordx4 v6, s[8:11], s40 offen lds
    s_add_u32 m0, s35, 69632
    s_mov_b32 s40, 41728
    buffer_load_dwordx4 v6, s[8:11], s40 offen lds
    s_add_u32 m0, s35, 73728
    s_mov_b32 s40, 82688
    buffer_load_dwordx4 v6, s[8:11], s40 offen lds
    s_add_u32 m0, s35, 77824
    s_mov_b32 s40, 123648
    buffer_load_dwordx4 v6, s[8:11], s40 offen lds
    s_add_u32 m0, s35, 81920
    s_mov_b32 s41, 768
    buffer_load_dwordx4 v7, s[12:15], s41 offen lds
    s_add_u32 m0, s35, 86016
    s_mov_b32 s41, 41728
    buffer_load_dwordx4 v7, s[12:15], s41 offen lds
    s_add_u32 m0, s35, 90112
    s_mov_b32 s41, 82688
    buffer_load_dwordx4 v7, s[12:15], s41 offen lds
    s_waitcnt vmcnt(7)
    s_barrier
    s_add_u32 m0, s35, 98304
    s_mov_b32 s40, 896
    buffer_load_dwordx4 v6, s[8:11], s40 offen lds
    s_add_u32 m0, s35, 102400
    s_mov_b32 s40, 41856
    buffer_load_dwordx4 v6, s[8:11], s40 offen lds
    s_add_u32 m0, s35, 106496
    s_mov_b32 s40, 82816
    buffer_load_dwordx4 v6, s[8:11], s40 offen lds
    s_add_u32 m0, s35, 110592
    s_mov_b32 s40, 123776
    buffer_load_dwordx4 v6, s[8:11], s40 offen lds
    s_add_u32 m0, s35, 114688
    s_mov_b32 s41, 896
    buffer_load_dwordx4 v7, s[12:15], s41 offen lds
    s_add_u32 m0, s35, 118784
    s_mov_b32 s41, 41856
    buffer_load_dwordx4 v7, s[12:15], s41 offen lds
    s_add_u32 m0, s35, 122880
    s_mov_b32 s41, 82816
    buffer_load_dwordx4 v7, s[12:15], s41 offen lds
    s_waitcnt vmcnt(7)
    s_barrier
    s_add_u32 m0, s35, 0
    s_mov_b32 s40, 1024
    buffer_load_dwordx4 v6, s[8:11], s40 offen lds
    s_add_u32 m0, s35, 4096
    s_mov_b32 s40, 41984
    buffer_load_dwordx4 v6, s[8:11], s40 offen lds
    s_add_u32 m0, s35, 8192
    s_mov_b32 s40, 82944
    buffer_load_dwordx4 v6, s[8:11], s40 offen lds
    s_add_u32 m0, s35, 12288
    s_mov_b32 s40, 123904
    buffer_load_dwordx4 v6, s[8:11], s40 offen lds
    s_add_u32 m0, s35, 16384
    s_mov_b32 s41, 1024
    buffer_load_dwordx4 v7, s[12:15], s41 offen lds
    s_add_u32 m0, s35, 20480
    s_mov_b32 s41, 41984
    buffer_load_dwordx4 v7, s[12:15], s41 offen lds
    s_add_u32 m0, s35, 24576
    s_mov_b32 s41, 82944
    buffer_load_dwordx4 v7, s[12:15], s41 offen lds
    s_waitcnt vmcnt(7)
    s_barrier
    s_add_u32 m0, s35, 32768
    s_mov_b32 s40, 1152
    buffer_load_dwordx4 v6, s[8:11], s40 offen lds
    s_add_u32 m0, s35, 36864
    s_mov_b32 s40, 42112
    buffer_load_dwordx4 v6, s[8:11], s40 offen lds
    s_add_u32 m0, s35, 40960
    s_mov_b32 s40, 83072
    buffer_load_dwordx4 v6, s[8:11], s40 offen lds
    s_add_u32 m0, s35, 45056
    s_mov_b32 s40, 124032
    buffer_load_dwordx4 v6, s[8:11], s40 offen lds
    s_add_u32 m0, s35, 49152
    s_mov_b32 s41, 1152
    buffer_load_dwordx4 v7, s[12:15], s41 offen lds
    s_add_u32 m0, s35, 53248
    s_mov_b32 s41, 42112
    buffer_load_dwordx4 v7, s[12:15], s41 offen lds
    s_add_u32 m0, s35, 57344
    s_mov_b32 s41, 83072
    buffer_load_dwordx4 v7, s[12:15], s41 offen lds
    s_waitcnt vmcnt(7)
    s_barrier
    s_waitcnt vmcnt(0)
    s_barrier
    s_barrier
    s_endpgm
k4_cons:
    v_and_b32 v3, 15, v2
    v_lshrrev_b32 v4, 4, v2
    v_lshrrev_b32 v8, 1, v3
    v_xor_b32 v8, v8, v4
    v_lshlrev_b32 v5, 7, v3
    v_lshl_add_u32 v5, v8, 4, v5
    s_mul_i32 s33, s3, 4096
    s_add_u32 s34, s33, 0
    v_add_u32 v8, s34, v5
    v_xor_b32 v9, 64, v8
    v_add_u32 v16, 0x4000, v5
    v_xor_b32 v17, 64, v16
    s_add_u32 s34, s33, 32768
    v_add_u32 v10, s34, v5
    v_xor_b32 v11, 64, v10
    v_add_u32 v18, 0xc000, v5
    v_xor_b32 v19, 64, v18
    s_add_u32 s34, s33, 65536
    v_add_u32 v12, s34, v5
    v_xor_b32 v13, 64, v12
    v_add_u32 v20, 0x14000, v5
    v_xor_b32 v21, 64, v20
    s_add_u32 s34, s33, 98304
    v_add_u32 v14, s34, v5
    v_xor_b32 v15, 64, v14
    v_add_u32 v22, 0x1c000, v5
    v_xor_b32 v23, 64, v22
    v_lshl_add_u32 v24, v4, 2, s32
    v_lshlrev_b32 v24, 1, v24
    buffer_load_dwordx2 v[26:27], v24, s[16:19], 0 offen offset:0
    buffer_load_dwordx2 v[28:29], v24, s[16:19], 0 offen offset:32
    buffer_load_dwordx2 v[30:31], v24, s[16:19], 0 offen offset:64
    buffer_load_dwordx2 v[32:33], v24, s[16:19], 0 offen offset:96
    buffer_load_dwordx2 v[34:35], v24, s[16:19], 0 offen offset:128
    buffer_load_dwordx2 v[36:37], v24, s[16:19], 0 offen offset:160
    buffer_load_dwordx2 v[38:39], v24, s[16:19], 0 offen offset:192
    s_mul_i32 s33, s3, 32
    s_add_u32 s33, s33, s31
    v_add_u32 v25, s33, v3
    v_mul_u32_u24 v25, 3456, v25
    v_add_u32 v25, v25, v24
    v_mov_b32 v40, 0
    v_mov_b32 v41, 0
    v_mov_b32 v42, 0
    v_mov_b32 v43, 0
    v_mov_b32 v44, 0
    v_mov_b32 v45, 0
    v_mov_b32 v46, 0
    v_mov_b32 v47, 0
    v_mov_b32 v48, 0
    v_mov_b32 v49, 0
    v_mov_b32 v50, 0
    v_mov_b32 v51, 0
    v_mov_b32 v52, 0
    v_mov_b32 v53, 0
    v_mov_b32 v54, 0
    v_mov_b32 v55, 0
    v_mov_b32 v56, 0
    v_mov_b32 v57, 0
    v_mov_b32 v58, 0
    v_mov_b32 v59, 0
    v_mov_b32 v60, 0
    v_mov_b32 v61, 0
    v_mov_b32 v62, 0
    v_mov_b32 v63, 0
    v_mov_b32 v64, 0
    v_mov_b32 v65, 0
    v_mov_b32 v66, 0
    v_mov_b32 v67, 0
    v_mov_b32 v68, 0
    v_mov_b32 v69, 0
    v_mov_b32 v70, 0
    v_mov_b32 v71, 0
    v_mov_b32 v72, 0
    v_mov_b32 v73, 0
    v_mov_b32 v74, 0
    v_mov_b32 v75, 0
    v_mov_b32 v76, 0
    v_mov_b32 v77, 0
    v_mov_b32 v78, 0
    v_mov_b32 v79, 0
    v_mov_b32 v80, 0
    v_mov_b32 v81, 0
    v_mov_b32 v82, 0
    v_mov_b32 v83, 0
    v_mov_b32 v84, 0
    v_mov_b32 v85, 0
    v_mov_b32 v86, 0
    v_mov_b32 v87, 0
    v_mov_b32 v88, 0
    v_mov_b32 v89, 0
    v_mov_b32 v90, 0
    v_mov_b32 v91, 0
    v_mov_b32 v92, 0
    v_mov_b32 v93, 0
    v_mov_b32 v94, 0
    v_mov_b32 v95, 0
    s_barrier
    ds_read_b128 v[152:155], v8 offset:0
    ds_read_b128 v[156:159], v8 offset:2048
    ds_read_b128 v[96:99], v16 offset:0
    ds_read_b128 v[100:103], v16 offset:2048
    ds_read_b128 v[104:107], v16 offset:4096
    ds_read_b128 v[108:111], v16 offset:6144
    ds_read_b128 v[112:115], v16 offset:8192
    ds_read_b128 v[116:119], v16 offset:10240
    ds_read_b128 v[120:123], v16 offset:12288
    s_barrier
    ds_read_b128 v[160:163], v9 offset:0
    ds_read_b128 v[164:167], v9 offset:2048
    ds_read_b128 v[124:127], v17 offset:0
    ds_read_b128 v[128:131], v17 offset:2048
    ds_read_b128 v[132:135], v17 offset:4096
    ds_read_b128 v[136:139], v17 offset:6144
    ds_read_b128 v[140:143], v17 offset:8192
    ds_read_b128 v[144:147], v17 offset:10240
    ds_read_b128 v[148:151], v17 offset:12288
    s_waitcnt lgkmcnt(9)
    v_mfma_f32_16x16x32_bf16 v[40:43], v[96:99], v[152:155], v[40:43]
    v_mfma_f32_16x16x32_bf16 v[68:71], v[96:99], v[156:159], v[68:71]
    v_mfma_f32_16x16x32_bf16 v[44:47], v[100:103], v[152:155], v[44:47]
    v_mfma_f32_16x16x32_bf16 v[72:75], v[100:103], v[156:159], v[72:75]
    v_mfma_f32_16x16x32_bf16 v[48:51], v[104:107], v[152:155], v[48:51]
    v_mfma_f32_16x16x32_bf16 v[76:79], v[104:107], v[156:159], v[76:79]
    v_mfma_f32_16x16x32_bf16 v[52:55], v[108:111], v[152:155], v[52:55]
    v_mfma_f32_16x16x32_bf16 v[80:83], v[108:111], v[156:159], v[80:83]
    v_mfma_f32_16x16x32_bf16 v[56:59], v[112:115], v[152:155], v[56:59]
    v_mfma_f32_16x16x32_bf16 v[84:87], v[112:115], v[156:159], v[84:87]
    v_mfma_f32_16x16x32_bf16 v[60:63], v[116:119], v[152:155], v[60:63]
    v_mfma_f32_16x16x32_bf16 v[88:91], v[116:119], v[156:159], v[88:91]
    v_mfma_f32_16x16x32_bf16 v[64:67], v[120:123], v[152:155], v[64:67]
    v_mfma_f32_16x16x32_bf16 v[92:95], v[120:123], v[156:159], v[92:95]
    ds_read_b128 v[152:155], v10 offset:0
    ds_read_b128 v[156:159], v10 offset:2048
    ds_read_b128 v[96:99], v18 offset:0
    ds_read_b128 v[100:103], v18 offset:2048
    ds_read_b128 v[104:107], v18 offset:4096
    ds_read_b128 v[108:111], v18 offset:6144
    ds_read_b128 v[112:115], v18 offset:8192
    ds_read_b128 v[116:119], v18 offset:10240
    ds_read_b128 v[120:123], v18 offset:12288
    s_waitcnt lgkmcnt(9)
    v_mfma_f32_16x16x32_bf16 v[40:43], v[124:127], v[160:163], v[40:43]
    v_mfma_f32_16x16x32_bf16 v[68:71], v[124:127], v[164:167], v[68:71]
    v_mfma_f32_16x16x32_bf16 v[44:47], v[128:131], v[160:163], v[44:47]
    v_mfma_f32_16x16x32_bf16 v[72:75], v[128:131], v[164:167], v[72:75]
    v_mfma_f32_16x16x32_bf16 v[48:51], v[132:135], v[160:163], v[48:51]
    v_mfma_f32_16x16x32_bf16 v[76:79], v[132:135], v[164:167], v[76:79]
    v_mfma_f32_16x16x32_bf16 v[52:55], v[136:139], v[160:163], v[52:55]
    v_mfma_f32_16x16x32_bf16 v[80:83], v[136:139], v[164:167], v[80:83]
    v_mfma_f32_16x16x32_bf16 v[56:59], v[140:143], v[160:163], v[56:59]
    v_mfma_f32_16x16x32_bf16 v[84:87], v[140:143], v[164:167], v[84:87]
    v_mfma_f32_16x16x32_bf16 v[60:63], v[144:147], v[160:163], v[60:63]
    v_mfma_f32_16x16x32_bf16 v[88:91], v[144:147], v[164:167], v[88:91]
    v_mfma_f32_16x16x32_bf16 v[64:67], v[148:151], v[160:163], v[64:67]
    v_mfma_f32_16x16x32_bf16 v[92:95], v[148:151], v[164:167], v[92:95]
    s_barrier
    ds_read_b128 v[160:163], v11 offset:0
    ds_read_b128 v[164:167], v11 offset:2048
    ds_read_b128 v[124:127], v19 offset:0
    ds_read_b128 v[128:131], v19 offset:2048
    ds_read_b128 v[132:135], v19 offset:4096
    ds_read_b128 v[136:139], v19 offset:6144
    ds_read_b128 v[140:143], v19 offset:8192
    ds_read_b128 v[144:147], v19 offset:10240
    ds_read_b128 v[148:151], v19 offset:12288
    s_waitcnt lgkmcnt(9)
    v_mfma_f32_16x16x32_bf16 v[40:43], v[96:99], v[152:155], v[40:43]
    v_mfma_f32_16x16x32_bf16 v[68:71], v[96:99], v[156:159], v[68:71]
    v_mfma_f32_16x16x32_bf16 v[44:47], v[100:103], v[152:155], v[44:47]
    v_mfma_f32_16x16x32_bf16 v[72:75], v[100:103], v[156:159], v[72:75]
    v_mfma_f32_16x16x32_bf16 v[48:51], v[104:107], v[152:155], v[48:51]
    v_mfma_f32_16x16x32_bf16 v[76:79], v[104:107], v[156:159], v[76:79]
    v_mfma_f32_16x16x32_bf16 v[52:55], v[108:111], v[152:155], v[52:55]
    v_mfma_f32_16x16x32_bf16 v[80:83], v[108:111], v[156:159], v[80:83]
    v_mfma_f32_16x16x32_bf16 v[56:59], v[112:115], v[152:155], v[56:59]
    v_mfma_f32_16x16x32_bf16 v[84:87], v[112:115], v[156:159], v[84:87]
    v_mfma_f32_16x16x32_bf16 v[60:63], v[116:119], v[152:155], v[60:63]
    v_mfma_f32_16x16x32_bf16 v[88:91], v[116:119], v[156:159], v[88:91]
    v_mfma_f32_16x16x32_bf16 v[64:67], v[120:123], v[152:155], v[64:67]
    v_mfma_f32_16x16x32_bf16 v[92:95], v[120:123], v[156:159], v[92:95]
    ds_read_b128 v[152:155], v12 offset:0
    ds_read_b128 v[156:159], v12 offset:2048
    ds_read_b128 v[96:99], v20 offset:0
    ds_read_b128 v[100:103], v20 offset:2048
    ds_read_b128 v[104:107], v20 offset:4096
    ds_read_b128 v[108:111], v20 offset:6144
    ds_read_b128 v[112:115], v20 offset:8192
    ds_read_b128 v[116:119], v20 offset:10240
    ds_read_b128 v[120:123], v20 offset:12288
    s_waitcnt lgkmcnt(9)
    v_mfma_f32_16x16x32_bf16 v[40:43], v[124:127], v[160:163], v[40:43]
    v_mfma_f32_16x16x32_bf16 v[68:71], v[124:127], v[164:167], v[68:71]
    v_mfma_f32_16x16x32_bf16 v[44:47], v[128:131], v[160:163], v[44:47]
    v_mfma_f32_16x16x32_bf16 v[72:75], v[128:131], v[164:167], v[72:75]
    v_mfma_f32_16x16x32_bf16 v[48:51], v[132:135], v[160:163], v[48:51]
    v_mfma_f32_16x16x32_bf16 v[76:79], v[132:135], v[164:167], v[76:79]
    v_mfma_f32_16x16x32_bf16 v[52:55], v[136:139], v[160:163], v[52:55]
    v_mfma_f32_16x16x32_bf16 v[80:83], v[136:139], v[164:167], v[80:83]
    v_mfma_f32_16x16x32_bf16 v[56:59], v[140:143], v[160:163], v[56:59]
    v_mfma_f32_16x16x32_bf16 v[84:87], v[140:143], v[164:167], v[84:87]
    v_mfma_f32_16x16x32_bf16 v[60:63], v[144:147], v[160:163], v[60:63]
    v_mfma_f32_16x16x32_bf16 v[88:91], v[144:147], v[164:167], v[88:91]
    v_mfma_f32_16x16x32_bf16 v[64:67], v[148:151], v[160:163], v[64:67]
    v_mfma_f32_16x16x32_bf16 v[92:95], v[148:151], v[164:167], v[92:95]
    s_barrier
    ds_read_b128 v[160:163], v13 offset:0
    ds_read_b128 v[164:167], v13 offset:2048
    ds_read_b128 v[124:127], v21 offset:0
    ds_read_b128 v[128:131], v21 offset:2048
    ds_read_b128 v[132:135], v21 offset:4096
    ds_read_b128 v[136:139], v21 offset:6144
    ds_read_b128 v[140:143], v21 offset:8192
    ds_read_b128 v[144:147], v21 offset:10240
    ds_read_b128 v[148:151], v21 offset:12288
    s_waitcnt lgkmcnt(9)
    v_mfma_f32_16x16x32_bf16 v[40:43], v[96:99], v[152:155], v[40:43]
    v_mfma_f32_16x16x32_bf16 v[68:71], v[96:99], v[156:159], v[68:71]
    v_mfma_f32_16x16x32_bf16 v[44:47], v[100:103], v[152:155], v[44:47]
    v_mfma_f32_16x16x32_bf16 v[72:75], v[100:103], v[156:159], v[72:75]
    v_mfma_f32_16x16x32_bf16 v[48:51], v[104:107], v[152:155], v[48:51]
    v_mfma_f32_16x16x32_bf16 v[76:79], v[104:107], v[156:159], v[76:79]
    v_mfma_f32_16x16x32_bf16 v[52:55], v[108:111], v[152:155], v[52:55]
    v_mfma_f32_16x16x32_bf16 v[80:83], v[108:111], v[156:159], v[80:83]
    v_mfma_f32_16x16x32_bf16 v[56:59], v[112:115], v[152:155], v[56:59]
    v_mfma_f32_16x16x32_bf16 v[84:87], v[112:115], v[156:159], v[84:87]
    v_mfma_f32_16x16x32_bf16 v[60:63], v[116:119], v[152:155], v[60:63]
    v_mfma_f32_16x16x32_bf16 v[88:91], v[116:119], v[156:159], v[88:91]
    v_mfma_f32_16x16x32_bf16 v[64:67], v[120:123], v[152:155], v[64:67]
    v_mfma_f32_16x16x32_bf16 v[92:95], v[120:123], v[156:159], v[92:95]
    ds_read_b128 v[152:155], v14 offset:0
    ds_read_b128 v[156:159], v14 offset:2048
    ds_read_b128 v[96:99], v22 offset:0
    ds_read_b128 v[100:103], v22 offset:2048
    ds_read_b128 v[104:107], v22 offset:4096
    ds_read_b128 v[108:111], v22 offset:6144
    ds_read_b128 v[112:115], v22 offset:8192
    ds_read_b128 v[116:119], v22 offset:10240
    ds_read_b128 v[120:123], v22 offset:12288
    s_waitcnt lgkmcnt(9)
    v_mfma_f32_16x16x32_bf16 v[40:43], v[124:127], v[160:163], v[40:43]
    v_mfma_f32_16x16x32_bf16 v[68:71], v[124:127], v[164:167], v[68:71]
    v_mfma_f32_16x16x32_bf16 v[44:47], v[128:131], v[160:163], v[44:47]
    v_mfma_f32_16x16x32_bf16 v[72:75], v[128:131], v[164:167], v[72:75]
    v_mfma_f32_16x16x32_bf16 v[48:51], v[132:135], v[160:163], v[48:51]
    v_mfma_f32_16x16x32_bf16 v[76:79], v[132:135], v[164:167], v[76:79]
    v_mfma_f32_16x16x32_bf16 v[52:55], v[136:139], v[160:163], v[52:55]
    v_mfma_f32_16x16x32_bf16 v[80:83], v[136:139], v[164:167], v[80:83]
    v_mfma_f32_16x16x32_bf16 v[56:59], v[140:143], v[160:163], v[56:59]
    v_mfma_f32_16x16x32_bf16 v[84:87], v[140:143], v[164:167], v[84:87]
    v_mfma_f32_16x16x32_bf16 v[60:63], v[144:147], v[160:163], v[60:63]
    v_mfma_f32_16x16x32_bf16 v[88:91], v[144:147], v[164:167], v[88:91]
    v_mfma_f32_16x16x32_bf16 v[64:67], v[148:151], v[160:163], v[64:67]
    v_mfma_f32_16x16x32_bf16 v[92:95], v[148:151], v[164:167], v[92:95]
    s_barrier
    ds_read_b128 v[160:163], v15 offset:0
    ds_read_b128 v[164:167], v15 offset:2048
    ds_read_b128 v[124:127], v23 offset:0
    ds_read_b128 v[128:131], v23 offset:2048
    ds_read_b128 v[132:135], v23 offset:4096
    ds_read_b128 v[136:139], v23 offset:6144
    ds_read_b128 v[140:143], v23 offset:8192
    ds_read_b128 v[144:147], v23 offset:10240
    ds_read_b128 v[148:151], v23 offset:12288
    s_waitcnt lgkmcnt(9)
    v_mfma_f32_16x16x32_bf16 v[40:43], v[96:99], v[152:155], v[40:43]
    v_mfma_f32_16x16x32_bf16 v[68:71], v[96:99], v[156:159], v[68:71]
    v_mfma_f32_16x16x32_bf16 v[44:47], v[100:103], v[152:155], v[44:47]
    v_mfma_f32_16x16x32_bf16 v[72:75], v[100:103], v[156:159], v[72:75]
    v_mfma_f32_16x16x32_bf16 v[48:51], v[104:107], v[152:155], v[48:51]
    v_mfma_f32_16x16x32_bf16 v[76:79], v[104:107], v[156:159], v[76:79]
    v_mfma_f32_16x16x32_bf16 v[52:55], v[108:111], v[152:155], v[52:55]
    v_mfma_f32_16x16x32_bf16 v[80:83], v[108:111], v[156:159], v[80:83]
    v_mfma_f32_16x16x32_bf16 v[56:59], v[112:115], v[152:155], v[56:59]
    v_mfma_f32_16x16x32_bf16 v[84:87], v[112:115], v[156:159], v[84:87]
    v_mfma_f32_16x16x32_bf16 v[60:63], v[116:119], v[152:155], v[60:63]
    v_mfma_f32_16x16x32_bf16 v[88:91], v[116:119], v[156:159], v[88:91]
    v_mfma_f32_16x16x32_bf16 v[64:67], v[120:123], v[152:155], v[64:67]
    v_mfma_f32_16x16x32_bf16 v[92:95], v[120:123], v[156:159], v[92:95]
    ds_read_b128 v[152:155], v8 offset:0
    ds_read_b128 v[156:159], v8 offset:2048
    ds_read_b128 v[96:99], v16 offset:0
    ds_read_b128 v[100:103], v16 offset:2048
    ds_read_b128 v[104:107], v16 offset:4096
    ds_read_b128 v[108:111], v16 offset:6144
    ds_read_b128 v[112:115], v16 offset:8192
    ds_read_b128 v[116:119], v16 offset:10240
    ds_read_b128 v[120:123], v16 offset:12288
    s_waitcnt lgkmcnt(9)
    v_mfma_f32_16x16x32_bf16 v[40:43], v[124:127], v[160:163], v[40:43]
    v_mfma_f32_16x16x32_bf16 v[68:71], v[124:127], v[164:167], v[68:71]
    v_mfma_f32_16x16x32_bf16 v[44:47], v[128:131], v[160:163], v[44:47]
    v_mfma_f32_16x16x32_bf16 v[72:75], v[128:131], v[164:167], v[72:75]
    v_mfma_f32_16x16x32_bf16 v[48:51], v[132:135], v[160:163], v[48:51]
    v_mfma_f32_16x16x32_bf16 v[76:79], v[132:135], v[164:167], v[76:79]
    v_mfma_f32_16x16x32_bf16 v[52:55], v[136:139], v[160:163], v[52:55]
    v_mfma_f32_16x16x32_bf16 v[80:83], v[136:139], v[164:167], v[80:83]
    v_mfma_f32_16x16x32_bf16 v[56:59], v[140:143], v[160:163], v[56:59]
    v_mfma_f32_16x16x32_bf16 v[84:87], v[140:143], v[164:167], v[84:87]
    v_mfma_f32_16x16x32_bf16 v[60:63], v[144:147], v[160:163], v[60:63]
    v_mfma_f32_16x16x32_bf16 v[88:91], v[144:147], v[164:167], v[88:91]
    v_mfma_f32_16x16x32_bf16 v[64:67], v[148:151], v[160:163], v[64:67]
    v_mfma_f32_16x16x32_bf16 v[92:95], v[148:151], v[164:167], v[92:95]
    s_barrier
    ds_read_b128 v[160:163], v9 offset:0
    ds_read_b128 v[164:167], v9 offset:2048
    ds_read_b128 v[124:127], v17 offset:0
    ds_read_b128 v[128:131], v17 offset:2048
    ds_read_b128 v[132:135], v17 offset:4096
    ds_read_b128 v[136:139], v17 offset:6144
    ds_read_b128 v[140:143], v17 offset:8192
    ds_read_b128 v[144:147], v17 offset:10240
    ds_read_b128 v[148:151], v17 offset:12288
    s_waitcnt lgkmcnt(9)
    v_mfma_f32_16x16x32_bf16 v[40:43], v[96:99], v[152:155], v[40:43]
    v_mfma_f32_16x16x32_bf16 v[68:71], v[96:99], v[156:159], v[68:71]
    v_mfma_f32_16x16x32_bf16 v[44:47], v[100:103], v[152:155], v[44:47]
    v_mfma_f32_16x16x32_bf16 v[72:75], v[100:103], v[156:159], v[72:75]
    v_mfma_f32_16x16x32_bf16 v[48:51], v[104:107], v[152:155], v[48:51]
    v_mfma_f32_16x16x32_bf16 v[76:79], v[104:107], v[156:159], v[76:79]
    v_mfma_f32_16x16x32_bf16 v[52:55], v[108:111], v[152:155], v[52:55]
    v_mfma_f32_16x16x32_bf16 v[80:83], v[108:111], v[156:159], v[80:83]
    v_mfma_f32_16x16x32_bf16 v[56:59], v[112:115], v[152:155], v[56:59]
    v_mfma_f32_16x16x32_bf16 v[84:87], v[112:115], v[156:159], v[84:87]
    v_mfma_f32_16x16x32_bf16 v[60:63], v[116:119], v[152:155], v[60:63]
    v_mfma_f32_16x16x32_bf16 v[88:91], v[116:119], v[156:159], v[88:91]
    v_mfma_f32_16x16x32_bf16 v[64:67], v[120:123], v[152:155], v[64:67]
    v_mfma_f32_16x16x32_bf16 v[92:95], v[120:123], v[156:159], v[92:95]
    ds_read_b128 v[152:155], v10 offset:0
    ds_read_b128 v[156:159], v10 offset:2048
    ds_read_b128 v[96:99], v18 offset:0
    ds_read_b128 v[100:103], v18 offset:2048
    ds_read_b128 v[104:107], v18 offset:4096
    ds_read_b128 v[108:111], v18 offset:6144
    ds_read_b128 v[112:115], v18 offset:8192
    ds_read_b128 v[116:119], v18 offset:10240
    ds_read_b128 v[120:123], v18 offset:12288
    s_waitcnt lgkmcnt(9)
    v_mfma_f32_16x16x32_bf16 v[40:43], v[124:127], v[160:163], v[40:43]
    v_mfma_f32_16x16x32_bf16 v[68:71], v[124:127], v[164:167], v[68:71]
    v_mfma_f32_16x16x32_bf16 v[44:47], v[128:131], v[160:163], v[44:47]
    v_mfma_f32_16x16x32_bf16 v[72:75], v[128:131], v[164:167], v[72:75]
    v_mfma_f32_16x16x32_bf16 v[48:51], v[132:135], v[160:163], v[48:51]
    v_mfma_f32_16x16x32_bf16 v[76:79], v[132:135], v[164:167], v[76:79]
    v_mfma_f32_16x16x32_bf16 v[52:55], v[136:139], v[160:163], v[52:55]
    v_mfma_f32_16x16x32_bf16 v[80:83], v[136:139], v[164:167], v[80:83]
    v_mfma_f32_16x16x32_bf16 v[56:59], v[140:143], v[160:163], v[56:59]
    v_mfma_f32_16x16x32_bf16 v[84:87], v[140:143], v[164:167], v[84:87]
    v_mfma_f32_16x16x32_bf16 v[60:63], v[144:147], v[160:163], v[60:63]
    v_mfma_f32_16x16x32_bf16 v[88:91], v[144:147], v[164:167], v[88:91]
    v_mfma_f32_16x16x32_bf16 v[64:67], v[148:151], v[160:163], v[64:67]
    v_mfma_f32_16x16x32_bf16 v[92:95], v[148:151], v[164:167], v[92:95]
    s_barrier
    ds_read_b128 v[160:163], v11 offset:0
    ds_read_b128 v[164:167], v11 offset:2048
    ds_read_b128 v[124:127], v19 offset:0
    ds_read_b128 v[128:131], v19 offset:2048
    ds_read_b128 v[132:135], v19 offset:4096
    ds_read_b128 v[136:139], v19 offset:6144
    ds_read_b128 v[140:143], v19 offset:8192
    ds_read_b128 v[144:147], v19 offset:10240
    ds_read_b128 v[148:151], v19 offset:12288
    s_waitcnt lgkmcnt(9)
    v_mfma_f32_16x16x32_bf16 v[40:43], v[96:99], v[152:155], v[40:43]
    v_mfma_f32_16x16x32_bf16 v[68:71], v[96:99], v[156:159], v[68:71]
    v_mfma_f32_16x16x32_bf16 v[44:47], v[100:103], v[152:155], v[44:47]
    v_mfma_f32_16x16x32_bf16 v[72:75], v[100:103], v[156:159], v[72:75]
    v_mfma_f32_16x16x32_bf16 v[48:51], v[104:107], v[152:155], v[48:51]
    v_mfma_f32_16x16x32_bf16 v[76:79], v[104:107], v[156:159], v[76:79]
    v_mfma_f32_16x16x32_bf16 v[52:55], v[108:111], v[152:155], v[52:55]
    v_mfma_f32_16x16x32_bf16 v[80:83], v[108:111], v[156:159], v[80:83]
    v_mfma_f32_16x16x32_bf16 v[56:59], v[112:115], v[152:155], v[56:59]
    v_mfma_f32_16x16x32_bf16 v[84:87], v[112:115], v[156:159], v[84:87]
    v_mfma_f32_16x16x32_bf16 v[60:63], v[116:119], v[152:155], v[60:63]
    v_mfma_f32_16x16x32_bf16 v[88:91], v[116:119], v[156:159], v[88:91]
    v_mfma_f32_16x16x32_bf16 v[64:67], v[120:123], v[152:155], v[64:67]
    v_mfma_f32_16x16x32_bf16 v[92:95], v[120:123], v[156:159], v[92:95]
    ds_read_b128 v[152:155], v12 offset:0
    ds_read_b128 v[156:159], v12 offset:2048
    ds_read_b128 v[96:99], v20 offset:0
    ds_read_b128 v[100:103], v20 offset:2048
    ds_read_b128 v[104:107], v20 offset:4096
    ds_read_b128 v[108:111], v20 offset:6144
    ds_read_b128 v[112:115], v20 offset:8192
    ds_read_b128 v[116:119], v20 offset:10240
    ds_read_b128 v[120:123], v20 offset:12288
    s_waitcnt lgkmcnt(9)
    v_mfma_f32_16x16x32_bf16 v[40:43], v[124:127], v[160:163], v[40:43]
    v_mfma_f32_16x16x32_bf16 v[68:71], v[124:127], v[164:167], v[68:71]
    v_mfma_f32_16x16x32_bf16 v[44:47], v[128:131], v[160:163], v[44:47]
    v_mfma_f32_16x16x32_bf16 v[72:75], v[128:131], v[164:167], v[72:75]
    v_mfma_f32_16x16x32_bf16 v[48:51], v[132:135], v[160:163], v[48:51]
    v_mfma_f32_16x16x32_bf16 v[76:79], v[132:135], v[164:167], v[76:79]
    v_mfma_f32_16x16x32_bf16 v[52:55], v[136:139], v[160:163], v[52:55]
    v_mfma_f32_16x16x32_bf16 v[80:83], v[136:139], v[164:167], v[80:83]
    v_mfma_f32_16x16x32_bf16 v[56:59], v[140:143], v[160:163], v[56:59]
    v_mfma_f32_16x16x32_bf16 v[84:87], v[140:143], v[164:167], v[84:87]
    v_mfma_f32_16x16x32_bf16 v[60:63], v[144:147], v[160:163], v[60:63]
    v_mfma_f32_16x16x32_bf16 v[88:91], v[144:147], v[164:167], v[88:91]
    v_mfma_f32_16x16x32_bf16 v[64:67], v[148:151], v[160:163], v[64:67]
    v_mfma_f32_16x16x32_bf16 v[92:95], v[148:151], v[164:167], v[92:95]
    s_barrier
    ds_read_b128 v[160:163], v13 offset:0
    ds_read_b128 v[164:167], v13 offset:2048
    ds_read_b128 v[124:127], v21 offset:0
    ds_read_b128 v[128:131], v21 offset:2048
    ds_read_b128 v[132:135], v21 offset:4096
    ds_read_b128 v[136:139], v21 offset:6144
    ds_read_b128 v[140:143], v21 offset:8192
    ds_read_b128 v[144:147], v21 offset:10240
    ds_read_b128 v[148:151], v21 offset:12288
    s_waitcnt lgkmcnt(9)
    v_mfma_f32_16x16x32_bf16 v[40:43], v[96:99], v[152:155], v[40:43]
    v_mfma_f32_16x16x32_bf16 v[68:71], v[96:99], v[156:159], v[68:71]
    v_mfma_f32_16x16x32_bf16 v[44:47], v[100:103], v[152:155], v[44:47]
    v_mfma_f32_16x16x32_bf16 v[72:75], v[100:103], v[156:159], v[72:75]
    v_mfma_f32_16x16x32_bf16 v[48:51], v[104:107], v[152:155], v[48:51]
    v_mfma_f32_16x16x32_bf16 v[76:79], v[104:107], v[156:159], v[76:79]
    v_mfma_f32_16x16x32_bf16 v[52:55], v[108:111], v[152:155], v[52:55]
    v_mfma_f32_16x16x32_bf16 v[80:83], v[108:111], v[156:159], v[80:83]
    v_mfma_f32_16x16x32_bf16 v[56:59], v[112:115], v[152:155], v[56:59]
    v_mfma_f32_16x16x32_bf16 v[84:87], v[112:115], v[156:159], v[84:87]
    v_mfma_f32_16x16x32_bf16 v[60:63], v[116:119], v[152:155], v[60:63]
    v_mfma_f32_16x16x32_bf16 v[88:91], v[116:119], v[156:159], v[88:91]
    v_mfma_f32_16x16x32_bf16 v[64:67], v[120:123], v[152:155], v[64:67]
    v_mfma_f32_16x16x32_bf16 v[92:95], v[120:123], v[156:159], v[92:95]
    ds_read_b128 v[152:155], v14 offset:0
    ds_read_b128 v[156:159], v14 offset:2048
    ds_read_b128 v[96:99], v22 offset:0
    ds_read_b128 v[100:103], v22 offset:2048
    ds_read_b128 v[104:107], v22 offset:4096
    ds_read_b128 v[108:111], v22 offset:6144
    ds_read_b128 v[112:115], v22 offset:8192
    ds_read_b128 v[116:119], v22 offset:10240
    ds_read_b128 v[120:123], v22 offset:12288
    s_waitcnt lgkmcnt(9)
    v_mfma_f32_16x16x32_bf16 v[40:43], v[124:127], v[160:163], v[40:43]
    v_mfma_f32_16x16x32_bf16 v[68:71], v[124:127], v[164:167], v[68:71]
    v_mfma_f32_16x16x32_bf16 v[44:47], v[128:131], v[160:163], v[44:47]
    v_mfma_f32_16x16x32_bf16 v[72:75], v[128:131], v[164:167], v[72:75]
    v_mfma_f32_16x16x32_bf16 v[48:51], v[132:135], v[160:163], v[48:51]
    v_mfma_f32_16x16x32_bf16 v[76:79], v[132:135], v[164:167], v[76:79]
    v_mfma_f32_16x16x32_bf16 v[52:55], v[136:139], v[160:163], v[52:55]
    v_mfma_f32_16x16x32_bf16 v[80:83], v[136:139], v[164:167], v[80:83]
    v_mfma_f32_16x16x32_bf16 v[56:59], v[140:143], v[160:163], v[56:59]
    v_mfma_f32_16x16x32_bf16 v[84:87], v[140:143], v[164:167], v[84:87]
    v_mfma_f32_16x16x32_bf16 v[60:63], v[144:147], v[160:163], v[60:63]
    v_mfma_f32_16x16x32_bf16 v[88:91], v[144:147], v[164:167], v[88:91]
    v_mfma_f32_16x16x32_bf16 v[64:67], v[148:151], v[160:163], v[64:67]
    v_mfma_f32_16x16x32_bf16 v[92:95], v[148:151], v[164:167], v[92:95]
    s_barrier
    ds_read_b128 v[160:163], v15 offset:0
    ds_read_b128 v[164:167], v15 offset:2048
    ds_read_b128 v[124:127], v23 offset:0
    ds_read_b128 v[128:131], v23 offset:2048
    ds_read_b128 v[132:135], v23 offset:4096
    ds_read_b128 v[136:139], v23 offset:6144
    ds_read_b128 v[140:143], v23 offset:8192
    ds_read_b128 v[144:147], v23 offset:10240
    ds_read_b128 v[148:151], v23 offset:12288
    s_waitcnt lgkmcnt(9)
    v_mfma_f32_16x16x32_bf16 v[40:43], v[96:99], v[152:155], v[40:43]
    v_mfma_f32_16x16x32_bf16 v[68:71], v[96:99], v[156:159], v[68:71]
    v_mfma_f32_16x16x32_bf16 v[44:47], v[100:103], v[152:155], v[44:47]
    v_mfma_f32_16x16x32_bf16 v[72:75], v[100:103], v[156:159], v[72:75]
    v_mfma_f32_16x16x32_bf16 v[48:51], v[104:107], v[152:155], v[48:51]
    v_mfma_f32_16x16x32_bf16 v[76:79], v[104:107], v[156:159], v[76:79]
    v_mfma_f32_16x16x32_bf16 v[52:55], v[108:111], v[152:155], v[52:55]
    v_mfma_f32_16x16x32_bf16 v[80:83], v[108:111], v[156:159], v[80:83]
    v_mfma_f32_16x16x32_bf16 v[56:59], v[112:115], v[152:155], v[56:59]
    v_mfma_f32_16x16x32_bf16 v[84:87], v[112:115], v[156:159], v[84:87]
    v_mfma_f32_16x16x32_bf16 v[60:63], v[116:119], v[152:155], v[60:63]
    v_mfma_f32_16x16x32_bf16 v[88:91], v[116:119], v[156:159], v[88:91]
    v_mfma_f32_16x16x32_bf16 v[64:67], v[120:123], v[152:155], v[64:67]
    v_mfma_f32_16x16x32_bf16 v[92:95], v[120:123], v[156:159], v[92:95]
    ds_read_b128 v[152:155], v8 offset:0
    ds_read_b128 v[156:159], v8 offset:2048
    ds_read_b128 v[96:99], v16 offset:0
    ds_read_b128 v[100:103], v16 offset:2048
    ds_read_b128 v[104:107], v16 offset:4096
    ds_read_b128 v[108:111], v16 offset:6144
    ds_read_b128 v[112:115], v16 offset:8192
    ds_read_b128 v[116:119], v16 offset:10240
    ds_read_b128 v[120:123], v16 offset:12288
    s_waitcnt lgkmcnt(9)
    v_mfma_f32_16x16x32_bf16 v[40:43], v[124:127], v[160:163], v[40:43]
    v_mfma_f32_16x16x32_bf16 v[68:71], v[124:127], v[164:167], v[68:71]
    v_mfma_f32_16x16x32_bf16 v[44:47], v[128:131], v[160:163], v[44:47]
    v_mfma_f32_16x16x32_bf16 v[72:75], v[128:131], v[164:167], v[72:75]
    v_mfma_f32_16x16x32_bf16 v[48:51], v[132:135], v[160:163], v[48:51]
    v_mfma_f32_16x16x32_bf16 v[76:79], v[132:135], v[164:167], v[76:79]
    v_mfma_f32_16x16x32_bf16 v[52:55], v[136:139], v[160:163], v[52:55]
    v_mfma_f32_16x16x32_bf16 v[80:83], v[136:139], v[164:167], v[80:83]
    v_mfma_f32_16x16x32_bf16 v[56:59], v[140:143], v[160:163], v[56:59]
    v_mfma_f32_16x16x32_bf16 v[84:87], v[140:143], v[164:167], v[84:87]
    v_mfma_f32_16x16x32_bf16 v[60:63], v[144:147], v[160:163], v[60:63]
    v_mfma_f32_16x16x32_bf16 v[88:91], v[144:147], v[164:167], v[88:91]
    v_mfma_f32_16x16x32_bf16 v[64:67], v[148:151], v[160:163], v[64:67]
    v_mfma_f32_16x16x32_bf16 v[92:95], v[148:151], v[164:167], v[92:95]
    s_barrier
    ds_read_b128 v[160:163], v9 offset:0
    ds_read_b128 v[164:167], v9 offset:2048
    ds_read_b128 v[124:127], v17 offset:0
    ds_read_b128 v[128:131], v17 offset:2048
    ds_read_b128 v[132:135], v17 offset:4096
    ds_read_b128 v[136:139], v17 offset:6144
    ds_read_b128 v[140:143], v17 offset:8192
    ds_read_b128 v[144:147], v17 offset:10240
    ds_read_b128 v[148:151], v17 offset:12288
    s_waitcnt lgkmcnt(9)
    v_mfma_f32_16x16x32_bf16 v[40:43], v[96:99], v[152:155], v[40:43]
    v_mfma_f32_16x16x32_bf16 v[68:71], v[96:99], v[156:159], v[68:71]
    v_mfma_f32_16x16x32_bf16 v[44:47], v[100:103], v[152:155], v[44:47]
    v_mfma_f32_16x16x32_bf16 v[72:75], v[100:103], v[156:159], v[72:75]
    v_mfma_f32_16x16x32_bf16 v[48:51], v[104:107], v[152:155], v[48:51]
    v_mfma_f32_16x16x32_bf16 v[76:79], v[104:107], v[156:159], v[76:79]
    v_mfma_f32_16x16x32_bf16 v[52:55], v[108:111], v[152:155], v[52:55]
    v_mfma_f32_16x16x32_bf16 v[80:83], v[108:111], v[156:159], v[80:83]
    v_mfma_f32_16x16x32_bf16 v[56:59], v[112:115], v[152:155], v[56:59]
    v_mfma_f32_16x16x32_bf16 v[84:87], v[112:115], v[156:159], v[84:87]
    v_mfma_f32_16x16x32_bf16 v[60:63], v[116:119], v[152:155], v[60:63]
    v_mfma_f32_16x16x32_bf16 v[88:91], v[116:119], v[156:159], v[88:91]
    v_mfma_f32_16x16x32_bf16 v[64:67], v[120:123], v[152:155], v[64:67]
    v_mfma_f32_16x16x32_bf16 v[92:95], v[120:123], v[156:159], v[92:95]
    ds_read_b128 v[152:155], v10 offset:0
    ds_read_b128 v[156:159], v10 offset:2048
    ds_read_b128 v[96:99], v18 offset:0
    ds_read_b128 v[100:103], v18 offset:2048
    ds_read_b128 v[104:107], v18 offset:4096
    ds_read_b128 v[108:111], v18 offset:6144
    ds_read_b128 v[112:115], v18 offset:8192
    ds_read_b128 v[116:119], v18 offset:10240
    ds_read_b128 v[120:123], v18 offset:12288
    s_waitcnt lgkmcnt(9)
    v_mfma_f32_16x16x32_bf16 v[40:43], v[124:127], v[160:163], v[40:43]
    v_mfma_f32_16x16x32_bf16 v[68:71], v[124:127], v[164:167], v[68:71]
    v_mfma_f32_16x16x32_bf16 v[44:47], v[128:131], v[160:163], v[44:47]
    v_mfma_f32_16x16x32_bf16 v[72:75], v[128:131], v[164:167], v[72:75]
    v_mfma_f32_16x16x32_bf16 v[48:51], v[132:135], v[160:163], v[48:51]
    v_mfma_f32_16x16x32_bf16 v[76:79], v[132:135], v[164:167], v[76:79]
    v_mfma_f32_16x16x32_bf16 v[52:55], v[136:139], v[160:163], v[52:55]
    v_mfma_f32_16x16x32_bf16 v[80:83], v[136:139], v[164:167], v[80:83]
    v_mfma_f32_16x16x32_bf16 v[56:59], v[140:143], v[160:163], v[56:59]
    v_mfma_f32_16x16x32_bf16 v[84:87], v[140:143], v[164:167], v[84:87]
    v_mfma_f32_16x16x32_bf16 v[60:63], v[144:147], v[160:163], v[60:63]
    v_mfma_f32_16x16x32_bf16 v[88:91], v[144:147], v[164:167], v[88:91]
    v_mfma_f32_16x16x32_bf16 v[64:67], v[148:151], v[160:163], v[64:67]
    v_mfma_f32_16x16x32_bf16 v[92:95], v[148:151], v[164:167], v[92:95]
    s_barrier
    ds_read_b128 v[160:163], v11 offset:0
    ds_read_b128 v[164:167], v11 offset:2048
    ds_read_b128 v[124:127], v19 offset:0
    ds_read_b128 v[128:131], v19 offset:2048
    ds_read_b128 v[132:135], v19 offset:4096
    ds_read_b128 v[136:139], v19 offset:6144
    ds_read_b128 v[140:143], v19 offset:8192
    ds_read_b128 v[144:147], v19 offset:10240
    ds_read_b128 v[148:151], v19 offset:12288
    s_waitcnt lgkmcnt(9)
    v_mfma_f32_16x16x32_bf16 v[40:43], v[96:99], v[152:155], v[40:43]
    v_mfma_f32_16x16x32_bf16 v[68:71], v[96:99], v[156:159], v[68:71]
    v_mfma_f32_16x16x32_bf16 v[44:47], v[100:103], v[152:155], v[44:47]
    v_mfma_f32_16x16x32_bf16 v[72:75], v[100:103], v[156:159], v[72:75]
    v_mfma_f32_16x16x32_bf16 v[48:51], v[104:107], v[152:155], v[48:51]
    v_mfma_f32_16x16x32_bf16 v[76:79], v[104:107], v[156:159], v[76:79]
    v_mfma_f32_16x16x32_bf16 v[52:55], v[108:111], v[152:155], v[52:55]
    v_mfma_f32_16x16x32_bf16 v[80:83], v[108:111], v[156:159], v[80:83]
    v_mfma_f32_16x16x32_bf16 v[56:59], v[112:115], v[152:155], v[56:59]
    v_mfma_f32_16x16x32_bf16 v[84:87], v[112:115], v[156:159], v[84:87]
    v_mfma_f32_16x16x32_bf16 v[60:63], v[116:119], v[152:155], v[60:63]
    v_mfma_f32_16x16x32_bf16 v[88:91], v[116:119], v[156:159], v[88:91]
    v_mfma_f32_16x16x32_bf16 v[64:67], v[120:123], v[152:155], v[64:67]
    v_mfma_f32_16x16x32_bf16 v[92:95], v[120:123], v[156:159], v[92:95]
    s_waitcnt lgkmcnt(0)
    v_mfma_f32_16x16x32_bf16 v[40:43], v[124:127], v[160:163], v[40:43]
    v_mfma_f32_16x16x32_bf16 v[68:71], v[124:127], v[164:167], v[68:71]
    v_mfma_f32_16x16x32_bf16 v[44:47], v[128:131], v[160:163], v[44:47]
    v_mfma_f32_16x16x32_bf16 v[72:75], v[128:131], v[164:167], v[72:75]
    v_mfma_f32_16x16x32_bf16 v[48:51], v[132:135], v[160:163], v[48:51]
    v_mfma_f32_16x16x32_bf16 v[76:79], v[132:135], v[164:167], v[76:79]
    v_mfma_f32_16x16x32_bf16 v[52:55], v[136:139], v[160:163], v[52:55]
    v_mfma_f32_16x16x32_bf16 v[80:83], v[136:139], v[164:167], v[80:83]
    v_mfma_f32_16x16x32_bf16 v[56:59], v[140:143], v[160:163], v[56:59]
    v_mfma_f32_16x16x32_bf16 v[84:87], v[140:143], v[164:167], v[84:87]
    v_mfma_f32_16x16x32_bf16 v[60:63], v[144:147], v[160:163], v[60:63]
    v_mfma_f32_16x16x32_bf16 v[88:91], v[144:147], v[164:167], v[88:91]
    v_mfma_f32_16x16x32_bf16 v[64:67], v[148:151], v[160:163], v[64:67]
    v_mfma_f32_16x16x32_bf16 v[92:95], v[148:151], v[164:167], v[92:95]
    s_waitcnt vmcnt(0)
    s_nop 7
    s_nop 3
    v_mov_b32 v168, 0xc0135761
    v_mov_b32 v169, 0xc0135761
    v_mov_b32 v170, 0xbdd2d3e8
    v_mov_b32 v171, 0xbdd2d3e8
    v_mov_b32 v172, 0x3f800000
    v_mov_b32 v173, 0x3f800000
    v_lshlrev_b32 v184, 16, v26
    v_and_b32 v185, 0xffff0000, v26
    v_lshlrev_b32 v186, 16, v27
    v_and_b32 v187, 0xffff0000, v27
    v_cvt_pk_bf16_f32 v182, v40, v41
    v_cvt_pk_bf16_f32 v183, v42, v43
    v_lshlrev_b32 v174, 16, v182
    v_and_b32 v175, 0xffff0000, v182
    v_lshlrev_b32 v176, 16, v183
    v_and_b32 v177, 0xffff0000, v183
    v_pk_add_f32 v[174:175], v[174:175], v[184:185]
    v_pk_add_f32 v[176:177], v[176:177], v[186:187]
    v_cvt_pk_bf16_f32 v182, v174, v175
    v_cvt_pk_bf16_f32 v183, v176, v177
    v_lshlrev_b32 v174, 16, v182
    v_and_b32 v175, 0xffff0000, v182
    v_lshlrev_b32 v176, 16, v183
    v_and_b32 v177, 0xffff0000, v183
    v_pk_mul_f32 v[178:179], v[174:175], v[174:175]
    v_pk_mul_f32 v[180:181], v[176:177], v[176:177]
    v_pk_fma_f32 v[178:179], v[178:179], v[170:171], v[168:169]
    v_pk_fma_f32 v[180:181], v[180:181], v[170:171], v[168:169]
    v_pk_mul_f32 v[178:179], v[178:179], v[174:175]
    v_pk_mul_f32 v[180:181], v[180:181], v[176:177]
    v_exp_f32 v178, v178
    v_exp_f32 v179, v179
    v_exp_f32 v180, v180
    v_exp_f32 v181, v181
    s_nop 0
    v_pk_add_f32 v[178:179], v[178:179], v[172:173]
    v_pk_add_f32 v[180:181], v[180:181], v[172:173]
    v_rcp_f32 v178, v178
    v_rcp_f32 v179, v179
    v_rcp_f32 v180, v180
    v_rcp_f32 v181, v181
    s_nop 0
    v_pk_mul_f32 v[174:175], v[174:175], v[178:179]
    v_pk_mul_f32 v[176:177], v[176:177], v[180:181]
    v_cvt_pk_bf16_f32 v182, v174, v175
    v_cvt_pk_bf16_f32 v183, v176, v177
    s_mov_b32 s42, 0
    buffer_store_dwordx2 v[182:183], v25, s[20:23], s42 offen offset:0
    s_nop 1
    v_cvt_pk_bf16_f32 v182, v68, v69
    v_cvt_pk_bf16_f32 v183, v70, v71
    v_lshlrev_b32 v174, 16, v182
    v_and_b32 v175, 0xffff0000, v182
    v_lshlrev_b32 v176, 16, v183
    v_and_b32 v177, 0xffff0000, v183
    v_pk_add_f32 v[174:175], v[174:175], v[184:185]
    v_pk_add_f32 v[176:177], v[176:177], v[186:187]
    v_cvt_pk_bf16_f32 v182, v174, v175
    v_cvt_pk_bf16_f32 v183, v176, v177
    v_lshlrev_b32 v174, 16, v182
    v_and_b32 v175, 0xffff0000, v182
    v_lshlrev_b32 v176, 16, v183
    v_and_b32 v177, 0xffff0000, v183
    v_pk_mul_f32 v[178:179], v[174:175], v[174:175]
    v_pk_mul_f32 v[180:181], v[176:177], v[176:177]
    v_pk_fma_f32 v[178:179], v[178:179], v[170:171], v[168:169]
    v_pk_fma_f32 v[180:181], v[180:181], v[170:171], v[168:169]
    v_pk_mul_f32 v[178:179], v[178:179], v[174:175]
    v_pk_mul_f32 v[180:181], v[180:181], v[176:177]
    v_exp_f32 v178, v178
    v_exp_f32 v179, v179
    v_exp_f32 v180, v180
    v_exp_f32 v181, v181
    s_nop 0
    v_pk_add_f32 v[178:179], v[178:179], v[172:173]
    v_pk_add_f32 v[180:181], v[180:181], v[172:173]
    v_rcp_f32 v178, v178
    v_rcp_f32 v179, v179
    v_rcp_f32 v180, v180
    v_rcp_f32 v181, v181
    s_nop 0
    v_pk_mul_f32 v[174:175], v[174:175], v[178:179]
    v_pk_mul_f32 v[176:177], v[176:177], v[180:181]
    v_cvt_pk_bf16_f32 v182, v174, v175
    v_cvt_pk_bf16_f32 v183, v176, v177
    s_mov_b32 s42, 55296
    buffer_store_dwordx2 v[182:183], v25, s[20:23], s42 offen offset:0
    s_nop 1
    s_add_u32 s33, s32, 16
    s_cmp_ge_u32 s33, 1728
    s_cbranch_scc1 k4_end
    v_lshlrev_b32 v184, 16, v28
    v_and_b32 v185, 0xffff0000, v28
    v_lshlrev_b32 v186, 16, v29
    v_and_b32 v187, 0xffff0000, v29
    v_cvt_pk_bf16_f32 v182, v44, v45
    v_cvt_pk_bf16_f32 v183, v46, v47
    v_lshlrev_b32 v174, 16, v182
    v_and_b32 v175, 0xffff0000, v182
    v_lshlrev_b32 v176, 16, v183
    v_and_b32 v177, 0xffff0000, v183
    v_pk_add_f32 v[174:175], v[174:175], v[184:185]
    v_pk_add_f32 v[176:177], v[176:177], v[186:187]
    v_cvt_pk_bf16_f32 v182, v174, v175
    v_cvt_pk_bf16_f32 v183, v176, v177
    v_lshlrev_b32 v174, 16, v182
    v_and_b32 v175, 0xffff0000, v182
    v_lshlrev_b32 v176, 16, v183
    v_and_b32 v177, 0xffff0000, v183
    v_pk_mul_f32 v[178:179], v[174:175], v[174:175]
    v_pk_mul_f32 v[180:181], v[176:177], v[176:177]
    v_pk_fma_f32 v[178:179], v[178:179], v[170:171], v[168:169]
    v_pk_fma_f32 v[180:181], v[180:181], v[170:171], v[168:169]
    v_pk_mul_f32 v[178:179], v[178:179], v[174:175]
    v_pk_mul_f32 v[180:181], v[180:181], v[176:177]
    v_exp_f32 v178, v178
    v_exp_f32 v179, v179
    v_exp_f32 v180, v180
    v_exp_f32 v181, v181
    s_nop 0
    v_pk_add_f32 v[178:179], v[178:179], v[172:173]
    v_pk_add_f32 v[180:181], v[180:181], v[172:173]
    v_rcp_f32 v178, v178
    v_rcp_f32 v179, v179
    v_rcp_f32 v180, v180
    v_rcp_f32 v181, v181
    s_nop 0
    v_pk_mul_f32 v[174:175], v[174:175], v[178:179]
    v_pk_mul_f32 v[176:177], v[176:177], v[180:181]
    v_cvt_pk_bf16_f32 v182, v174, v175
    v_cvt_pk_bf16_f32 v183, v176, v177
    s_mov_b32 s42, 0
    buffer_store_dwordx2 v[182:183], v25, s[20:23], s42 offen offset:32
    s_nop 1
    v_cvt_pk_bf16_f32 v182, v72, v73
    v_cvt_pk_bf16_f32 v183, v74, v75
    v_lshlrev_b32 v174, 16, v182
    v_and_b32 v175, 0xffff0000, v182
    v_lshlrev_b32 v176, 16, v183
    v_and_b32 v177, 0xffff0000, v183
    v_pk_add_f32 v[174:175], v[174:175], v[184:185]
    v_pk_add_f32 v[176:177], v[176:177], v[186:187]
    v_cvt_pk_bf16_f32 v182, v174, v175
    v_cvt_pk_bf16_f32 v183, v176, v177
    v_lshlrev_b32 v174, 16, v182
    v_and_b32 v175, 0xffff0000, v182
    v_lshlrev_b32 v176, 16, v183
    v_and_b32 v177, 0xffff0000, v183
    v_pk_mul_f32 v[178:179], v[174:175], v[174:175]
    v_pk_mul_f32 v[180:181], v[176:177], v[176:177]
    v_pk_fma_f32 v[178:179], v[178:179], v[170:171], v[168:169]
    v_pk_fma_f32 v[180:181], v[180:181], v[170:171], v[168:169]
    v_pk_mul_f32 v[178:179], v[178:179], v[174:175]
    v_pk_mul_f32 v[180:181], v[180:181], v[176:177]
    v_exp_f32 v178, v178
    v_exp_f32 v179, v179
    v_exp_f32 v180, v180
    v_exp_f32 v181, v181
    s_nop 0
    v_pk_add_f32 v[178:179], v[178:179], v[172:173]
    v_pk_add_f32 v[180:181], v[180:181], v[172:173]
    v_rcp_f32 v178, v178
    v_rcp_f32 v179, v179
    v_rcp_f32 v180, v180
    v_rcp_f32 v181, v181
    s_nop 0
    v_pk_mul_f32 v[174:175], v[174:175], v[178:179]
    v_pk_mul_f32 v[176:177], v[176:177], v[180:181]
    v_cvt_pk_bf16_f32 v182, v174, v175
    v_cvt_pk_bf16_f32 v183, v176, v177
    s_mov_b32 s42, 55296
    buffer_store_dwordx2 v[182:183], v25, s[20:23], s42 offen offset:32
    s_nop 1
    s_add_u32 s33, s32, 32
    s_cmp_ge_u32 s33, 1728
    s_cbranch_scc1 k4_end
    v_lshlrev_b32 v184, 16, v30
    v_and_b32 v185, 0xffff0000, v30
    v_lshlrev_b32 v186, 16, v31
    v_and_b32 v187, 0xffff0000, v31
    v_cvt_pk_bf16_f32 v182, v48, v49
    v_cvt_pk_bf16_f32 v183, v50, v51
    v_lshlrev_b32 v174, 16, v182
    v_and_b32 v175, 0xffff0000, v182
    v_lshlrev_b32 v176, 16, v183
    v_and_b32 v177, 0xffff0000, v183
    v_pk_add_f32 v[174:175], v[174:175], v[184:185]
    v_pk_add_f32 v[176:177], v[176:177], v[186:187]
    v_cvt_pk_bf16_f32 v182, v174, v175
    v_cvt_pk_bf16_f32 v183, v176, v177
    v_lshlrev_b32 v174, 16, v182
    v_and_b32 v175, 0xffff0000, v182
    v_lshlrev_b32 v176, 16, v183
    v_and_b32 v177, 0xffff0000, v183
    v_pk_mul_f32 v[178:179], v[174:175], v[174:175]
    v_pk_mul_f32 v[180:181], v[176:177], v[176:177]
    v_pk_fma_f32 v[178:179], v[178:179], v[170:171], v[168:169]
    v_pk_fma_f32 v[180:181], v[180:181], v[170:171], v[168:169]
    v_pk_mul_f32 v[178:179], v[178:179], v[174:175]
    v_pk_mul_f32 v[180:181], v[180:181], v[176:177]
    v_exp_f32 v178, v178
    v_exp_f32 v179, v179
    v_exp_f32 v180, v180
    v_exp_f32 v181, v181
    s_nop 0
    v_pk_add_f32 v[178:179], v[178:179], v[172:173]
    v_pk_add_f32 v[180:181], v[180:181], v[172:173]
    v_rcp_f32 v178, v178
    v_rcp_f32 v179, v179
    v_rcp_f32 v180, v180
    v_rcp_f32 v181, v181
    s_nop 0
    v_pk_mul_f32 v[174:175], v[174:175], v[178:179]
    v_pk_mul_f32 v[176:177], v[176:177], v[180:181]
    v_cvt_pk_bf16_f32 v182, v174, v175
    v_cvt_pk_bf16_f32 v183, v176, v177
    s_mov_b32 s42, 0
    buffer_store_dwordx2 v[182:183], v25, s[20:23], s42 offen offset:64
    s_nop 1
    v_cvt_pk_bf16_f32 v182, v76, v77
    v_cvt_pk_bf16_f32 v183, v78, v79
    v_lshlrev_b32 v174, 16, v182
    v_and_b32 v175, 0xffff0000, v182
    v_lshlrev_b32 v176, 16, v183
    v_and_b32 v177, 0xffff0000, v183
    v_pk_add_f32 v[174:175], v[174:175], v[184:185]
    v_pk_add_f32 v[176:177], v[176:177], v[186:187]
    v_cvt_pk_bf16_f32 v182, v174, v175
    v_cvt_pk_bf16_f32 v183, v176, v177
    v_lshlrev_b32 v174, 16, v182
    v_and_b32 v175, 0xffff0000, v182
    v_lshlrev_b32 v176, 16, v183
    v_and_b32 v177, 0xffff0000, v183
    v_pk_mul_f32 v[178:179], v[174:175], v[174:175]
    v_pk_mul_f32 v[180:181], v[176:177], v[176:177]
    v_pk_fma_f32 v[178:179], v[178:179], v[170:171], v[168:169]
    v_pk_fma_f32 v[180:181], v[180:181], v[170:171], v[168:169]
    v_pk_mul_f32 v[178:179], v[178:179], v[174:175]
    v_pk_mul_f32 v[180:181], v[180:181], v[176:177]
    v_exp_f32 v178, v178
    v_exp_f32 v179, v179
    v_exp_f32 v180, v180
    v_exp_f32 v181, v181
    s_nop 0
    v_pk_add_f32 v[178:179], v[178:179], v[172:173]
    v_pk_add_f32 v[180:181], v[180:181], v[172:173]
    v_rcp_f32 v178, v178
    v_rcp_f32 v179, v179
    v_rcp_f32 v180, v180
    v_rcp_f32 v181, v181
    s_nop 0
    v_pk_mul_f32 v[174:175], v[174:175], v[178:179]
    v_pk_mul_f32 v[176:177], v[176:177], v[180:181]
    v_cvt_pk_bf16_f32 v182, v174, v175
    v_cvt_pk_bf16_f32 v183, v176, v177
    s_mov_b32 s42, 55296
    buffer_store_dwordx2 v[182:183], v25, s[20:23], s42 offen offset:64
    s_nop 1
    s_add_u32 s33, s32, 48
    s_cmp_ge_u32 s33, 1728
    s_cbranch_scc1 k4_end
    v_lshlrev_b32 v184, 16, v32
    v_and_b32 v185, 0xffff0000, v32
    v_lshlrev_b32 v186, 16, v33
    v_and_b32 v187, 0xffff0000, v33
    v_cvt_pk_bf16_f32 v182, v52, v53
    v_cvt_pk_bf16_f32 v183, v54, v55
    v_lshlrev_b32 v174, 16, v182
    v_and_b32 v175, 0xffff0000, v182
    v_lshlrev_b32 v176, 16, v183
    v_and_b32 v177, 0xffff0000, v183
    v_pk_add_f32 v[174:175], v[174:175], v[184:185]
    v_pk_add_f32 v[176:177], v[176:177], v[186:187]
    v_cvt_pk_bf16_f32 v182, v174, v175
    v_cvt_pk_bf16_f32 v183, v176, v177
    v_lshlrev_b32 v174, 16, v182
    v_and_b32 v175, 0xffff0000, v182
    v_lshlrev_b32 v176, 16, v183
    v_and_b32 v177, 0xffff0000, v183
    v_pk_mul_f32 v[178:179], v[174:175], v[174:175]
    v_pk_mul_f32 v[180:181], v[176:177], v[176:177]
    v_pk_fma_f32 v[178:179], v[178:179], v[170:171], v[168:169]
    v_pk_fma_f32 v[180:181], v[180:181], v[170:171], v[168:169]
    v_pk_mul_f32 v[178:179], v[178:179], v[174:175]
    v_pk_mul_f32 v[180:181], v[180:181], v[176:177]
    v_exp_f32 v178, v178
    v_exp_f32 v179, v179
    v_exp_f32 v180, v180
    v_exp_f32 v181, v181
    s_nop 0
    v_pk_add_f32 v[178:179], v[178:179], v[172:173]
    v_pk_add_f32 v[180:181], v[180:181], v[172:173]
    v_rcp_f32 v178, v178
    v_rcp_f32 v179, v179
    v_rcp_f32 v180, v180
    v_rcp_f32 v181, v181
    s_nop 0
    v_pk_mul_f32 v[174:175], v[174:175], v[178:179]
    v_pk_mul_f32 v[176:177], v[176:177], v[180:181]
    v_cvt_pk_bf16_f32 v182, v174, v175
    v_cvt_pk_bf16_f32 v183, v176, v177
    s_mov_b32 s42, 0
    buffer_store_dwordx2 v[182:183], v25, s[20:23], s42 offen offset:96
    s_nop 1
    v_cvt_pk_bf16_f32 v182, v80, v81
    v_cvt_pk_bf16_f32 v183, v82, v83
    v_lshlrev_b32 v174, 16, v182
    v_and_b32 v175, 0xffff0000, v182
    v_lshlrev_b32 v176, 16, v183
    v_and_b32 v177, 0xffff0000, v183
    v_pk_add_f32 v[174:175], v[174:175], v[184:185]
    v_pk_add_f32 v[176:177], v[176:177], v[186:187]
    v_cvt_pk_bf16_f32 v182, v174, v175
    v_cvt_pk_bf16_f32 v183, v176, v177
    v_lshlrev_b32 v174, 16, v182
    v_and_b32 v175, 0xffff0000, v182
    v_lshlrev_b32 v176, 16, v183
    v_and_b32 v177, 0xffff0000, v183
    v_pk_mul_f32 v[178:179], v[174:175], v[174:175]
    v_pk_mul_f32 v[180:181], v[176:177], v[176:177]
    v_pk_fma_f32 v[178:179], v[178:179], v[170:171], v[168:169]
    v_pk_fma_f32 v[180:181], v[180:181], v[170:171], v[168:169]
    v_pk_mul_f32 v[178:179], v[178:179], v[174:175]
    v_pk_mul_f32 v[180:181], v[180:181], v[176:177]
    v_exp_f32 v178, v178
    v_exp_f32 v179, v179
    v_exp_f32 v180, v180
    v_exp_f32 v181, v181
    s_nop 0
    v_pk_add_f32 v[178:179], v[178:179], v[172:173]
    v_pk_add_f32 v[180:181], v[180:181], v[172:173]
    v_rcp_f32 v178, v178
    v_rcp_f32 v179, v179
    v_rcp_f32 v180, v180
    v_rcp_f32 v181, v181
    s_nop 0
    v_pk_mul_f32 v[174:175], v[174:175], v[178:179]
    v_pk_mul_f32 v[176:177], v[176:177], v[180:181]
    v_cvt_pk_bf16_f32 v182, v174, v175
    v_cvt_pk_bf16_f32 v183, v176, v177
    s_mov_b32 s42, 55296
    buffer_store_dwordx2 v[182:183], v25, s[20:23], s42 offen offset:96
    s_nop 1
    s_add_u32 s33, s32, 64
    s_cmp_ge_u32 s33, 1728
    s_cbranch_scc1 k4_end
    v_lshlrev_b32 v184, 16, v34
    v_and_b32 v185, 0xffff0000, v34
    v_lshlrev_b32 v186, 16, v35
    v_and_b32 v187, 0xffff0000, v35
    v_cvt_pk_bf16_f32 v182, v56, v57
    v_cvt_pk_bf16_f32 v183, v58, v59
    v_lshlrev_b32 v174, 16, v182
    v_and_b32 v175, 0xffff0000, v182
    v_lshlrev_b32 v176, 16, v183
    v_and_b32 v177, 0xffff0000, v183
    v_pk_add_f32 v[174:175], v[174:175], v[184:185]
    v_pk_add_f32 v[176:177], v[176:177], v[186:187]
    v_cvt_pk_bf16_f32 v182, v174, v175
    v_cvt_pk_bf16_f32 v183, v176, v177
    v_lshlrev_b32 v174, 16, v182
    v_and_b32 v175, 0xffff0000, v182
    v_lshlrev_b32 v176, 16, v183
    v_and_b32 v177, 0xffff0000, v183
    v_pk_mul_f32 v[178:179], v[174:175], v[174:175]
    v_pk_mul_f32 v[180:181], v[176:177], v[176:177]
    v_pk_fma_f32 v[178:179], v[178:179], v[170:171], v[168:169]
    v_pk_fma_f32 v[180:181], v[180:181], v[170:171], v[168:169]
    v_pk_mul_f32 v[178:179], v[178:179], v[174:175]
    v_pk_mul_f32 v[180:181], v[180:181], v[176:177]
    v_exp_f32 v178, v178
    v_exp_f32 v179, v179
    v_exp_f32 v180, v180
    v_exp_f32 v181, v181
    s_nop 0
    v_pk_add_f32 v[178:179], v[178:179], v[172:173]
    v_pk_add_f32 v[180:181], v[180:181], v[172:173]
    v_rcp_f32 v178, v178
    v_rcp_f32 v179, v179
    v_rcp_f32 v180, v180
    v_rcp_f32 v181, v181
    s_nop 0
    v_pk_mul_f32 v[174:175], v[174:175], v[178:179]
    v_pk_mul_f32 v[176:177], v[176:177], v[180:181]
    v_cvt_pk_bf16_f32 v182, v174, v175
    v_cvt_pk_bf16_f32 v183, v176, v177
    s_mov_b32 s42, 0
    buffer_store_dwordx2 v[182:183], v25, s[20:23], s42 offen offset:128
    s_nop 1
    v_cvt_pk_bf16_f32 v182, v84, v85
    v_cvt_pk_bf16_f32 v183, v86, v87
    v_lshlrev_b32 v174, 16, v182
    v_and_b32 v175, 0xffff0000, v182
    v_lshlrev_b32 v176, 16, v183
    v_and_b32 v177, 0xffff0000, v183
    v_pk_add_f32 v[174:175], v[174:175], v[184:185]
    v_pk_add_f32 v[176:177], v[176:177], v[186:187]
    v_cvt_pk_bf16_f32 v182, v174, v175
    v_cvt_pk_bf16_f32 v183, v176, v177
    v_lshlrev_b32 v174, 16, v182
    v_and_b32 v175, 0xffff0000, v182
    v_lshlrev_b32 v176, 16, v183
    v_and_b32 v177, 0xffff0000, v183
    v_pk_mul_f32 v[178:179], v[174:175], v[174:175]
    v_pk_mul_f32 v[180:181], v[176:177], v[176:177]
    v_pk_fma_f32 v[178:179], v[178:179], v[170:171], v[168:169]
    v_pk_fma_f32 v[180:181], v[180:181], v[170:171], v[168:169]
    v_pk_mul_f32 v[178:179], v[178:179], v[174:175]
    v_pk_mul_f32 v[180:181], v[180:181], v[176:177]
    v_exp_f32 v178, v178
    v_exp_f32 v179, v179
    v_exp_f32 v180, v180
    v_exp_f32 v181, v181
    s_nop 0
    v_pk_add_f32 v[178:179], v[178:179], v[172:173]
    v_pk_add_f32 v[180:181], v[180:181], v[172:173]
    v_rcp_f32 v178, v178
    v_rcp_f32 v179, v179
    v_rcp_f32 v180, v180
    v_rcp_f32 v181, v181
    s_nop 0
    v_pk_mul_f32 v[174:175], v[174:175], v[178:179]
    v_pk_mul_f32 v[176:177], v[176:177], v[180:181]
    v_cvt_pk_bf16_f32 v182, v174, v175
    v_cvt_pk_bf16_f32 v183, v176, v177
    s_mov_b32 s42, 55296
    buffer_store_dwordx2 v[182:183], v25, s[20:23], s42 offen offset:128
    s_nop 1
    s_add_u32 s33, s32, 80
    s_cmp_ge_u32 s33, 1728
    s_cbranch_scc1 k4_end
    v_lshlrev_b32 v184, 16, v36
    v_and_b32 v185, 0xffff0000, v36
    v_lshlrev_b32 v186, 16, v37
    v_and_b32 v187, 0xffff0000, v37
    v_cvt_pk_bf16_f32 v182, v60, v61
    v_cvt_pk_bf16_f32 v183, v62, v63
    v_lshlrev_b32 v174, 16, v182
    v_and_b32 v175, 0xffff0000, v182
    v_lshlrev_b32 v176, 16, v183
    v_and_b32 v177, 0xffff0000, v183
    v_pk_add_f32 v[174:175], v[174:175], v[184:185]
    v_pk_add_f32 v[176:177], v[176:177], v[186:187]
    v_cvt_pk_bf16_f32 v182, v174, v175
    v_cvt_pk_bf16_f32 v183, v176, v177
    v_lshlrev_b32 v174, 16, v182
    v_and_b32 v175, 0xffff0000, v182
    v_lshlrev_b32 v176, 16, v183
    v_and_b32 v177, 0xffff0000, v183
    v_pk_mul_f32 v[178:179], v[174:175], v[174:175]
    v_pk_mul_f32 v[180:181], v[176:177], v[176:177]
    v_pk_fma_f32 v[178:179], v[178:179], v[170:171], v[168:169]
    v_pk_fma_f32 v[180:181], v[180:181], v[170:171], v[168:169]
    v_pk_mul_f32 v[178:179], v[178:179], v[174:175]
    v_pk_mul_f32 v[180:181], v[180:181], v[176:177]
    v_exp_f32 v178, v178
    v_exp_f32 v179, v179
    v_exp_f32 v180, v180
    v_exp_f32 v181, v181
    s_nop 0
    v_pk_add_f32 v[178:179], v[178:179], v[172:173]
    v_pk_add_f32 v[180:181], v[180:181], v[172:173]
    v_rcp_f32 v178, v178
    v_rcp_f32 v179, v179
    v_rcp_f32 v180, v180
    v_rcp_f32 v181, v181
    s_nop 0
    v_pk_mul_f32 v[174:175], v[174:175], v[178:179]
    v_pk_mul_f32 v[176:177], v[176:177], v[180:181]
    v_cvt_pk_bf16_f32 v182, v174, v175
    v_cvt_pk_bf16_f32 v183, v176, v177
    s_mov_b32 s42, 0
    buffer_store_dwordx2 v[182:183], v25, s[20:23], s42 offen offset:160
    s_nop 1
    v_cvt_pk_bf16_f32 v182, v88, v89
    v_cvt_pk_bf16_f32 v183, v90, v91
    v_lshlrev_b32 v174, 16, v182
    v_and_b32 v175, 0xffff0000, v182
    v_lshlrev_b32 v176, 16, v183
    v_and_b32 v177, 0xffff0000, v183
    v_pk_add_f32 v[174:175], v[174:175], v[184:185]
    v_pk_add_f32 v[176:177], v[176:177], v[186:187]
    v_cvt_pk_bf16_f32 v182, v174, v175
    v_cvt_pk_bf16_f32 v183, v176, v177
    v_lshlrev_b32 v174, 16, v182
    v_and_b32 v175, 0xffff0000, v182
    v_lshlrev_b32 v176, 16, v183
    v_and_b32 v177, 0xffff0000, v183
    v_pk_mul_f32 v[178:179], v[174:175], v[174:175]
    v_pk_mul_f32 v[180:181], v[176:177], v[176:177]
    v_pk_fma_f32 v[178:179], v[178:179], v[170:171], v[168:169]
    v_pk_fma_f32 v[180:181], v[180:181], v[170:171], v[168:169]
    v_pk_mul_f32 v[178:179], v[178:179], v[174:175]
    v_pk_mul_f32 v[180:181], v[180:181], v[176:177]
    v_exp_f32 v178, v178
    v_exp_f32 v179, v179
    v_exp_f32 v180, v180
    v_exp_f32 v181, v181
    s_nop 0
    v_pk_add_f32 v[178:179], v[178:179], v[172:173]
    v_pk_add_f32 v[180:181], v[180:181], v[172:173]
    v_rcp_f32 v178, v178
    v_rcp_f32 v179, v179
    v_rcp_f32 v180, v180
    v_rcp_f32 v181, v181
    s_nop 0
    v_pk_mul_f32 v[174:175], v[174:175], v[178:179]
    v_pk_mul_f32 v[176:177], v[176:177], v[180:181]
    v_cvt_pk_bf16_f32 v182, v174, v175
    v_cvt_pk_bf16_f32 v183, v176, v177
    s_mov_b32 s42, 55296
    buffer_store_dwordx2 v[182:183], v25, s[20:23], s42 offen offset:160
    s_nop 1
    s_add_u32 s33, s32, 96
    s_cmp_ge_u32 s33, 1728
    s_cbranch_scc1 k4_end
    v_lshlrev_b32 v184, 16, v38
    v_and_b32 v185, 0xffff0000, v38
    v_lshlrev_b32 v186, 16, v39
    v_and_b32 v187, 0xffff0000, v39
    v_cvt_pk_bf16_f32 v182, v64, v65
    v_cvt_pk_bf16_f32 v183, v66, v67
    v_lshlrev_b32 v174, 16, v182
    v_and_b32 v175, 0xffff0000, v182
    v_lshlrev_b32 v176, 16, v183
    v_and_b32 v177, 0xffff0000, v183
    v_pk_add_f32 v[174:175], v[174:175], v[184:185]
    v_pk_add_f32 v[176:177], v[176:177], v[186:187]
    v_cvt_pk_bf16_f32 v182, v174, v175
    v_cvt_pk_bf16_f32 v183, v176, v177
    v_lshlrev_b32 v174, 16, v182
    v_and_b32 v175, 0xffff0000, v182
    v_lshlrev_b32 v176, 16, v183
    v_and_b32 v177, 0xffff0000, v183
    v_pk_mul_f32 v[178:179], v[174:175], v[174:175]
    v_pk_mul_f32 v[180:181], v[176:177], v[176:177]
    v_pk_fma_f32 v[178:179], v[178:179], v[170:171], v[168:169]
    v_pk_fma_f32 v[180:181], v[180:181], v[170:171], v[168:169]
    v_pk_mul_f32 v[178:179], v[178:179], v[174:175]
    v_pk_mul_f32 v[180:181], v[180:181], v[176:177]
    v_exp_f32 v178, v178
    v_exp_f32 v179, v179
    v_exp_f32 v180, v180
    v_exp_f32 v181, v181
    s_nop 0
    v_pk_add_f32 v[178:179], v[178:179], v[172:173]
    v_pk_add_f32 v[180:181], v[180:181], v[172:173]
    v_rcp_f32 v178, v178
    v_rcp_f32 v179, v179
    v_rcp_f32 v180, v180
    v_rcp_f32 v181, v181
    s_nop 0
    v_pk_mul_f32 v[174:175], v[174:175], v[178:179]
    v_pk_mul_f32 v[176:177], v[176:177], v[180:181]
    v_cvt_pk_bf16_f32 v182, v174, v175
    v_cvt_pk_bf16_f32 v183, v176, v177
    s_mov_b32 s42, 0
    buffer_store_dwordx2 v[182:183], v25, s[20:23], s42 offen offset:192
    s_nop 1
    v_cvt_pk_bf16_f32 v182, v92, v93
    v_cvt_pk_bf16_f32 v183, v94, v95
    v_lshlrev_b32 v174, 16, v182
    v_and_b32 v175, 0xffff0000, v182
    v_lshlrev_b32 v176, 16, v183
    v_and_b32 v177, 0xffff0000, v183
    v_pk_add_f32 v[174:175], v[174:175], v[184:185]
    v_pk_add_f32 v[176:177], v[176:177], v[186:187]
    v_cvt_pk_bf16_f32 v182, v174, v175
    v_cvt_pk_bf16_f32 v183, v176, v177
    v_lshlrev_b32 v174, 16, v182
    v_and_b32 v175, 0xffff0000, v182
    v_lshlrev_b32 v176, 16, v183
    v_and_b32 v177, 0xffff0000, v183
    v_pk_mul_f32 v[178:179], v[174:175], v[174:175]
    v_pk_mul_f32 v[180:181], v[176:177], v[176:177]
    v_pk_fma_f32 v[178:179], v[178:179], v[170:171], v[168:169]
    v_pk_fma_f32 v[180:181], v[180:181], v[170:171], v[168:169]
    v_pk_mul_f32 v[178:179], v[178:179], v[174:175]
    v_pk_mul_f32 v[180:181], v[180:181], v[176:177]
    v_exp_f32 v178, v178
    v_exp_f32 v179, v179
    v_exp_f32 v180, v180
    v_exp_f32 v181, v181
    s_nop 0
    v_pk_add_f32 v[178:179], v[178:179], v[172:173]
    v_pk_add_f32 v[180:181], v[180:181], v[172:173]
    v_rcp_f32 v178, v178
    v_rcp_f32 v179, v179
    v_rcp_f32 v180, v180
    v_rcp_f32 v181, v181
    s_nop 0
    v_pk_mul_f32 v[174:175], v[174:175], v[178:179]
    v_pk_mul_f32 v[176:177], v[176:177], v[180:181]
    v_cvt_pk_bf16_f32 v182, v174, v175
    v_cvt_pk_bf16_f32 v183, v176, v177
    s_mov_b32 s42, 55296
    buffer_store_dwordx2 v[182:183], v25, s[20:23], s42 offen offset:192
    s_nop 1
k4_end:
    s_endpgm
.globl k5_kernel
.p2align 8
.type k5_kernel,@function
k5_kernel:
    s_load_dwordx2 s[4:5], s[0:1], 80
    s_load_dwordx2 s[6:7], s[0:1], 56
    s_load_dwordx2 s[36:37], s[0:1], 64
    s_cmp_ge_u32 s2, 256
    s_cbranch_scc1 k5_end
    v_lshrrev_b32 v1, 6, v0
    v_and_b32 v2, 63, v0
    v_readfirstlane_b32 s3, v1
    s_lshr_b32 s70, s3, 2
    s_and_b32 s3, s3, 3
    s_waitcnt lgkmcnt(0)
    s_add_u32 s8, s4, 0x1800000
    s_addc_u32 s9, s5, 0
    s_mov_b32 s10, 0x6c0000
    s_mov_b32 s11, 0x00020000
    s_add_u32 s12, s4, 0x2400000
    s_addc_u32 s13, s5, 0
    s_mov_b32 s14, 0x21c000
    s_mov_b32 s15, 0x00020000
    s_mov_b32 s20, s36
    s_mov_b32 s21, s37
    s_mov_b32 s22, 0x280000
    s_mov_b32 s23, 0x00020000
    s_add_u32 s24, s4, 0x1000000
    s_addc_u32 s25, s5, 0
    s_mov_b32 s26, 0x280000
    s_mov_b32 s27, 0x00020000
    s_mov_b32 s16, s6
    s_mov_b32 s17, s7
    s_mov_b32 s18, 0x500
    s_mov_b32 s19, 0x00020000
    s_and_b32 s33, s2, 7
    s_lshr_b32 s34, s2, 3
    s_and_b32 s29, s33, 3
    s_lshl_b32 s29, s29, 3
    s_and_b32 s30, s34, 7
    s_add_u32 s29, s29, s30
    s_lshr_b32 s30, s33, 2
    s_mul_i32 s30, s30, 4
    s_lshr_b32 s34, s34, 3
    s_add_u32 s30, s30, s34
    s_mul_i32 s31, s29, 64
    s_mul_i32 s32, s30, 80
    v_lshrrev_b32 v3, 3, v2
    v_lshrrev_b32 v5, 4, v2
    s_and_b32 s33, s3, 1
    s_lshl_b32 s33, s33, 2
    v_add_u32 v5, s33, v5
    v_and_b32 v4, 7, v2
    v_xor_b32 v4, v4, v5
    s_lshl_b32 s33, s3, 3
    s_add_u32 s34, s33, s31
    v_add_u32 v6, s34, v3
    v_mul_u32_u24 v6, 3456, v6
    v_lshl_add_u32 v6, v4, 4, v6
    s_add_u32 s34, s33, s32
    v_add_u32 v7, s34, v3
    v_mul_u32_u24 v7, 3456, v7
    v_lshl_add_u32 v7, v4, 4, v7
    s_lshl_b32 s35, s3, 10
    s_cmp_eq_u32 s70, 0
    s_cbranch_scc1 k5_cons
    s_cmp_ge_u32 s3, 2
    s_cbranch_scc1 k5_ld2
    s_add_u32 m0, s35, 0
    s_mov_b32 s40, 0
    buffer_load_dwordx4 v6, s[8:11], s40 offen lds
    s_add_u32 m0, s35, 4096
    s_mov_b32 s40, 110592
    buffer_load_dwordx4 v6, s[8:11], s40 offen lds
    s_add_u32 m0, s35, 8192
    s_mov_b32 s41, 0
    buffer_load_dwordx4 v7, s[12:15], s41 offen lds
    s_add_u32 m0, s35, 12288
    s_mov_b32 s41, 110592
    buffer_load_dwordx4 v7, s[12:15], s41 offen lds
    s_add_u32 m0, s35, 16384
    s_mov_b32 s41, 221184
    buffer_load_dwordx4 v7, s[12:15], s41 offen lds
    s_add_u32 m0, s35, 20480
    s_mov_b32 s40, 128
    buffer_load_dwordx4 v6, s[8:11], s40 offen lds
    s_add_u32 m0, s35, 24576
    s_mov_b32 s40, 110720
    buffer_load_dwordx4 v6, s[8:11], s40 offen lds
    s_add_u32 m0, s35, 28672
    s_mov_b32 s41, 128
    buffer_load_dwordx4 v7, s[12:15], s41 offen lds
    s_add_u32 m0, s35, 32768
    s_mov_b32 s41, 110720
    buffer_load_dwordx4 v7, s[12:15], s41 offen lds
    s_add_u32 m0, s35, 36864
    s_mov_b32 s41, 221312
    buffer_load_dwordx4 v7, s[12:15], s41 offen lds
    s_waitcnt vmcnt(5)
    s_barrier
    s_waitcnt vmcnt(0)
    s_barrier
    s_add_u32 m0, s35, 40960
    s_mov_b32 s40, 256
    buffer_load_dwordx4 v6, s[8:11], s40 offen lds
    s_add_u32 m0, s35, 45056
    s_mov_b32 s40, 110848
    buffer_load_dwordx4 v6, s[8:11], s40 offen lds
    s_add_u32 m0, s35, 49152
    s_mov_b32 s41, 256
    buffer_load_dwordx4 v7, s[12:15], s41 offen lds
    s_add_u32 m0, s35, 53248
    s_mov_b32 s41, 110848
    buffer_load_dwordx4 v7, s[12:15], s41 offen lds
    s_add_u32 m0, s35, 57344
    s_mov_b32 s41, 221440
    buffer_load_dwordx4 v7, s[12:15], s41 offen lds
    s_add_u32 m0, s35, 61440
    s_mov_b32 s40, 384
    buffer_load_dwordx4 v6, s[8:11], s40 offen lds
    s_add_u32 m0, s35, 65536
    s_mov_b32 s40, 110976
    buffer_load_dwordx4 v6, s[8:11], s40 offen lds
    s_add_u32 m0, s35, 69632
    s_mov_b32 s41, 384
    buffer_load_dwordx4 v7, s[12:15], s41 offen lds
    s_add_u32 m0, s35, 73728
    s_mov_b32 s41, 110976
    buffer_load_dwordx4 v7, s[12:15], s41 offen lds
    s_add_u32 m0, s35, 77824
    s_mov_b32 s41, 221568
    buffer_load_dwordx4 v7, s[12:15], s41 offen lds
    s_waitcnt vmcnt(5)
    s_barrier
    s_add_u32 m0, s35, 81920
    s_mov_b32 s40, 512
    buffer_load_dwordx4 v6, s[8:11], s40 offen lds
    s_add_u32 m0, s35, 86016
    s_mov_b32 s40, 111104
    buffer_load_dwordx4 v6, s[8:11], s40 offen lds
    s_add_u32 m0, s35, 90112
    s_mov_b32 s41, 512
    buffer_load_dwordx4 v7, s[12:15], s41 offen lds
    s_add_u32 m0, s35, 94208
    s_mov_b32 s41, 111104
    buffer_load_dwordx4 v7, s[12:15], s41 offen lds
    s_add_u32 m0, s35, 98304
    s_mov_b32 s41, 221696
    buffer_load_dwordx4 v7, s[12:15], s41 offen lds
    s_add_u32 m0, s35, 102400
    s_mov_b32 s40, 640
    buffer_load_dwordx4 v6, s[8:11], s40 offen lds
    s_add_u32 m0, s35, 106496
    s_mov_b32 s40, 111232
    buffer_load_dwordx4 v6, s[8:11], s40 offen lds
    s_add_u32 m0, s35, 110592
    s_mov_b32 s41, 640
    buffer_load_dwordx4 v7, s[12:15], s41 offen lds
    s_add_u32 m0, s35, 114688
    s_mov_b32 s41, 111232
    buffer_load_dwordx4 v7, s[12:15], s41 offen lds
    s_add_u32 m0, s35, 118784
    s_mov_b32 s41, 221824
    buffer_load_dwordx4 v7, s[12:15], s41 offen lds
    s_waitcnt vmcnt(10)
    s_barrier
    s_add_u32 m0, s35, 0
    s_mov_b32 s40, 768
    buffer_load_dwordx4 v6, s[8:11], s40 offen lds
    s_add_u32 m0, s35, 4096
    s_mov_b32 s40, 111360
    buffer_load_dwordx4 v6, s[8:11], s40 offen lds
    s_add_u32 m0, s35, 8192
    s_mov_b32 s41, 768
    buffer_load_dwordx4 v7, s[12:15], s41 offen lds
    s_add_u32 m0, s35, 12288
    s_mov_b32 s41, 111360
    buffer_load_dwordx4 v7, s[12:15], s41 offen lds
    s_add_u32 m0, s35, 16384
    s_mov_b32 s41, 221952
    buffer_load_dwordx4 v7, s[12:15], s41 offen lds
    s_add_u32 m0, s35, 20480
    s_mov_b32 s40, 896
    buffer_load_dwordx4 v6, s[8:11], s40 offen lds
    s_add_u32 m0, s35, 24576
    s_mov_b32 s40, 111488
    buffer_load_dwordx4 v6, s[8:11], s40 offen lds
    s_add_u32 m0, s35, 28672
    s_mov_b32 s41, 896
    buffer_load_dwordx4 v7, s[12:15], s41 offen lds
    s_add_u32 m0, s35, 32768
    s_mov_b32 s41, 111488
    buffer_load_dwordx4 v7, s[12:15], s41 offen lds
    s_add_u32 m0, s35, 36864
    s_mov_b32 s41, 222080
    buffer_load_dwordx4 v7, s[12:15], s41 offen lds
    s_waitcnt vmcnt(15)
    s_barrier
    s_add_u32 m0, s35, 40960
    s_mov_b32 s40, 1024
    buffer_load_dwordx4 v6, s[8:11], s40 offen lds
    s_add_u32 m0, s35, 45056
    s_mov_b32 s40, 111616
    buffer_load_dwordx4 v6, s[8:11], s40 offen lds
    s_add_u32 m0, s35, 49152
    s_mov_b32 s41, 1024
    buffer_load_dwordx4 v7, s[12:15], s41 offen lds
    s_add_u32 m0, s35, 53248
    s_mov_b32 s41, 111616
    buffer_load_dwordx4 v7, s[12:15], s41 offen lds
    s_add_u32 m0, s35, 57344
    s_mov_b32 s41, 222208
    buffer_load_dwordx4 v7, s[12:15], s41 offen lds
    s_waitcnt vmcnt(15)
    s_barrier
    s_add_u32 m0, s35, 61440
    s_mov_b32 s40, 1152
    buffer_load_dwordx4 v6, s[8:11], s40 offen lds
    s_add_u32 m0, s35, 65536
    s_mov_b32 s40, 111744
    buffer_load_dwordx4 v6, s[8:11], s40 offen lds
    s_add_u32 m0, s35, 69632
    s_mov_b32 s41, 1152
    buffer_load_dwordx4 v7, s[12:15], s41 offen lds
    s_add_u32 m0, s35, 73728
    s_mov_b32 s41, 111744
    buffer_load_dwordx4 v7, s[12:15], s41 offen lds
    s_add_u32 m0, s35, 77824
    s_mov_b32 s41, 222336
    buffer_load_dwordx4 v7, s[12:15], s41 offen lds
    s_waitcnt vmcnt(15)
    s_barrier
    s_add_u32 m0, s35, 81920
    s_mov_b32 s40, 1280
    buffer_load_dwordx4 v6, s[8:11], s40 offen lds
    s_add_u32 m0, s35, 86016
    s_mov_b32 s40, 111872
    buffer_load_dwordx4 v6, s[8:11], s40 offen lds
    s_add_u32 m0, s35, 90112
    s_mov_b32 s41, 1280
    buffer_load_dwordx4 v7, s[12:15], s41 offen lds
    s_add_u32 m0, s35, 94208
    s_mov_b32 s41, 111872
    buffer_load_dwordx4 v7, s[12:15], s41 offen lds
    s_add_u32 m0, s35, 98304
    s_mov_b32 s41, 222464
    buffer_load_dwordx4 v7, s[12:15], s41 offen lds
    s_waitcnt vmcnt(15)
    s_barrier
    s_add_u32 m0, s35, 102400
    s_mov_b32 s40, 1408
    buffer_load_dwordx4 v6, s[8:11], s40 offen lds
    s_add_u32 m0, s35, 106496
    s_mov_b32 s40, 112000
    buffer_load_dwordx4 v6, s[8:11], s40 offen lds
    s_add_u32 m0, s35, 110592
    s_mov_b32 s41, 1408
    buffer_load_dwordx4 v7, s[12:15], s41 offen lds
    s_add_u32 m0, s35, 114688
    s_mov_b32 s41, 112000
    buffer_load_dwordx4 v7, s[12:15], s41 offen lds
    s_add_u32 m0, s35, 118784
    s_mov_b32 s41, 222592
    buffer_load_dwordx4 v7, s[12:15], s41 offen lds
    s_waitcnt vmcnt(15)
    s_barrier
    s_add_u32 m0, s35, 0
    s_mov_b32 s40, 1536
    buffer_load_dwordx4 v6, s[8:11], s40 offen lds
    s_add_u32 m0, s35, 4096
    s_mov_b32 s40, 112128
    buffer_load_dwordx4 v6, s[8:11], s40 offen lds
    s_add_u32 m0, s35, 8192
    s_mov_b32 s41, 1536
    buffer_load_dwordx4 v7, s[12:15], s41 offen lds
    s_add_u32 m0, s35, 12288
    s_mov_b32 s41, 112128
    buffer_load_dwordx4 v7, s[12:15], s41 offen lds
    s_add_u32 m0, s35, 16384
    s_mov_b32 s41, 222720
    buffer_load_dwordx4 v7, s[12:15], s41 offen lds
    s_waitcnt vmcnt(15)
    s_barrier
    s_add_u32 m0, s35, 20480
    s_mov_b32 s40, 1664
    buffer_load_dwordx4 v6, s[8:11], s40 offen lds
    s_add_u32 m0, s35, 24576
    s_mov_b32 s40, 112256
    buffer_load_dwordx4 v6, s[8:11], s40 offen lds
    s_add_u32 m0, s35, 28672
    s_mov_b32 s41, 1664
    buffer_load_dwordx4 v7, s[12:15], s41 offen lds
    s_add_u32 m0, s35, 32768
    s_mov_b32 s41, 112256
    buffer_load_dwordx4 v7, s[12:15], s41 offen lds
    s_add_u32 m0, s35, 36864
    s_mov_b32 s41, 222848
    buffer_load_dwordx4 v7, s[12:15], s41 offen lds
    s_waitcnt vmcnt(15)
    s_barrier
    s_add_u32 m0, s35, 40960
    s_mov_b32 s40, 1792
    buffer_load_dwordx4 v6, s[8:11], s40 offen lds
    s_add_u32 m0, s35, 45056
    s_mov_b32 s40, 112384
    buffer_load_dwordx4 v6, s[8:11], s40 offen lds
    s_add_u32 m0, s35, 49152
    s_mov_b32 s41, 1792
    buffer_load_dwordx4 v7, s[12:15], s41 offen lds
    s_add_u32 m0, s35, 53248
    s_mov_b32 s41, 112384
    buffer_load_dwordx4 v7, s[12:15], s41 offen lds
    s_add_u32 m0, s35, 57344
    s_mov_b32 s41, 222976
    buffer_load_dwordx4 v7, s[12:15], s41 offen lds
    s_waitcnt vmcnt(15)
    s_barrier
    s_add_u32 m0, s35, 61440
    s_mov_b32 s40, 1920
    buffer_load_dwordx4 v6, s[8:11], s40 offen lds
    s_add_u32 m0, s35, 65536
    s_mov_b32 s40, 112512
    buffer_load_dwordx4 v6, s[8:11], s40 offen lds
    s_add_u32 m0, s35, 69632
    s_mov_b32 s41, 1920
    buffer_load_dwordx4 v7, s[12:15], s41 offen lds
    s_add_u32 m0, s35, 73728
    s_mov_b32 s41, 112512
    buffer_load_dwordx4 v7, s[12:15], s41 offen lds
    s_add_u32 m0, s35, 77824
    s_mov_b32 s41, 223104
    buffer_load_dwordx4 v7, s[12:15], s41 offen lds
    s_waitcnt vmcnt(15)
    s_barrier
    s_add_u32 m0, s35, 81920
    s_mov_b32 s40, 2048
    buffer_load_dwordx4 v6, s[8:11], s40 offen lds
    s_add_u32 m0, s35, 86016
    s_mov_b32 s40, 112640
    buffer_load_dwordx4 v6, s[8:11], s40 offen lds
    s_add_u32 m0, s35, 90112
    s_mov_b32 s41, 2048
    buffer_load_dwordx4 v7, s[12:15], s41 offen lds
    s_add_u32 m0, s35, 94208
    s_mov_b32 s41, 112640
    buffer_load_dwordx4 v7, s[12:15], s41 offen lds
    s_add_u32 m0, s35, 98304
    s_mov_b32 s41, 223232
    buffer_load_dwordx4 v7, s[12:15], s41 offen lds
    s_waitcnt vmcnt(15)
    s_barrier
    s_add_u32 m0, s35, 102400
    s_mov_b32 s40, 2176
    buffer_load_dwordx4 v6, s[8:11], s40 offen lds
    s_add_u32 m0, s35, 106496
    s_mov_b32 s40, 112768
    buffer_load_dwordx4 v6, s[8:11], s40 offen lds
    s_add_u32 m0, s35, 110592
    s_mov_b32 s41, 2176
    buffer_load_dwordx4 v7, s[12:15], s41 offen lds
    s_add_u32 m0, s35, 114688
    s_mov_b32 s41, 112768
    buffer_load_dwordx4 v7, s[12:15], s41 offen lds
    s_add_u32 m0, s35, 118784
    s_mov_b32 s41, 223360
    buffer_load_dwordx4 v7, s[12:15], s41 offen lds
    s_waitcnt vmcnt(15)
    s_barrier
    s_add_u32 m0, s35, 0
    s_mov_b32 s40, 2304
    buffer_load_dwordx4 v6, s[8:11], s40 offen lds
    s_add_u32 m0, s35, 4096
    s_mov_b32 s40, 112896
    buffer_load_dwordx4 v6, s[8:11], s40 offen lds
    s_add_u32 m0, s35, 8192
    s_mov_b32 s41, 2304
    buffer_load_dwordx4 v7, s[12:15], s41 offen lds
    s_add_u32 m0, s35, 12288
    s_mov_b32 s41, 112896
    buffer_load_dwordx4 v7, s[12:15], s41 offen lds
    s_add_u32 m0, s35, 16384
    s_mov_b32 s41, 223488
    buffer_load_dwordx4 v7, s[12:15], s41 offen lds
    s_waitcnt vmcnt(15)
    s_barrier
    s_add_u32 m0, s35, 20480
    s_mov_b32 s40, 2432
    buffer_load_dwordx4 v6, s[8:11], s40 offen lds
    s_add_u32 m0, s35, 24576
    s_mov_b32 s40, 113024
    buffer_load_dwordx4 v6, s[8:11], s40 offen lds
    s_add_u32 m0, s35, 28672
    s_mov_b32 s41, 2432
    buffer_load_dwordx4 v7, s[12:15], s41 offen lds
    s_add_u32 m0, s35, 32768
    s_mov_b32 s41, 113024
    buffer_load_dwordx4 v7, s[12:15], s41 offen lds
    s_add_u32 m0, s35, 36864
    s_mov_b32 s41, 223616
    buffer_load_dwordx4 v7, s[12:15], s41 offen lds
    s_waitcnt vmcnt(15)
    s_barrier
    s_add_u32 m0, s35, 40960
    s_mov_b32 s40, 2560
    buffer_load_dwordx4 v6, s[8:11], s40 offen lds
    s_add_u32 m0, s35, 45056
    s_mov_b32 s40, 113152
    buffer_load_dwordx4 v6, s[8:11], s40 offen lds
    s_add_u32 m0, s35, 49152
    s_mov_b32 s41, 2560
    buffer_load_dwordx4 v7, s[12:15], s41 offen lds
    s_add_u32 m0, s35, 53248
    s_mov_b32 s41, 113152
    buffer_load_dwordx4 v7, s[12:15], s41 offen lds
    s_add_u32 m0, s35, 57344
    s_mov_b32 s41, 223744
    buffer_load_dwordx4 v7, s[12:15], s41 offen lds
    s_waitcnt vmcnt(15)
    s_barrier
    s_add_u32 m0, s35, 61440
    s_mov_b32 s40, 2688
    buffer_load_dwordx4 v6, s[8:11], s40 offen lds
    s_add_u32 m0, s35, 65536
    s_mov_b32 s40, 113280
    buffer_load_dwordx4 v6, s[8:11], s40 offen lds
    s_add_u32 m0, s35, 69632
    s_mov_b32 s41, 2688
    buffer_load_dwordx4 v7, s[12:15], s41 offen lds
    s_add_u32 m0, s35, 73728
    s_mov_b32 s41, 113280
    buffer_load_dwordx4 v7, s[12:15], s41 offen lds
    s_add_u32 m0, s35, 77824
    s_mov_b32 s41, 223872
    buffer_load_dwordx4 v7, s[12:15], s41 offen lds
    s_waitcnt vmcnt(15)
    s_barrier
    s_add_u32 m0, s35, 81920
    s_mov_b32 s40, 2816
    buffer_load_dwordx4 v6, s[8:11], s40 offen lds
    s_add_u32 m0, s35, 86016
    s_mov_b32 s40, 113408
    buffer_load_dwordx4 v6, s[8:11], s40 offen lds
    s_add_u32 m0, s35, 90112
    s_mov_b32 s41, 2816
    buffer_load_dwordx4 v7, s[12:15], s41 offen lds
    s_add_u32 m0, s35, 94208
    s_mov_b32 s41, 113408
    buffer_load_dwordx4 v7, s[12:15], s41 offen lds
    s_add_u32 m0, s35, 98304
    s_mov_b32 s41, 224000
    buffer_load_dwordx4 v7, s[12:15], s41 offen lds
    s_waitcnt vmcnt(15)
    s_barrier
    s_add_u32 m0, s35, 102400
    s_mov_b32 s40, 2944
    buffer_load_dwordx4 v6, s[8:11], s40 offen lds
    s_add_u32 m0, s35, 106496
    s_mov_b32 s40, 113536
    buffer_load_dwordx4 v6, s[8:11], s40 offen lds
    s_add_u32 m0, s35, 110592
    s_mov_b32 s41, 2944
    buffer_load_dwordx4 v7, s[12:15], s41 offen lds
    s_add_u32 m0, s35, 114688
    s_mov_b32 s41, 113536
    buffer_load_dwordx4 v7, s[12:15], s41 offen lds
    s_add_u32 m0, s35, 118784
    s_mov_b32 s41, 224128
    buffer_load_dwordx4 v7, s[12:15], s41 offen lds
    s_waitcnt vmcnt(15)
    s_barrier
    s_add_u32 m0, s35, 0
    s_mov_b32 s40, 3072
    buffer_load_dwordx4 v6, s[8:11], s40 offen lds
    s_add_u32 m0, s35, 4096
    s_mov_b32 s40, 113664
    buffer_load_dwordx4 v6, s[8:11], s40 offen lds
    s_add_u32 m0, s35, 8192
    s_mov_b32 s41, 3072
    buffer_load_dwordx4 v7, s[12:15], s41 offen lds
    s_add_u32 m0, s35, 12288
    s_mov_b32 s41, 113664
    buffer_load_dwordx4 v7, s[12:15], s41 offen lds
    s_add_u32 m0, s35, 16384
    s_mov_b32 s41, 224256
    buffer_load_dwordx4 v7, s[12:15], s41 offen lds
    s_waitcnt vmcnt(15)
    s_barrier
    s_add_u32 m0, s35, 20480
    s_mov_b32 s40, 3200
    buffer_load_dwordx4 v6, s[8:11], s40 offen lds
    s_add_u32 m0, s35, 24576
    s_mov_b32 s40, 113792
    buffer_load_dwordx4 v6, s[8:11], s40 offen lds
    s_add_u32 m0, s35, 28672
    s_mov_b32 s41, 3200
    buffer_load_dwordx4 v7, s[12:15], s41 offen lds
    s_add_u32 m0, s35, 32768
    s_mov_b32 s41, 113792
    buffer_load_dwordx4 v7, s[12:15], s41 offen lds
    s_add_u32 m0, s35, 36864
    s_mov_b32 s41, 224384
    buffer_load_dwordx4 v7, s[12:15], s41 offen lds
    s_waitcnt vmcnt(15)
    s_barrier
    s_add_u32 m0, s35, 40960
    s_mov_b32 s40, 3328
    buffer_load_dwordx4 v6, s[8:11], s40 offen lds
    s_add_u32 m0, s35, 45056
    s_mov_b32 s40, 113920
    buffer_load_dwordx4 v6, s[8:11], s40 offen lds
    s_add_u32 m0, s35, 49152
    s_mov_b32 s41, 3328
    buffer_load_dwordx4 v7, s[12:15], s41 offen lds
    s_add_u32 m0, s35, 53248
    s_mov_b32 s41, 113920
    buffer_load_dwordx4 v7, s[12:15], s41 offen lds
    s_add_u32 m0, s35, 57344
    s_mov_b32 s41, 224512
    buffer_load_dwordx4 v7, s[12:15], s41 offen lds
    s_waitcnt vmcnt(15)
    s_barrier
    s_waitcnt vmcnt(10)
    s_barrier
    s_waitcnt vmcnt(5)
    s_barrier
    s_waitcnt vmcnt(0)
    s_barrier
    s_barrier
    s_endpgm
k5_ld2:
    s_add_u32 m0, s35, 0
    s_mov_b32 s40, 0
    buffer_load_dwordx4 v6, s[8:11], s40 offen lds
    s_add_u32 m0, s35, 4096
    s_mov_b32 s40, 110592
    buffer_load_dwordx4 v6, s[8:11], s40 offen lds
    s_add_u32 m0, s35, 8192
    s_mov_b32 s41, 0
    buffer_load_dwordx4 v7, s[12:15], s41 offen lds
    s_add_u32 m0, s35, 12288
    s_mov_b32 s41, 110592
    buffer_load_dwordx4 v7, s[12:15], s41 offen lds
    s_add_u32 m0, s35, 20480
    s_mov_b32 s40, 128
    buffer_load_dwordx4 v6, s[8:11], s40 offen lds
    s_add_u32 m0, s35, 24576
    s_mov_b32 s40, 110720
    buffer_load_dwordx4 v6, s[8:11], s40 offen lds
    s_add_u32 m0, s35, 28672
    s_mov_b32 s41, 128
    buffer_load_dwordx4 v7, s[12:15], s41 offen lds
    s_add_u32 m0, s35, 32768
    s_mov_b32 s41, 110720
    buffer_load_dwordx4 v7, s[12:15], s41 offen lds
    s_waitcnt vmcnt(4)
    s_barrier
    s_waitcnt vmcnt(0)
    s_barrier
    s_add_u32 m0, s35, 40960
    s_mov_b32 s40, 256
    buffer_load_dwordx4 v6, s[8:11], s40 offen lds
    s_add_u32 m0, s35, 45056
    s_mov_b32 s40, 110848
    buffer_load_dwordx4 v6, s[8:11], s40 offen lds
    s_add_u32 m0, s35, 49152
    s_mov_b32 s41, 256
    buffer_load_dwordx4 v7, s[12:15], s41 offen lds
    s_add_u32 m0, s35, 53248
    s_mov_b32 s41, 110848
    buffer_load_dwordx4 v7, s[12:15], s41 offen lds
    s_add_u32 m0, s35, 61440
    s_mov_b32 s40, 384
    buffer_load_dwordx4 v6, s[8:11], s40 offen lds
    s_add_u32 m0, s35, 65536
    s_mov_b32 s40, 110976
    buffer_load_dwordx4 v6, s[8:11], s40 offen lds
    s_add_u32 m0, s35, 69632
    s_mov_b32 s41, 384
    buffer_load_dwordx4 v7, s[12:15], s41 offen lds
    s_add_u32 m0, s35, 73728
    s_mov_b32 s41, 110976
    buffer_load_dwordx4 v7, s[12:15], s41 offen lds
    s_waitcnt vmcnt(4)
    s_barrier
    s_add_u32 m0, s35, 81920
    s_mov_b32 s40, 512
    buffer_load_dwordx4 v6, s[8:11], s40 offen lds
    s_add_u32 m0, s35, 86016
    s_mov_b32 s40, 111104
    buffer_load_dwordx4 v6, s[8:11], s40 offen lds
    s_add_u32 m0, s35, 90112
    s_mov_b32 s41, 512
    buffer_load_dwordx4 v7, s[12:15], s41 offen lds
    s_add_u32 m0, s35, 94208
    s_mov_b32 s41, 111104
    buffer_load_dwordx4 v7, s[12:15], s41 offen lds
    s_add_u32 m0, s35, 102400
    s_mov_b32 s40, 640
    buffer_load_dwordx4 v6, s[8:11], s40 offen lds
    s_add_u32 m0, s35, 106496
    s_mov_b32 s40, 111232
    buffer_load_dwordx4 v6, s[8:11], s40 offen lds
    s_add_u32 m0, s35, 110592
    s_mov_b32 s41, 640
    buffer_load_dwordx4 v7, s[12:15], s41 offen lds
    s_add_u32 m0, s35, 114688
    s_mov_b32 s41, 111232
    buffer_load_dwordx4 v7, s[12:15], s41 offen lds
    s_waitcnt vmcnt(8)
    s_barrier
    s_add_u32 m0, s35, 0
    s_mov_b32 s40, 768
    buffer_load_dwordx4 v6, s[8:11], s40 offen lds
    s_add_u32 m0, s35, 4096
    s_mov_b32 s40, 111360
    buffer_load_dwordx4 v6, s[8:11], s40 offen lds
    s_add_u32 m0, s35, 8192
    s_mov_b32 s41, 768
    buffer_load_dwordx4 v7, s[12:15], s41 offen lds
    s_add_u32 m0, s35, 12288
    s_mov_b32 s41, 111360
    buffer_load_dwordx4 v7, s[12:15], s41 offen lds
    s_add_u32 m0, s35, 20480
    s_mov_b32 s40, 896
    buffer_load_dwordx4 v6, s[8:11], s40 offen lds
    s_add_u32 m0, s35, 24576
    s_mov_b32 s40, 111488
    buffer_load_dwordx4 v6, s[8:11], s40 offen lds
    s_add_u32 m0, s35, 28672
    s_mov_b32 s41, 896
    buffer_load_dwordx4 v7, s[12:15], s41 offen lds
    s_add_u32 m0, s35, 32768
    s_mov_b32 s41, 111488
    buffer_load_dwordx4 v7, s[12:15], s41 offen lds
    s_waitcnt vmcnt(12)
    s_barrier
    s_add_u32 m0, s35, 40960
    s_mov_b32 s40, 1024
    buffer_load_dwordx4 v6, s[8:11], s40 offen lds
    s_add_u32 m0, s35, 45056
    s_mov_b32 s40, 111616
    buffer_load_dwordx4 v6, s[8:11], s40 offen lds
    s_add_u32 m0, s35, 49152
    s_mov_b32 s41, 1024
    buffer_load_dwordx4 v7, s[12:15], s41 offen lds
    s_add_u32 m0, s35, 53248
    s_mov_b32 s41, 111616
    buffer_load_dwordx4 v7, s[12:15], s41 offen lds
    s_waitcnt vmcnt(12)
    s_barrier
    s_add_u32 m0, s35, 61440
    s_mov_b32 s40, 1152
    buffer_load_dwordx4 v6, s[8:11], s40 offen lds
    s_add_u32 m0, s35, 65536
    s_mov_b32 s40, 111744
    buffer_load_dwordx4 v6, s[8:11], s40 offen lds
    s_add_u32 m0, s35, 69632
    s_mov_b32 s41, 1152
    buffer_load_dwordx4 v7, s[12:15], s41 offen lds
    s_add_u32 m0, s35, 73728
    s_mov_b32 s41, 111744
    buffer_load_dwordx4 v7, s[12:15], s41 offen lds
    s_waitcnt vmcnt(12)
    s_barrier
    s_add_u32 m0, s35, 81920
    s_mov_b32 s40, 1280
    buffer_load_dwordx4 v6, s[8:11], s40 offen lds
    s_add_u32 m0, s35, 86016
    s_mov_b32 s40, 111872
    buffer_load_dwordx4 v6, s[8:11], s40 offen lds
    s_add_u32 m0, s35, 90112
    s_mov_b32 s41, 1280
    buffer_load_dwordx4 v7, s[12:15], s41 offen lds
    s_add_u32 m0, s35, 94208
    s_mov_b32 s41, 111872
    buffer_load_dwordx4 v7, s[12:15], s41 offen lds
    s_waitcnt vmcnt(12)
    s_barrier
    s_add_u32 m0, s35, 102400
    s_mov_b32 s40, 1408
    buffer_load_dwordx4 v6, s[8:11], s40 offen lds
    s_add_u32 m0, s35, 106496
    s_mov_b32 s40, 112000
    buffer_load_dwordx4 v6, s[8:11], s40 offen lds
    s_add_u32 m0, s35, 110592
    s_mov_b32 s41, 1408
    buffer_load_dwordx4 v7, s[12:15], s41 offen lds
    s_add_u32 m0, s35, 114688
    s_mov_b32 s41, 112000
    buffer_load_dwordx4 v7, s[12:15], s41 offen lds
    s_waitcnt vmcnt(12)
    s_barrier
    s_add_u32 m0, s35, 0
    s_mov_b32 s40, 1536
    buffer_load_dwordx4 v6, s[8:11], s40 offen lds
    s_add_u32 m0, s35, 4096
    s_mov_b32 s40, 112128
    buffer_load_dwordx4 v6, s[8:11], s40 offen lds
    s_add_u32 m0, s35, 8192
    s_mov_b32 s41, 1536
    buffer_load_dwordx4 v7, s[12:15], s41 offen lds
    s_add_u32 m0, s35, 12288
    s_mov_b32 s41, 112128
    buffer_load_dwordx4 v7, s[12:15], s41 offen lds
    s_waitcnt vmcnt(12)
    s_barrier
    s_add_u32 m0, s35, 20480
    s_mov_b32 s40, 1664
    buffer_load_dwordx4 v6, s[8:11], s40 offen lds
    s_add_u32 m0, s35, 24576
    s_mov_b32 s40, 112256
    buffer_load_dwordx4 v6, s[8:11], s40 offen lds
    s_add_u32 m0, s35, 28672
    s_mov_b32 s41, 1664
    buffer_load_dwordx4 v7, s[12:15], s41 offen lds
    s_add_u32 m0, s35, 32768
    s_mov_b32 s41, 112256
    buffer_load_dwordx4 v7, s[12:15], s41 offen lds
    s_waitcnt vmcnt(12)
    s_barrier
    s_add_u32 m0, s35, 40960
    s_mov_b32 s40, 1792
    buffer_load_dwordx4 v6, s[8:11], s40 offen lds
    s_add_u32 m0, s35, 45056
    s_mov_b32 s40, 112384
    buffer_load_dwordx4 v6, s[8:11], s40 offen lds
    s_add_u32 m0, s35, 49152
    s_mov_b32 s41, 1792
    buffer_load_dwordx4 v7, s[12:15], s41 offen lds
    s_add_u32 m0, s35, 53248
    s_mov_b32 s41, 112384
    buffer_load_dwordx4 v7, s[12:15], s41 offen lds
    s_waitcnt vmcnt(12)
    s_barrier
    s_add_u32 m0, s35, 61440
    s_mov_b32 s40, 1920
    buffer_load_dwordx4 v6, s[8:11], s40 offen lds
    s_add_u32 m0, s35, 65536
    s_mov_b32 s40, 112512
    buffer_load_dwordx4 v6, s[8:11], s40 offen lds
    s_add_u32 m0, s35, 69632
    s_mov_b32 s41, 1920
    buffer_load_dwordx4 v7, s[12:15], s41 offen lds
    s_add_u32 m0, s35, 73728
    s_mov_b32 s41, 112512
    buffer_load_dwordx4 v7, s[12:15], s41 offen lds
    s_waitcnt vmcnt(12)
    s_barrier
    s_add_u32 m0, s35, 81920
    s_mov_b32 s40, 2048
    buffer_load_dwordx4 v6, s[8:11], s40 offen lds
    s_add_u32 m0, s35, 86016
    s_mov_b32 s40, 112640
    buffer_load_dwordx4 v6, s[8:11], s40 offen lds
    s_add_u32 m0, s35, 90112
    s_mov_b32 s41, 2048
    buffer_load_dwordx4 v7, s[12:15], s41 offen lds
    s_add_u32 m0, s35, 94208
    s_mov_b32 s41, 112640
    buffer_load_dwordx4 v7, s[12:15], s41 offen lds
    s_waitcnt vmcnt(12)
    s_barrier
    s_add_u32 m0, s35, 102400
    s_mov_b32 s40, 2176
    buffer_load_dwordx4 v6, s[8:11], s40 offen lds
    s_add_u32 m0, s35, 106496
    s_mov_b32 s40, 112768
    buffer_load_dwordx4 v6, s[8:11], s40 offen lds
    s_add_u32 m0, s35, 110592
    s_mov_b32 s41, 2176
    buffer_load_dwordx4 v7, s[12:15], s41 offen lds
    s_add_u32 m0, s35, 114688
    s_mov_b32 s41, 112768
    buffer_load_dwordx4 v7, s[12:15], s41 offen lds
    s_waitcnt vmcnt(12)
    s_barrier
    s_add_u32 m0, s35, 0
    s_mov_b32 s40, 2304
    buffer_load_dwordx4 v6, s[8:11], s40 offen lds
    s_add_u32 m0, s35, 4096
    s_mov_b32 s40, 112896
    buffer_load_dwordx4 v6, s[8:11], s40 offen lds
    s_add_u32 m0, s35, 8192
    s_mov_b32 s41, 2304
    buffer_load_dwordx4 v7, s[12:15], s41 offen lds
    s_add_u32 m0, s35, 12288
    s_mov_b32 s41, 112896
    buffer_load_dwordx4 v7, s[12:15], s41 offen lds
    s_waitcnt vmcnt(12)
    s_barrier
    s_add_u32 m0, s35, 20480
    s_mov_b32 s40, 2432
    buffer_load_dwordx4 v6, s[8:11], s40 offen lds
    s_add_u32 m0, s35, 24576
    s_mov_b32 s40, 113024
    buffer_load_dwordx4 v6, s[8:11], s40 offen lds
    s_add_u32 m0, s35, 28672
    s_mov_b32 s41, 2432
    buffer_load_dwordx4 v7, s[12:15], s41 offen lds
    s_add_u32 m0, s35, 32768
    s_mov_b32 s41, 113024
    buffer_load_dwordx4 v7, s[12:15], s41 offen lds
    s_waitcnt vmcnt(12)
    s_barrier
    s_add_u32 m0, s35, 40960
    s_mov_b32 s40, 2560
    buffer_load_dwordx4 v6, s[8:11], s40 offen lds
    s_add_u32 m0, s35, 45056
    s_mov_b32 s40, 113152
    buffer_load_dwordx4 v6, s[8:11], s40 offen lds
    s_add_u32 m0, s35, 49152
    s_mov_b32 s41, 2560
    buffer_load_dwordx4 v7, s[12:15], s41 offen lds
    s_add_u32 m0, s35, 53248
    s_mov_b32 s41, 113152
    buffer_load_dwordx4 v7, s[12:15], s41 offen lds
    s_waitcnt vmcnt(12)
    s_barrier
    s_add_u32 m0, s35, 61440
    s_mov_b32 s40, 2688
    buffer_load_dwordx4 v6, s[8:11], s40 offen lds
    s_add_u32 m0, s35, 65536
    s_mov_b32 s40, 113280
    buffer_load_dwordx4 v6, s[8:11], s40 offen lds
    s_add_u32 m0, s35, 69632
    s_mov_b32 s41, 2688
    buffer_load_dwordx4 v7, s[12:15], s41 offen lds
    s_add_u32 m0, s35, 73728
    s_mov_b32 s41, 113280
    buffer_load_dwordx4 v7, s[12:15], s41 offen lds
    s_waitcnt vmcnt(12)
    s_barrier
    s_add_u32 m0, s35, 81920
    s_mov_b32 s40, 2816
    buffer_load_dwordx4 v6, s[8:11], s40 offen lds
    s_add_u32 m0, s35, 86016
    s_mov_b32 s40, 113408
    buffer_load_dwordx4 v6, s[8:11], s40 offen lds
    s_add_u32 m0, s35, 90112
    s_mov_b32 s41, 2816
    buffer_load_dwordx4 v7, s[12:15], s41 offen lds
    s_add_u32 m0, s35, 94208
    s_mov_b32 s41, 113408
    buffer_load_dwordx4 v7, s[12:15], s41 offen lds
    s_waitcnt vmcnt(12)
    s_barrier
    s_add_u32 m0, s35, 102400
    s_mov_b32 s40, 2944
    buffer_load_dwordx4 v6, s[8:11], s40 offen lds
    s_add_u32 m0, s35, 106496
    s_mov_b32 s40, 113536
    buffer_load_dwordx4 v6, s[8:11], s40 offen lds
    s_add_u32 m0, s35, 110592
    s_mov_b32 s41, 2944
    buffer_load_dwordx4 v7, s[12:15], s41 offen lds
    s_add_u32 m0, s35, 114688
    s_mov_b32 s41, 113536
    buffer_load_dwordx4 v7, s[12:15], s41 offen lds
    s_waitcnt vmcnt(12)
    s_barrier
    s_add_u32 m0, s35, 0
    s_mov_b32 s40, 3072
    buffer_load_dwordx4 v6, s[8:11], s40 offen lds
    s_add_u32 m0, s35, 4096
    s_mov_b32 s40, 113664
    buffer_load_dwordx4 v6, s[8:11], s40 offen lds
    s_add_u32 m0, s35, 8192
    s_mov_b32 s41, 3072
    buffer_load_dwordx4 v7, s[12:15], s41 offen lds
    s_add_u32 m0, s35, 12288
    s_mov_b32 s41, 113664
    buffer_load_dwordx4 v7, s[12:15], s41 offen lds
    s_waitcnt vmcnt(12)
    s_barrier
    s_add_u32 m0, s35, 20480
    s_mov_b32 s40, 3200
    buffer_load_dwordx4 v6, s[8:11], s40 offen lds
    s_add_u32 m0, s35, 24576
    s_mov_b32 s40, 113792
    buffer_load_dwordx4 v6, s[8:11], s40 offen lds
    s_add_u32 m0, s35, 28672
    s_mov_b32 s41, 3200
    buffer_load_dwordx4 v7, s[12:15], s41 offen lds
    s_add_u32 m0, s35, 32768
    s_mov_b32 s41, 113792
    buffer_load_dwordx4 v7, s[12:15], s41 offen lds
    s_waitcnt vmcnt(12)
    s_barrier
    s_add_u32 m0, s35, 40960
    s_mov_b32 s40, 3328
    buffer_load_dwordx4 v6, s[8:11], s40 offen lds
    s_add_u32 m0, s35, 45056
    s_mov_b32 s40, 113920
    buffer_load_dwordx4 v6, s[8:11], s40 offen lds
    s_add_u32 m0, s35, 49152
    s_mov_b32 s41, 3328
    buffer_load_dwordx4 v7, s[12:15], s41 offen lds
    s_add_u32 m0, s35, 53248
    s_mov_b32 s41, 113920
    buffer_load_dwordx4 v7, s[12:15], s41 offen lds
    s_waitcnt vmcnt(12)
    s_barrier
    s_waitcnt vmcnt(8)
    s_barrier
    s_waitcnt vmcnt(4)
    s_barrier
    s_waitcnt vmcnt(0)
    s_barrier
    s_barrier
    s_endpgm
k5_cons:
    v_and_b32 v3, 15, v2
    v_lshrrev_b32 v4, 4, v2
    v_lshrrev_b32 v8, 1, v3
    v_xor_b32 v8, v8, v4
    v_lshlrev_b32 v5, 7, v3
    v_lshl_add_u32 v5, v8, 4, v5
    s_mul_i32 s33, s3, 2048
    s_add_u32 s34, s33, 0
    v_add_u32 v8, s34, v5
    v_xor_b32 v9, 64, v8
    v_add_u32 v20, 0x2000, v5
    v_xor_b32 v21, 64, v20
    s_add_u32 s34, s33, 20480
    v_add_u32 v10, s34, v5
    v_xor_b32 v11, 64, v10
    v_add_u32 v22, 0x7000, v5
    v_xor_b32 v23, 64, v22
    s_add_u32 s34, s33, 40960
    v_add_u32 v12, s34, v5
    v_xor_b32 v13, 64, v12
    v_add_u32 v24, 0xc000, v5
    v_xor_b32 v25, 64, v24
    s_add_u32 s34, s33, 61440
    v_add_u32 v14, s34, v5
    v_xor_b32 v15, 64, v14
    v_add_u32 v26, 0x11000, v5
    v_xor_b32 v27, 64, v26
    s_add_u32 s34, s33, 81920
    v_add_u32 v16, s34, v5
    v_xor_b32 v17, 64, v16
    v_add_u32 v28, 0x16000, v5
    v_xor_b32 v29, 64, v28
    s_add_u32 s34, s33, 102400
    v_add_u32 v18, s34, v5
    v_xor_b32 v19, 64, v18
    v_add_u32 v30, 0x1b000, v5
    v_xor_b32 v31, 64, v30
    v_lshl_add_u32 v32, v4, 2, s32
    v_lshlrev_b32 v32, 1, v32
    buffer_load_dwordx2 v[34:35], v32, s[16:19], 0 offen offset:0
    buffer_load_dwordx2 v[36:37], v32, s[16:19], 0 offen offset:32
    buffer_load_dwordx2 v[38:39], v32, s[16:19], 0 offen offset:64
    buffer_load_dwordx2 v[40:41], v32, s[16:19], 0 offen offset:96
    buffer_load_dwordx2 v[42:43], v32, s[16:19], 0 offen offset:128
    s_mul_i32 s33, s3, 16
    s_add_u32 s33, s33, s31
    v_add_u32 v33, s33, v3
    v_mul_u32_u24 v33, 1280, v33
    v_add_u32 v33, v33, v32
    s_mov_b32 s42, 0
    buffer_load_dwordx2 v[44:45], v33, s[24:27], s42 offen offset:0
    s_mov_b32 s42, 0
    buffer_load_dwordx2 v[46:47], v33, s[24:27], s42 offen offset:32
    s_mov_b32 s42, 0
    buffer_load_dwordx2 v[48:49], v33, s[24:27], s42 offen offset:64
    s_mov_b32 s42, 0
    buffer_load_dwordx2 v[50:51], v33, s[24:27], s42 offen offset:96
    s_mov_b32 s42, 0
    buffer_load_dwordx2 v[52:53], v33, s[24:27], s42 offen offset:128
    v_mov_b32 v56, 0
    v_mov_b32 v57, 0
    v_mov_b32 v58, 0
    v_mov_b32 v59, 0
    v_mov_b32 v60, 0
    v_mov_b32 v61, 0
    v_mov_b32 v62, 0
    v_mov_b32 v63, 0
    v_mov_b32 v64, 0
    v_mov_b32 v65, 0
    v_mov_b32 v66, 0
    v_mov_b32 v67, 0
    v_mov_b32 v68, 0
    v_mov_b32 v69, 0
    v_mov_b32 v70, 0
    v_mov_b32 v71, 0
    v_mov_b32 v72, 0
    v_mov_b32 v73, 0
    v_mov_b32 v74, 0
    v_mov_b32 v75, 0
    s_barrier
    ds_read_b128 v[116:119], v8 offset:0
    ds_read_b128 v[76:79], v20 offset:0
    ds_read_b128 v[80:83], v20 offset:2048
    ds_read_b128 v[84:87], v20 offset:4096
    ds_read_b128 v[88:91], v20 offset:6144
    ds_read_b128 v[92:95], v20 offset:8192
    s_barrier
    ds_read_b128 v[120:123], v9 offset:0
    ds_read_b128 v[96:99], v21 offset:0
    ds_read_b128 v[100:103], v21 offset:2048
    ds_read_b128 v[104:107], v21 offset:4096
    ds_read_b128 v[108:111], v21 offset:6144
    ds_read_b128 v[112:115], v21 offset:8192
    s_waitcnt lgkmcnt(6)
    v_mfma_f32_16x16x32_bf16 v[56:59], v[76:79], v[116:119], v[56:59]
    v_mfma_f32_16x16x32_bf16 v[60:63], v[80:83], v[116:119], v[60:63]
    v_mfma_f32_16x16x32_bf16 v[64:67], v[84:87], v[116:119], v[64:67]
    v_mfma_f32_16x16x32_bf16 v[68:71], v[88:91], v[116:119], v[68:71]
    v_mfma_f32_16x16x32_bf16 v[72:75], v[92:95], v[116:119], v[72:75]
    ds_read_b128 v[116:119], v10 offset:0
    ds_read_b128 v[76:79], v22 offset:0
    ds_read_b128 v[80:83], v22 offset:2048
    ds_read_b128 v[84:87], v22 offset:4096
    ds_read_b128 v[88:91], v22 offset:6144
    ds_read_b128 v[92:95], v22 offset:8192
    s_waitcnt lgkmcnt(6)
    v_mfma_f32_16x16x32_bf16 v[56:59], v[96:99], v[120:123], v[56:59]
    v_mfma_f32_16x16x32_bf16 v[60:63], v[100:103], v[120:123], v[60:63]
    v_mfma_f32_16x16x32_bf16 v[64:67], v[104:107], v[120:123], v[64:67]
    v_mfma_f32_16x16x32_bf16 v[68:71], v[108:111], v[120:123], v[68:71]
    v_mfma_f32_16x16x32_bf16 v[72:75], v[112:115], v[120:123], v[72:75]
    s_barrier
    ds_read_b128 v[120:123], v11 offset:0
    ds_read_b128 v[96:99], v23 offset:0
    ds_read_b128 v[100:103], v23 offset:2048
    ds_read_b128 v[104:107], v23 offset:4096
    ds_read_b128 v[108:111], v23 offset:6144
    ds_read_b128 v[112:115], v23 offset:8192
    s_waitcnt lgkmcnt(6)
    v_mfma_f32_16x16x32_bf16 v[56:59], v[76:79], v[116:119], v[56:59]
    v_mfma_f32_16x16x32_bf16 v[60:63], v[80:83], v[116:119], v[60:63]
    v_mfma_f32_16x16x32_bf16 v[64:67], v[84:87], v[116:119], v[64:67]
    v_mfma_f32_16x16x32_bf16 v[68:71], v[88:91], v[116:119], v[68:71]
    v_mfma_f32_16x16x32_bf16 v[72:75], v[92:95], v[116:119], v[72:75]
    ds_read_b128 v[116:119], v12 offset:0
    ds_read_b128 v[76:79], v24 offset:0
    ds_read_b128 v[80:83], v24 offset:2048
    ds_read_b128 v[84:87], v24 offset:4096
    ds_read_b128 v[88:91], v24 offset:6144
    ds_read_b128 v[92:95], v24 offset:8192
    s_waitcnt lgkmcnt(6)
    v_mfma_f32_16x16x32_bf16 v[56:59], v[96:99], v[120:123], v[56:59]
    v_mfma_f32_16x16x32_bf16 v[60:63], v[100:103], v[120:123], v[60:63]
    v_mfma_f32_16x16x32_bf16 v[64:67], v[104:107], v[120:123], v[64:67]
    v_mfma_f32_16x16x32_bf16 v[68:71], v[108:111], v[120:123], v[68:71]
    v_mfma_f32_16x16x32_bf16 v[72:75], v[112:115], v[120:123], v[72:75]
    s_barrier
    ds_read_b128 v[120:123], v13 offset:0
    ds_read_b128 v[96:99], v25 offset:0
    ds_read_b128 v[100:103], v25 offset:2048
    ds_read_b128 v[104:107], v25 offset:4096
    ds_read_b128 v[108:111], v25 offset:6144
    ds_read_b128 v[112:115], v25 offset:8192
    s_waitcnt lgkmcnt(6)
    v_mfma_f32_16x16x32_bf16 v[56:59], v[76:79], v[116:119], v[56:59]
    v_mfma_f32_16x16x32_bf16 v[60:63], v[80:83], v[116:119], v[60:63]
    v_mfma_f32_16x16x32_bf16 v[64:67], v[84:87], v[116:119], v[64:67]
    v_mfma_f32_16x16x32_bf16 v[68:71], v[88:91], v[116:119], v[68:71]
    v_mfma_f32_16x16x32_bf16 v[72:75], v[92:95], v[116:119], v[72:75]
    ds_read_b128 v[116:119], v14 offset:0
    ds_read_b128 v[76:79], v26 offset:0
    ds_read_b128 v[80:83], v26 offset:2048
    ds_read_b128 v[84:87], v26 offset:4096
    ds_read_b128 v[88:91], v26 offset:6144
    ds_read_b128 v[92:95], v26 offset:8192
    s_waitcnt lgkmcnt(6)
    v_mfma_f32_16x16x32_bf16 v[56:59], v[96:99], v[120:123], v[56:59]
    v_mfma_f32_16x16x32_bf16 v[60:63], v[100:103], v[120:123], v[60:63]
    v_mfma_f32_16x16x32_bf16 v[64:67], v[104:107], v[120:123], v[64:67]
    v_mfma_f32_16x16x32_bf16 v[68:71], v[108:111], v[120:123], v[68:71]
    v_mfma_f32_16x16x32_bf16 v[72:75], v[112:115], v[120:123], v[72:75]
    s_barrier
    ds_read_b128 v[120:123], v15 offset:0
    ds_read_b128 v[96:99], v27 offset:0
    ds_read_b128 v[100:103], v27 offset:2048
    ds_read_b128 v[104:107], v27 offset:4096
    ds_read_b128 v[108:111], v27 offset:6144
    ds_read_b128 v[112:115], v27 offset:8192
    s_waitcnt lgkmcnt(6)
    v_mfma_f32_16x16x32_bf16 v[56:59], v[76:79], v[116:119], v[56:59]
    v_mfma_f32_16x16x32_bf16 v[60:63], v[80:83], v[116:119], v[60:63]
    v_mfma_f32_16x16x32_bf16 v[64:67], v[84:87], v[116:119], v[64:67]
    v_mfma_f32_16x16x32_bf16 v[68:71], v[88:91], v[116:119], v[68:71]
    v_mfma_f32_16x16x32_bf16 v[72:75], v[92:95], v[116:119], v[72:75]
    ds_read_b128 v[116:119], v16 offset:0
    ds_read_b128 v[76:79], v28 offset:0
    ds_read_b128 v[80:83], v28 offset:2048
    ds_read_b128 v[84:87], v28 offset:4096
    ds_read_b128 v[88:91], v28 offset:6144
    ds_read_b128 v[92:95], v28 offset:8192
    s_waitcnt lgkmcnt(6)
    v_mfma_f32_16x16x32_bf16 v[56:59], v[96:99], v[120:123], v[56:59]
    v_mfma_f32_16x16x32_bf16 v[60:63], v[100:103], v[120:123], v[60:63]
    v_mfma_f32_16x16x32_bf16 v[64:67], v[104:107], v[120:123], v[64:67]
    v_mfma_f32_16x16x32_bf16 v[68:71], v[108:111], v[120:123], v[68:71]
    v_mfma_f32_16x16x32_bf16 v[72:75], v[112:115], v[120:123], v[72:75]
    s_barrier
    ds_read_b128 v[120:123], v17 offset:0
    ds_read_b128 v[96:99], v29 offset:0
    ds_read_b128 v[100:103], v29 offset:2048
    ds_read_b128 v[104:107], v29 offset:4096
    ds_read_b128 v[108:111], v29 offset:6144
    ds_read_b128 v[112:115], v29 offset:8192
    s_waitcnt lgkmcnt(6)
    v_mfma_f32_16x16x32_bf16 v[56:59], v[76:79], v[116:119], v[56:59]
    v_mfma_f32_16x16x32_bf16 v[60:63], v[80:83], v[116:119], v[60:63]
    v_mfma_f32_16x16x32_bf16 v[64:67], v[84:87], v[116:119], v[64:67]
    v_mfma_f32_16x16x32_bf16 v[68:71], v[88:91], v[116:119], v[68:71]
    v_mfma_f32_16x16x32_bf16 v[72:75], v[92:95], v[116:119], v[72:75]
    ds_read_b128 v[116:119], v18 offset:0
    ds_read_b128 v[76:79], v30 offset:0
    ds_read_b128 v[80:83], v30 offset:2048
    ds_read_b128 v[84:87], v30 offset:4096
    ds_read_b128 v[88:91], v30 offset:6144
    ds_read_b128 v[92:95], v30 offset:8192
    s_waitcnt lgkmcnt(6)
    v_mfma_f32_16x16x32_bf16 v[56:59], v[96:99], v[120:123], v[56:59]
    v_mfma_f32_16x16x32_bf16 v[60:63], v[100:103], v[120:123], v[60:63]
    v_mfma_f32_16x16x32_bf16 v[64:67], v[104:107], v[120:123], v[64:67]
    v_mfma_f32_16x16x32_bf16 v[68:71], v[108:111], v[120:123], v[68:71]
    v_mfma_f32_16x16x32_bf16 v[72:75], v[112:115], v[120:123], v[72:75]
    s_barrier
    ds_read_b128 v[120:123], v19 offset:0
    ds_read_b128 v[96:99], v31 offset:0
    ds_read_b128 v[100:103], v31 offset:2048
    ds_read_b128 v[104:107], v31 offset:4096
    ds_read_b128 v[108:111], v31 offset:6144
    ds_read_b128 v[112:115], v31 offset:8192
    s_waitcnt lgkmcnt(6)
    v_mfma_f32_16x16x32_bf16 v[56:59], v[76:79], v[116:119], v[56:59]
    v_mfma_f32_16x16x32_bf16 v[60:63], v[80:83], v[116:119], v[60:63]
    v_mfma_f32_16x16x32_bf16 v[64:67], v[84:87], v[116:119], v[64:67]
    v_mfma_f32_16x16x32_bf16 v[68:71], v[88:91], v[116:119], v[68:71]
    v_mfma_f32_16x16x32_bf16 v[72:75], v[92:95], v[116:119], v[72:75]
    ds_read_b128 v[116:119], v8 offset:0
    ds_read_b128 v[76:79], v20 offset:0
    ds_read_b128 v[80:83], v20 offset:2048
    ds_read_b128 v[84:87], v20 offset:4096
    ds_read_b128 v[88:91], v20 offset:6144
    ds_read_b128 v[92:95], v20 offset:8192
    s_waitcnt lgkmcnt(6)
    v_mfma_f32_16x16x32_bf16 v[56:59], v[96:99], v[120:123], v[56:59]
    v_mfma_f32_16x16x32_bf16 v[60:63], v[100:103], v[120:123], v[60:63]
    v_mfma_f32_16x16x32_bf16 v[64:67], v[104:107], v[120:123], v[64:67]
    v_mfma_f32_16x16x32_bf16 v[68:71], v[108:111], v[120:123], v[68:71]
    v_mfma_f32_16x16x32_bf16 v[72:75], v[112:115], v[120:123], v[72:75]
    s_barrier
    ds_read_b128 v[120:123], v9 offset:0
    ds_read_b128 v[96:99], v21 offset:0
    ds_read_b128 v[100:103], v21 offset:2048
    ds_read_b128 v[104:107], v21 offset:4096
    ds_read_b128 v[108:111], v21 offset:6144
    ds_read_b128 v[112:115], v21 offset:8192
    s_waitcnt lgkmcnt(6)
    v_mfma_f32_16x16x32_bf16 v[56:59], v[76:79], v[116:119], v[56:59]
    v_mfma_f32_16x16x32_bf16 v[60:63], v[80:83], v[116:119], v[60:63]
    v_mfma_f32_16x16x32_bf16 v[64:67], v[84:87], v[116:119], v[64:67]
    v_mfma_f32_16x16x32_bf16 v[68:71], v[88:91], v[116:119], v[68:71]
    v_mfma_f32_16x16x32_bf16 v[72:75], v[92:95], v[116:119], v[72:75]
    ds_read_b128 v[116:119], v10 offset:0
    ds_read_b128 v[76:79], v22 offset:0
    ds_read_b128 v[80:83], v22 offset:2048
    ds_read_b128 v[84:87], v22 offset:4096
    ds_read_b128 v[88:91], v22 offset:6144
    ds_read_b128 v[92:95], v22 offset:8192
    s_waitcnt lgkmcnt(6)
    v_mfma_f32_16x16x32_bf16 v[56:59], v[96:99], v[120:123], v[56:59]
    v_mfma_f32_16x16x32_bf16 v[60:63], v[100:103], v[120:123], v[60:63]
    v_mfma_f32_16x16x32_bf16 v[64:67], v[104:107], v[120:123], v[64:67]
    v_mfma_f32_16x16x32_bf16 v[68:71], v[108:111], v[120:123], v[68:71]
    v_mfma_f32_16x16x32_bf16 v[72:75], v[112:115], v[120:123], v[72:75]
    s_barrier
    ds_read_b128 v[120:123], v11 offset:0
    ds_read_b128 v[96:99], v23 offset:0
    ds_read_b128 v[100:103], v23 offset:2048
    ds_read_b128 v[104:107], v23 offset:4096
    ds_read_b128 v[108:111], v23 offset:6144
    ds_read_b128 v[112:115], v23 offset:8192
    s_waitcnt lgkmcnt(6)
    v_mfma_f32_16x16x32_bf16 v[56:59], v[76:79], v[116:119], v[56:59]
    v_mfma_f32_16x16x32_bf16 v[60:63], v[80:83], v[116:119], v[60:63]
    v_mfma_f32_16x16x32_bf16 v[64:67], v[84:87], v[116:119], v[64:67]
    v_mfma_f32_16x16x32_bf16 v[68:71], v[88:91], v[116:119], v[68:71]
    v_mfma_f32_16x16x32_bf16 v[72:75], v[92:95], v[116:119], v[72:75]
    ds_read_b128 v[116:119], v12 offset:0
    ds_read_b128 v[76:79], v24 offset:0
    ds_read_b128 v[80:83], v24 offset:2048
    ds_read_b128 v[84:87], v24 offset:4096
    ds_read_b128 v[88:91], v24 offset:6144
    ds_read_b128 v[92:95], v24 offset:8192
    s_waitcnt lgkmcnt(6)
    v_mfma_f32_16x16x32_bf16 v[56:59], v[96:99], v[120:123], v[56:59]
    v_mfma_f32_16x16x32_bf16 v[60:63], v[100:103], v[120:123], v[60:63]
    v_mfma_f32_16x16x32_bf16 v[64:67], v[104:107], v[120:123], v[64:67]
    v_mfma_f32_16x16x32_bf16 v[68:71], v[108:111], v[120:123], v[68:71]
    v_mfma_f32_16x16x32_bf16 v[72:75], v[112:115], v[120:123], v[72:75]
    s_barrier
    ds_read_b128 v[120:123], v13 offset:0
    ds_read_b128 v[96:99], v25 offset:0
    ds_read_b128 v[100:103], v25 offset:2048
    ds_read_b128 v[104:107], v25 offset:4096
    ds_read_b128 v[108:111], v25 offset:6144
    ds_read_b128 v[112:115], v25 offset:8192
    s_waitcnt lgkmcnt(6)
    v_mfma_f32_16x16x32_bf16 v[56:59], v[76:79], v[116:119], v[56:59]
    v_mfma_f32_16x16x32_bf16 v[60:63], v[80:83], v[116:119], v[60:63]
    v_mfma_f32_16x16x32_bf16 v[64:67], v[84:87], v[116:119], v[64:67]
    v_mfma_f32_16x16x32_bf16 v[68:71], v[88:91], v[116:119], v[68:71]
    v_mfma_f32_16x16x32_bf16 v[72:75], v[92:95], v[116:119], v[72:75]
    ds_read_b128 v[116:119], v14 offset:0
    ds_read_b128 v[76:79], v26 offset:0
    ds_read_b128 v[80:83], v26 offset:2048
    ds_read_b128 v[84:87], v26 offset:4096
    ds_read_b128 v[88:91], v26 offset:6144
    ds_read_b128 v[92:95], v26 offset:8192
    s_waitcnt lgkmcnt(6)
    v_mfma_f32_16x16x32_bf16 v[56:59], v[96:99], v[120:123], v[56:59]
    v_mfma_f32_16x16x32_bf16 v[60:63], v[100:103], v[120:123], v[60:63]
    v_mfma_f32_16x16x32_bf16 v[64:67], v[104:107], v[120:123], v[64:67]
    v_mfma_f32_16x16x32_bf16 v[68:71], v[108:111], v[120:123], v[68:71]
    v_mfma_f32_16x16x32_bf16 v[72:75], v[112:115], v[120:123], v[72:75]
    s_barrier
    ds_read_b128 v[120:123], v15 offset:0
    ds_read_b128 v[96:99], v27 offset:0
    ds_read_b128 v[100:103], v27 offset:2048
    ds_read_b128 v[104:107], v27 offset:4096
    ds_read_b128 v[108:111], v27 offset:6144
    ds_read_b128 v[112:115], v27 offset:8192
    s_waitcnt lgkmcnt(6)
    v_mfma_f32_16x16x32_bf16 v[56:59], v[76:79], v[116:119], v[56:59]
    v_mfma_f32_16x16x32_bf16 v[60:63], v[80:83], v[116:119], v[60:63]
    v_mfma_f32_16x16x32_bf16 v[64:67], v[84:87], v[116:119], v[64:67]
    v_mfma_f32_16x16x32_bf16 v[68:71], v[88:91], v[116:119], v[68:71]
    v_mfma_f32_16x16x32_bf16 v[72:75], v[92:95], v[116:119], v[72:75]
    ds_read_b128 v[116:119], v16 offset:0
    ds_read_b128 v[76:79], v28 offset:0
    ds_read_b128 v[80:83], v28 offset:2048
    ds_read_b128 v[84:87], v28 offset:4096
    ds_read_b128 v[88:91], v28 offset:6144
    ds_read_b128 v[92:95], v28 offset:8192
    s_waitcnt lgkmcnt(6)
    v_mfma_f32_16x16x32_bf16 v[56:59], v[96:99], v[120:123], v[56:59]
    v_mfma_f32_16x16x32_bf16 v[60:63], v[100:103], v[120:123], v[60:63]
    v_mfma_f32_16x16x32_bf16 v[64:67], v[104:107], v[120:123], v[64:67]
    v_mfma_f32_16x16x32_bf16 v[68:71], v[108:111], v[120:123], v[68:71]
    v_mfma_f32_16x16x32_bf16 v[72:75], v[112:115], v[120:123], v[72:75]
    s_barrier
    ds_read_b128 v[120:123], v17 offset:0
    ds_read_b128 v[96:99], v29 offset:0
    ds_read_b128 v[100:103], v29 offset:2048
    ds_read_b128 v[104:107], v29 offset:4096
    ds_read_b128 v[108:111], v29 offset:6144
    ds_read_b128 v[112:115], v29 offset:8192
    s_waitcnt lgkmcnt(6)
    v_mfma_f32_16x16x32_bf16 v[56:59], v[76:79], v[116:119], v[56:59]
    v_mfma_f32_16x16x32_bf16 v[60:63], v[80:83], v[116:119], v[60:63]
    v_mfma_f32_16x16x32_bf16 v[64:67], v[84:87], v[116:119], v[64:67]
    v_mfma_f32_16x16x32_bf16 v[68:71], v[88:91], v[116:119], v[68:71]
    v_mfma_f32_16x16x32_bf16 v[72:75], v[92:95], v[116:119], v[72:75]
    ds_read_b128 v[116:119], v18 offset:0
    ds_read_b128 v[76:79], v30 offset:0
    ds_read_b128 v[80:83], v30 offset:2048
    ds_read_b128 v[84:87], v30 offset:4096
    ds_read_b128 v[88:91], v30 offset:6144
    ds_read_b128 v[92:95], v30 offset:8192
    s_waitcnt lgkmcnt(6)
    v_mfma_f32_16x16x32_bf16 v[56:59], v[96:99], v[120:123], v[56:59]
    v_mfma_f32_16x16x32_bf16 v[60:63], v[100:103], v[120:123], v[60:63]
    v_mfma_f32_16x16x32_bf16 v[64:67], v[104:107], v[120:123], v[64:67]
    v_mfma_f32_16x16x32_bf16 v[68:71], v[108:111], v[120:123], v[68:71]
    v_mfma_f32_16x16x32_bf16 v[72:75], v[112:115], v[120:123], v[72:75]
    s_barrier
    ds_read_b128 v[120:123], v19 offset:0
    ds_read_b128 v[96:99], v31 offset:0
    ds_read_b128 v[100:103], v31 offset:2048
    ds_read_b128 v[104:107], v31 offset:4096
    ds_read_b128 v[108:111], v31 offset:6144
    ds_read_b128 v[112:115], v31 offset:8192
    s_waitcnt lgkmcnt(6)
    v_mfma_f32_16x16x32_bf16 v[56:59], v[76:79], v[116:119], v[56:59]
    v_mfma_f32_16x16x32_bf16 v[60:63], v[80:83], v[116:119], v[60:63]
    v_mfma_f32_16x16x32_bf16 v[64:67], v[84:87], v[116:119], v[64:67]
    v_mfma_f32_16x16x32_bf16 v[68:71], v[88:91], v[116:119], v[68:71]
    v_mfma_f32_16x16x32_bf16 v[72:75], v[92:95], v[116:119], v[72:75]
    ds_read_b128 v[116:119], v8 offset:0
    ds_read_b128 v[76:79], v20 offset:0
    ds_read_b128 v[80:83], v20 offset:2048
    ds_read_b128 v[84:87], v20 offset:4096
    ds_read_b128 v[88:91], v20 offset:6144
    ds_read_b128 v[92:95], v20 offset:8192
    s_waitcnt lgkmcnt(6)
    v_mfma_f32_16x16x32_bf16 v[56:59], v[96:99], v[120:123], v[56:59]
    v_mfma_f32_16x16x32_bf16 v[60:63], v[100:103], v[120:123], v[60:63]
    v_mfma_f32_16x16x32_bf16 v[64:67], v[104:107], v[120:123], v[64:67]
    v_mfma_f32_16x16x32_bf16 v[68:71], v[108:111], v[120:123], v[68:71]
    v_mfma_f32_16x16x32_bf16 v[72:75], v[112:115], v[120:123], v[72:75]
    s_barrier
    ds_read_b128 v[120:123], v9 offset:0
    ds_read_b128 v[96:99], v21 offset:0
    ds_read_b128 v[100:103], v21 offset:2048
    ds_read_b128 v[104:107], v21 offset:4096
    ds_read_b128 v[108:111], v21 offset:6144
    ds_read_b128 v[112:115], v21 offset:8192
    s_waitcnt lgkmcnt(6)
    v_mfma_f32_16x16x32_bf16 v[56:59], v[76:79], v[116:119], v[56:59]
    v_mfma_f32_16x16x32_bf16 v[60:63], v[80:83], v[116:119], v[60:63]
    v_mfma_f32_16x16x32_bf16 v[64:67], v[84:87], v[116:119], v[64:67]
    v_mfma_f32_16x16x32_bf16 v[68:71], v[88:91], v[116:119], v[68:71]
    v_mfma_f32_16x16x32_bf16 v[72:75], v[92:95], v[116:119], v[72:75]
    ds_read_b128 v[116:119], v10 offset:0
    ds_read_b128 v[76:79], v22 offset:0
    ds_read_b128 v[80:83], v22 offset:2048
    ds_read_b128 v[84:87], v22 offset:4096
    ds_read_b128 v[88:91], v22 offset:6144
    ds_read_b128 v[92:95], v22 offset:8192
    s_waitcnt lgkmcnt(6)
    v_mfma_f32_16x16x32_bf16 v[56:59], v[96:99], v[120:123], v[56:59]
    v_mfma_f32_16x16x32_bf16 v[60:63], v[100:103], v[120:123], v[60:63]
    v_mfma_f32_16x16x32_bf16 v[64:67], v[104:107], v[120:123], v[64:67]
    v_mfma_f32_16x16x32_bf16 v[68:71], v[108:111], v[120:123], v[68:71]
    v_mfma_f32_16x16x32_bf16 v[72:75], v[112:115], v[120:123], v[72:75]
    s_barrier
    ds_read_b128 v[120:123], v11 offset:0
    ds_read_b128 v[96:99], v23 offset:0
    ds_read_b128 v[100:103], v23 offset:2048
    ds_read_b128 v[104:107], v23 offset:4096
    ds_read_b128 v[108:111], v23 offset:6144
    ds_read_b128 v[112:115], v23 offset:8192
    s_waitcnt lgkmcnt(6)
    v_mfma_f32_16x16x32_bf16 v[56:59], v[76:79], v[116:119], v[56:59]
    v_mfma_f32_16x16x32_bf16 v[60:63], v[80:83], v[116:119], v[60:63]
    v_mfma_f32_16x16x32_bf16 v[64:67], v[84:87], v[116:119], v[64:67]
    v_mfma_f32_16x16x32_bf16 v[68:71], v[88:91], v[116:119], v[68:71]
    v_mfma_f32_16x16x32_bf16 v[72:75], v[92:95], v[116:119], v[72:75]
    ds_read_b128 v[116:119], v12 offset:0
    ds_read_b128 v[76:79], v24 offset:0
    ds_read_b128 v[80:83], v24 offset:2048
    ds_read_b128 v[84:87], v24 offset:4096
    ds_read_b128 v[88:91], v24 offset:6144
    ds_read_b128 v[92:95], v24 offset:8192
    s_waitcnt lgkmcnt(6)
    v_mfma_f32_16x16x32_bf16 v[56:59], v[96:99], v[120:123], v[56:59]
    v_mfma_f32_16x16x32_bf16 v[60:63], v[100:103], v[120:123], v[60:63]
    v_mfma_f32_16x16x32_bf16 v[64:67], v[104:107], v[120:123], v[64:67]
    v_mfma_f32_16x16x32_bf16 v[68:71], v[108:111], v[120:123], v[68:71]
    v_mfma_f32_16x16x32_bf16 v[72:75], v[112:115], v[120:123], v[72:75]
    s_barrier
    ds_read_b128 v[120:123], v13 offset:0
    ds_read_b128 v[96:99], v25 offset:0
    ds_read_b128 v[100:103], v25 offset:2048
    ds_read_b128 v[104:107], v25 offset:4096
    ds_read_b128 v[108:111], v25 offset:6144
    ds_read_b128 v[112:115], v25 offset:8192
    s_waitcnt lgkmcnt(6)
    v_mfma_f32_16x16x32_bf16 v[56:59], v[76:79], v[116:119], v[56:59]
    v_mfma_f32_16x16x32_bf16 v[60:63], v[80:83], v[116:119], v[60:63]
    v_mfma_f32_16x16x32_bf16 v[64:67], v[84:87], v[116:119], v[64:67]
    v_mfma_f32_16x16x32_bf16 v[68:71], v[88:91], v[116:119], v[68:71]
    v_mfma_f32_16x16x32_bf16 v[72:75], v[92:95], v[116:119], v[72:75]
    ds_read_b128 v[116:119], v14 offset:0
    ds_read_b128 v[76:79], v26 offset:0
    ds_read_b128 v[80:83], v26 offset:2048
    ds_read_b128 v[84:87], v26 offset:4096
    ds_read_b128 v[88:91], v26 offset:6144
    ds_read_b128 v[92:95], v26 offset:8192
    s_waitcnt lgkmcnt(6)
    v_mfma_f32_16x16x32_bf16 v[56:59], v[96:99], v[120:123], v[56:59]
    v_mfma_f32_16x16x32_bf16 v[60:63], v[100:103], v[120:123], v[60:63]
    v_mfma_f32_16x16x32_bf16 v[64:67], v[104:107], v[120:123], v[64:67]
    v_mfma_f32_16x16x32_bf16 v[68:71], v[108:111], v[120:123], v[68:71]
    v_mfma_f32_16x16x32_bf16 v[72:75], v[112:115], v[120:123], v[72:75]
    s_barrier
    ds_read_b128 v[120:123], v15 offset:0
    ds_read_b128 v[96:99], v27 offset:0
    ds_read_b128 v[100:103], v27 offset:2048
    ds_read_b128 v[104:107], v27 offset:4096
    ds_read_b128 v[108:111], v27 offset:6144
    ds_read_b128 v[112:115], v27 offset:8192
    s_waitcnt lgkmcnt(6)
    v_mfma_f32_16x16x32_bf16 v[56:59], v[76:79], v[116:119], v[56:59]
    v_mfma_f32_16x16x32_bf16 v[60:63], v[80:83], v[116:119], v[60:63]
    v_mfma_f32_16x16x32_bf16 v[64:67], v[84:87], v[116:119], v[64:67]
    v_mfma_f32_16x16x32_bf16 v[68:71], v[88:91], v[116:119], v[68:71]
    v_mfma_f32_16x16x32_bf16 v[72:75], v[92:95], v[116:119], v[72:75]
    ds_read_b128 v[116:119], v16 offset:0
    ds_read_b128 v[76:79], v28 offset:0
    ds_read_b128 v[80:83], v28 offset:2048
    ds_read_b128 v[84:87], v28 offset:4096
    ds_read_b128 v[88:91], v28 offset:6144
    ds_read_b128 v[92:95], v28 offset:8192
    s_waitcnt lgkmcnt(6)
    v_mfma_f32_16x16x32_bf16 v[56:59], v[96:99], v[120:123], v[56:59]
    v_mfma_f32_16x16x32_bf16 v[60:63], v[100:103], v[120:123], v[60:63]
    v_mfma_f32_16x16x32_bf16 v[64:67], v[104:107], v[120:123], v[64:67]
    v_mfma_f32_16x16x32_bf16 v[68:71], v[108:111], v[120:123], v[68:71]
    v_mfma_f32_16x16x32_bf16 v[72:75], v[112:115], v[120:123], v[72:75]
    s_barrier
    ds_read_b128 v[120:123], v17 offset:0
    ds_read_b128 v[96:99], v29 offset:0
    ds_read_b128 v[100:103], v29 offset:2048
    ds_read_b128 v[104:107], v29 offset:4096
    ds_read_b128 v[108:111], v29 offset:6144
    ds_read_b128 v[112:115], v29 offset:8192
    s_waitcnt lgkmcnt(6)
    v_mfma_f32_16x16x32_bf16 v[56:59], v[76:79], v[116:119], v[56:59]
    v_mfma_f32_16x16x32_bf16 v[60:63], v[80:83], v[116:119], v[60:63]
    v_mfma_f32_16x16x32_bf16 v[64:67], v[84:87], v[116:119], v[64:67]
    v_mfma_f32_16x16x32_bf16 v[68:71], v[88:91], v[116:119], v[68:71]
    v_mfma_f32_16x16x32_bf16 v[72:75], v[92:95], v[116:119], v[72:75]
    ds_read_b128 v[116:119], v18 offset:0
    ds_read_b128 v[76:79], v30 offset:0
    ds_read_b128 v[80:83], v30 offset:2048
    ds_read_b128 v[84:87], v30 offset:4096
    ds_read_b128 v[88:91], v30 offset:6144
    ds_read_b128 v[92:95], v30 offset:8192
    s_waitcnt lgkmcnt(6)
    v_mfma_f32_16x16x32_bf16 v[56:59], v[96:99], v[120:123], v[56:59]
    v_mfma_f32_16x16x32_bf16 v[60:63], v[100:103], v[120:123], v[60:63]
    v_mfma_f32_16x16x32_bf16 v[64:67], v[104:107], v[120:123], v[64:67]
    v_mfma_f32_16x16x32_bf16 v[68:71], v[108:111], v[120:123], v[68:71]
    v_mfma_f32_16x16x32_bf16 v[72:75], v[112:115], v[120:123], v[72:75]
    s_barrier
    ds_read_b128 v[120:123], v19 offset:0
    ds_read_b128 v[96:99], v31 offset:0
    ds_read_b128 v[100:103], v31 offset:2048
    ds_read_b128 v[104:107], v31 offset:4096
    ds_read_b128 v[108:111], v31 offset:6144
    ds_read_b128 v[112:115], v31 offset:8192
    s_waitcnt lgkmcnt(6)
    v_mfma_f32_16x16x32_bf16 v[56:59], v[76:79], v[116:119], v[56:59]
    v_mfma_f32_16x16x32_bf16 v[60:63], v[80:83], v[116:119], v[60:63]
    v_mfma_f32_16x16x32_bf16 v[64:67], v[84:87], v[116:119], v[64:67]
    v_mfma_f32_16x16x32_bf16 v[68:71], v[88:91], v[116:119], v[68:71]
    v_mfma_f32_16x16x32_bf16 v[72:75], v[92:95], v[116:119], v[72:75]
    ds_read_b128 v[116:119], v8 offset:0
    ds_read_b128 v[76:79], v20 offset:0
    ds_read_b128 v[80:83], v20 offset:2048
    ds_read_b128 v[84:87], v20 offset:4096
    ds_read_b128 v[88:91], v20 offset:6144
    ds_read_b128 v[92:95], v20 offset:8192
    s_waitcnt lgkmcnt(6)
    v_mfma_f32_16x16x32_bf16 v[56:59], v[96:99], v[120:123], v[56:59]
    v_mfma_f32_16x16x32_bf16 v[60:63], v[100:103], v[120:123], v[60:63]
    v_mfma_f32_16x16x32_bf16 v[64:67], v[104:107], v[120:123], v[64:67]
    v_mfma_f32_16x16x32_bf16 v[68:71], v[108:111], v[120:123], v[68:71]
    v_mfma_f32_16x16x32_bf16 v[72:75], v[112:115], v[120:123], v[72:75]
    s_barrier
    ds_read_b128 v[120:123], v9 offset:0
    ds_read_b128 v[96:99], v21 offset:0
    ds_read_b128 v[100:103], v21 offset:2048
    ds_read_b128 v[104:107], v21 offset:4096
    ds_read_b128 v[108:111], v21 offset:6144
    ds_read_b128 v[112:115], v21 offset:8192
    s_waitcnt lgkmcnt(6)
    v_mfma_f32_16x16x32_bf16 v[56:59], v[76:79], v[116:119], v[56:59]
    v_mfma_f32_16x16x32_bf16 v[60:63], v[80:83], v[116:119], v[60:63]
    v_mfma_f32_16x16x32_bf16 v[64:67], v[84:87], v[116:119], v[64:67]
    v_mfma_f32_16x16x32_bf16 v[68:71], v[88:91], v[116:119], v[68:71]
    v_mfma_f32_16x16x32_bf16 v[72:75], v[92:95], v[116:119], v[72:75]
    ds_read_b128 v[116:119], v10 offset:0
    ds_read_b128 v[76:79], v22 offset:0
    ds_read_b128 v[80:83], v22 offset:2048
    ds_read_b128 v[84:87], v22 offset:4096
    ds_read_b128 v[88:91], v22 offset:6144
    ds_read_b128 v[92:95], v22 offset:8192
    s_waitcnt lgkmcnt(6)
    v_mfma_f32_16x16x32_bf16 v[56:59], v[96:99], v[120:123], v[56:59]
    v_mfma_f32_16x16x32_bf16 v[60:63], v[100:103], v[120:123], v[60:63]
    v_mfma_f32_16x16x32_bf16 v[64:67], v[104:107], v[120:123], v[64:67]
    v_mfma_f32_16x16x32_bf16 v[68:71], v[108:111], v[120:123], v[68:71]
    v_mfma_f32_16x16x32_bf16 v[72:75], v[112:115], v[120:123], v[72:75]
    s_barrier
    ds_read_b128 v[120:123], v11 offset:0
    ds_read_b128 v[96:99], v23 offset:0
    ds_read_b128 v[100:103], v23 offset:2048
    ds_read_b128 v[104:107], v23 offset:4096
    ds_read_b128 v[108:111], v23 offset:6144
    ds_read_b128 v[112:115], v23 offset:8192
    s_waitcnt lgkmcnt(6)
    v_mfma_f32_16x16x32_bf16 v[56:59], v[76:79], v[116:119], v[56:59]
    v_mfma_f32_16x16x32_bf16 v[60:63], v[80:83], v[116:119], v[60:63]
    v_mfma_f32_16x16x32_bf16 v[64:67], v[84:87], v[116:119], v[64:67]
    v_mfma_f32_16x16x32_bf16 v[68:71], v[88:91], v[116:119], v[68:71]
    v_mfma_f32_16x16x32_bf16 v[72:75], v[92:95], v[116:119], v[72:75]
    ds_read_b128 v[116:119], v12 offset:0
    ds_read_b128 v[76:79], v24 offset:0
    ds_read_b128 v[80:83], v24 offset:2048
    ds_read_b128 v[84:87], v24 offset:4096
    ds_read_b128 v[88:91], v24 offset:6144
    ds_read_b128 v[92:95], v24 offset:8192
    s_waitcnt lgkmcnt(6)
    v_mfma_f32_16x16x32_bf16 v[56:59], v[96:99], v[120:123], v[56:59]
    v_mfma_f32_16x16x32_bf16 v[60:63], v[100:103], v[120:123], v[60:63]
    v_mfma_f32_16x16x32_bf16 v[64:67], v[104:107], v[120:123], v[64:67]
    v_mfma_f32_16x16x32_bf16 v[68:71], v[108:111], v[120:123], v[68:71]
    v_mfma_f32_16x16x32_bf16 v[72:75], v[112:115], v[120:123], v[72:75]
    s_barrier
    ds_read_b128 v[120:123], v13 offset:0
    ds_read_b128 v[96:99], v25 offset:0
    ds_read_b128 v[100:103], v25 offset:2048
    ds_read_b128 v[104:107], v25 offset:4096
    ds_read_b128 v[108:111], v25 offset:6144
    ds_read_b128 v[112:115], v25 offset:8192
    s_waitcnt lgkmcnt(6)
    v_mfma_f32_16x16x32_bf16 v[56:59], v[76:79], v[116:119], v[56:59]
    v_mfma_f32_16x16x32_bf16 v[60:63], v[80:83], v[116:119], v[60:63]
    v_mfma_f32_16x16x32_bf16 v[64:67], v[84:87], v[116:119], v[64:67]
    v_mfma_f32_16x16x32_bf16 v[68:71], v[88:91], v[116:119], v[68:71]
    v_mfma_f32_16x16x32_bf16 v[72:75], v[92:95], v[116:119], v[72:75]
    ds_read_b128 v[116:119], v14 offset:0
    ds_read_b128 v[76:79], v26 offset:0
    ds_read_b128 v[80:83], v26 offset:2048
    ds_read_b128 v[84:87], v26 offset:4096
    ds_read_b128 v[88:91], v26 offset:6144
    ds_read_b128 v[92:95], v26 offset:8192
    s_waitcnt lgkmcnt(6)
    v_mfma_f32_16x16x32_bf16 v[56:59], v[96:99], v[120:123], v[56:59]
    v_mfma_f32_16x16x32_bf16 v[60:63], v[100:103], v[120:123], v[60:63]
    v_mfma_f32_16x16x32_bf16 v[64:67], v[104:107], v[120:123], v[64:67]
    v_mfma_f32_16x16x32_bf16 v[68:71], v[108:111], v[120:123], v[68:71]
    v_mfma_f32_16x16x32_bf16 v[72:75], v[112:115], v[120:123], v[72:75]
    s_barrier
    ds_read_b128 v[120:123], v15 offset:0
    ds_read_b128 v[96:99], v27 offset:0
    ds_read_b128 v[100:103], v27 offset:2048
    ds_read_b128 v[104:107], v27 offset:4096
    ds_read_b128 v[108:111], v27 offset:6144
    ds_read_b128 v[112:115], v27 offset:8192
    s_waitcnt lgkmcnt(6)
    v_mfma_f32_16x16x32_bf16 v[56:59], v[76:79], v[116:119], v[56:59]
    v_mfma_f32_16x16x32_bf16 v[60:63], v[80:83], v[116:119], v[60:63]
    v_mfma_f32_16x16x32_bf16 v[64:67], v[84:87], v[116:119], v[64:67]
    v_mfma_f32_16x16x32_bf16 v[68:71], v[88:91], v[116:119], v[68:71]
    v_mfma_f32_16x16x32_bf16 v[72:75], v[92:95], v[116:119], v[72:75]
    ds_read_b128 v[116:119], v16 offset:0
    ds_read_b128 v[76:79], v28 offset:0
    ds_read_b128 v[80:83], v28 offset:2048
    ds_read_b128 v[84:87], v28 offset:4096
    ds_read_b128 v[88:91], v28 offset:6144
    ds_read_b128 v[92:95], v28 offset:8192
    s_waitcnt lgkmcnt(6)
    v_mfma_f32_16x16x32_bf16 v[56:59], v[96:99], v[120:123], v[56:59]
    v_mfma_f32_16x16x32_bf16 v[60:63], v[100:103], v[120:123], v[60:63]
    v_mfma_f32_16x16x32_bf16 v[64:67], v[104:107], v[120:123], v[64:67]
    v_mfma_f32_16x16x32_bf16 v[68:71], v[108:111], v[120:123], v[68:71]
    v_mfma_f32_16x16x32_bf16 v[72:75], v[112:115], v[120:123], v[72:75]
    s_barrier
    ds_read_b128 v[120:123], v17 offset:0
    ds_read_b128 v[96:99], v29 offset:0
    ds_read_b128 v[100:103], v29 offset:2048
    ds_read_b128 v[104:107], v29 offset:4096
    ds_read_b128 v[108:111], v29 offset:6144
    ds_read_b128 v[112:115], v29 offset:8192
    s_waitcnt lgkmcnt(6)
    v_mfma_f32_16x16x32_bf16 v[56:59], v[76:79], v[116:119], v[56:59]
    v_mfma_f32_16x16x32_bf16 v[60:63], v[80:83], v[116:119], v[60:63]
    v_mfma_f32_16x16x32_bf16 v[64:67], v[84:87], v[116:119], v[64:67]
    v_mfma_f32_16x16x32_bf16 v[68:71], v[88:91], v[116:119], v[68:71]
    v_mfma_f32_16x16x32_bf16 v[72:75], v[92:95], v[116:119], v[72:75]
    ds_read_b128 v[116:119], v18 offset:0
    ds_read_b128 v[76:79], v30 offset:0
    ds_read_b128 v[80:83], v30 offset:2048
    ds_read_b128 v[84:87], v30 offset:4096
    ds_read_b128 v[88:91], v30 offset:6144
    ds_read_b128 v[92:95], v30 offset:8192
    s_waitcnt lgkmcnt(6)
    v_mfma_f32_16x16x32_bf16 v[56:59], v[96:99], v[120:123], v[56:59]
    v_mfma_f32_16x16x32_bf16 v[60:63], v[100:103], v[120:123], v[60:63]
    v_mfma_f32_16x16x32_bf16 v[64:67], v[104:107], v[120:123], v[64:67]
    v_mfma_f32_16x16x32_bf16 v[68:71], v[108:111], v[120:123], v[68:71]
    v_mfma_f32_16x16x32_bf16 v[72:75], v[112:115], v[120:123], v[72:75]
    s_barrier
    ds_read_b128 v[120:123], v19 offset:0
    ds_read_b128 v[96:99], v31 offset:0
    ds_read_b128 v[100:103], v31 offset:2048
    ds_read_b128 v[104:107], v31 offset:4096
    ds_read_b128 v[108:111], v31 offset:6144
    ds_read_b128 v[112:115], v31 offset:8192
    s_waitcnt lgkmcnt(6)
    v_mfma_f32_16x16x32_bf16 v[56:59], v[76:79], v[116:119], v[56:59]
    v_mfma_f32_16x16x32_bf16 v[60:63], v[80:83], v[116:119], v[60:63]
    v_mfma_f32_16x16x32_bf16 v[64:67], v[84:87], v[116:119], v[64:67]
    v_mfma_f32_16x16x32_bf16 v[68:71], v[88:91], v[116:119], v[68:71]
    v_mfma_f32_16x16x32_bf16 v[72:75], v[92:95], v[116:119], v[72:75]
    ds_read_b128 v[116:119], v8 offset:0
    ds_read_b128 v[76:79], v20 offset:0
    ds_read_b128 v[80:83], v20 offset:2048
    ds_read_b128 v[84:87], v20 offset:4096
    ds_read_b128 v[88:91], v20 offset:6144
    ds_read_b128 v[92:95], v20 offset:8192
    s_waitcnt lgkmcnt(6)
    v_mfma_f32_16x16x32_bf16 v[56:59], v[96:99], v[120:123], v[56:59]
    v_mfma_f32_16x16x32_bf16 v[60:63], v[100:103], v[120:123], v[60:63]
    v_mfma_f32_16x16x32_bf16 v[64:67], v[104:107], v[120:123], v[64:67]
    v_mfma_f32_16x16x32_bf16 v[68:71], v[108:111], v[120:123], v[68:71]
    v_mfma_f32_16x16x32_bf16 v[72:75], v[112:115], v[120:123], v[72:75]
    s_barrier
    ds_read_b128 v[120:123], v9 offset:0
    ds_read_b128 v[96:99], v21 offset:0
    ds_read_b128 v[100:103], v21 offset:2048
    ds_read_b128 v[104:107], v21 offset:4096
    ds_read_b128 v[108:111], v21 offset:6144
    ds_read_b128 v[112:115], v21 offset:8192
    s_waitcnt lgkmcnt(6)
    v_mfma_f32_16x16x32_bf16 v[56:59], v[76:79], v[116:119], v[56:59]
    v_mfma_f32_16x16x32_bf16 v[60:63], v[80:83], v[116:119], v[60:63]
    v_mfma_f32_16x16x32_bf16 v[64:67], v[84:87], v[116:119], v[64:67]
    v_mfma_f32_16x16x32_bf16 v[68:71], v[88:91], v[116:119], v[68:71]
    v_mfma_f32_16x16x32_bf16 v[72:75], v[92:95], v[116:119], v[72:75]
    ds_read_b128 v[116:119], v10 offset:0
    ds_read_b128 v[76:79], v22 offset:0
    ds_read_b128 v[80:83], v22 offset:2048
    ds_read_b128 v[84:87], v22 offset:4096
    ds_read_b128 v[88:91], v22 offset:6144
    ds_read_b128 v[92:95], v22 offset:8192
    s_waitcnt lgkmcnt(6)
    v_mfma_f32_16x16x32_bf16 v[56:59], v[96:99], v[120:123], v[56:59]
    v_mfma_f32_16x16x32_bf16 v[60:63], v[100:103], v[120:123], v[60:63]
    v_mfma_f32_16x16x32_bf16 v[64:67], v[104:107], v[120:123], v[64:67]
    v_mfma_f32_16x16x32_bf16 v[68:71], v[108:111], v[120:123], v[68:71]
    v_mfma_f32_16x16x32_bf16 v[72:75], v[112:115], v[120:123], v[72:75]
    s_barrier
    ds_read_b128 v[120:123], v11 offset:0
    ds_read_b128 v[96:99], v23 offset:0
    ds_read_b128 v[100:103], v23 offset:2048
    ds_read_b128 v[104:107], v23 offset:4096
    ds_read_b128 v[108:111], v23 offset:6144
    ds_read_b128 v[112:115], v23 offset:8192
    s_waitcnt lgkmcnt(6)
    v_mfma_f32_16x16x32_bf16 v[56:59], v[76:79], v[116:119], v[56:59]
    v_mfma_f32_16x16x32_bf16 v[60:63], v[80:83], v[116:119], v[60:63]
    v_mfma_f32_16x16x32_bf16 v[64:67], v[84:87], v[116:119], v[64:67]
    v_mfma_f32_16x16x32_bf16 v[68:71], v[88:91], v[116:119], v[68:71]
    v_mfma_f32_16x16x32_bf16 v[72:75], v[92:95], v[116:119], v[72:75]
    ds_read_b128 v[116:119], v12 offset:0
    ds_read_b128 v[76:79], v24 offset:0
    ds_read_b128 v[80:83], v24 offset:2048
    ds_read_b128 v[84:87], v24 offset:4096
    ds_read_b128 v[88:91], v24 offset:6144
    ds_read_b128 v[92:95], v24 offset:8192
    s_waitcnt lgkmcnt(6)
    v_mfma_f32_16x16x32_bf16 v[56:59], v[96:99], v[120:123], v[56:59]
    v_mfma_f32_16x16x32_bf16 v[60:63], v[100:103], v[120:123], v[60:63]
    v_mfma_f32_16x16x32_bf16 v[64:67], v[104:107], v[120:123], v[64:67]
    v_mfma_f32_16x16x32_bf16 v[68:71], v[108:111], v[120:123], v[68:71]
    v_mfma_f32_16x16x32_bf16 v[72:75], v[112:115], v[120:123], v[72:75]
    s_barrier
    ds_read_b128 v[120:123], v13 offset:0
    ds_read_b128 v[96:99], v25 offset:0
    ds_read_b128 v[100:103], v25 offset:2048
    ds_read_b128 v[104:107], v25 offset:4096
    ds_read_b128 v[108:111], v25 offset:6144
    ds_read_b128 v[112:115], v25 offset:8192
    s_waitcnt lgkmcnt(6)
    v_mfma_f32_16x16x32_bf16 v[56:59], v[76:79], v[116:119], v[56:59]
    v_mfma_f32_16x16x32_bf16 v[60:63], v[80:83], v[116:119], v[60:63]
    v_mfma_f32_16x16x32_bf16 v[64:67], v[84:87], v[116:119], v[64:67]
    v_mfma_f32_16x16x32_bf16 v[68:71], v[88:91], v[116:119], v[68:71]
    v_mfma_f32_16x16x32_bf16 v[72:75], v[92:95], v[116:119], v[72:75]
    s_waitcnt lgkmcnt(0)
    v_mfma_f32_16x16x32_bf16 v[56:59], v[96:99], v[120:123], v[56:59]
    v_mfma_f32_16x16x32_bf16 v[60:63], v[100:103], v[120:123], v[60:63]
    v_mfma_f32_16x16x32_bf16 v[64:67], v[104:107], v[120:123], v[64:67]
    v_mfma_f32_16x16x32_bf16 v[68:71], v[108:111], v[120:123], v[68:71]
    v_mfma_f32_16x16x32_bf16 v[72:75], v[112:115], v[120:123], v[72:75]
    s_waitcnt vmcnt(0)
    s_nop 7
    s_nop 3
    v_lshlrev_b32 v132, 16, v34
    v_and_b32 v133, 0xffff0000, v34
    v_lshlrev_b32 v134, 16, v35
    v_and_b32 v135, 0xffff0000, v35
    v_cvt_pk_bf16_f32 v130, v56, v57
    v_cvt_pk_bf16_f32 v131, v58, v59
    v_lshlrev_b32 v54, 16, v130
    v_and_b32 v55, 0xffff0000, v130
    v_lshlrev_b32 v124, 16, v131
    v_and_b32 v125, 0xffff0000, v131
    v_pk_add_f32 v[54:55], v[54:55], v[132:133]
    v_pk_add_f32 v[124:125], v[124:125], v[134:135]
    v_cvt_pk_bf16_f32 v130, v54, v55
    v_cvt_pk_bf16_f32 v131, v124, v125
    v_lshlrev_b32 v54, 16, v130
    v_and_b32 v55, 0xffff0000, v130
    v_lshlrev_b32 v124, 16, v131
    v_and_b32 v125, 0xffff0000, v131
    s_waitcnt vmcnt(0)
    v_lshlrev_b32 v126, 16, v44
    v_and_b32 v127, 0xffff0000, v44
    v_lshlrev_b32 v128, 16, v45
    v_and_b32 v129, 0xffff0000, v45
    v_pk_add_f32 v[54:55], v[54:55], v[126:127]
    v_pk_add_f32 v[124:125], v[124:125], v[128:129]
    v_cvt_pk_bf16_f32 v130, v54, v55
    v_cvt_pk_bf16_f32 v131, v124, v125
    s_mov_b32 s42, 0
    buffer_store_dwordx2 v[130:131], v33, s[20:23], s42 offen offset:0
    s_nop 1
    v_lshlrev_b32 v132, 16, v36
    v_and_b32 v133, 0xffff0000, v36
    v_lshlrev_b32 v134, 16, v37
    v_and_b32 v135, 0xffff0000, v37
    v_cvt_pk_bf16_f32 v130, v60, v61
    v_cvt_pk_bf16_f32 v131, v62, v63
    v_lshlrev_b32 v54, 16, v130
    v_and_b32 v55, 0xffff0000, v130
    v_lshlrev_b32 v124, 16, v131
    v_and_b32 v125, 0xffff0000, v131
    v_pk_add_f32 v[54:55], v[54:55], v[132:133]
    v_pk_add_f32 v[124:125], v[124:125], v[134:135]
    v_cvt_pk_bf16_f32 v130, v54, v55
    v_cvt_pk_bf16_f32 v131, v124, v125
    v_lshlrev_b32 v54, 16, v130
    v_and_b32 v55, 0xffff0000, v130
    v_lshlrev_b32 v124, 16, v131
    v_and_b32 v125, 0xffff0000, v131
    v_lshlrev_b32 v126, 16, v46
    v_and_b32 v127, 0xffff0000, v46
    v_lshlrev_b32 v128, 16, v47
    v_and_b32 v129, 0xffff0000, v47
    v_pk_add_f32 v[54:55], v[54:55], v[126:127]
    v_pk_add_f32 v[124:125], v[124:125], v[128:129]
    v_cvt_pk_bf16_f32 v130, v54, v55
    v_cvt_pk_bf16_f32 v131, v124, v125
    s_mov_b32 s42, 0
    buffer_store_dwordx2 v[130:131], v33, s[20:23], s42 offen offset:32
    s_nop 1
    v_lshlrev_b32 v132, 16, v38
    v_and_b32 v133, 0xffff0000, v38
    v_lshlrev_b32 v134, 16, v39
    v_and_b32 v135, 0xffff0000, v39
    v_cvt_pk_bf16_f32 v130, v64, v65
    v_cvt_pk_bf16_f32 v131, v66, v67
    v_lshlrev_b32 v54, 16, v130
    v_and_b32 v55, 0xffff0000, v130
    v_lshlrev_b32 v124, 16, v131
    v_and_b32 v125, 0xffff0000, v131
    v_pk_add_f32 v[54:55], v[54:55], v[132:133]
    v_pk_add_f32 v[124:125], v[124:125], v[134:135]
    v_cvt_pk_bf16_f32 v130, v54, v55
    v_cvt_pk_bf16_f32 v131, v124, v125
    v_lshlrev_b32 v54, 16, v130
    v_and_b32 v55, 0xffff0000, v130
    v_lshlrev_b32 v124, 16, v131
    v_and_b32 v125, 0xffff0000, v131
    v_lshlrev_b32 v126, 16, v48
    v_and_b32 v127, 0xffff0000, v48
    v_lshlrev_b32 v128, 16, v49
    v_and_b32 v129, 0xffff0000, v49
    v_pk_add_f32 v[54:55], v[54:55], v[126:127]
    v_pk_add_f32 v[124:125], v[124:125], v[128:129]
    v_cvt_pk_bf16_f32 v130, v54, v55
    v_cvt_pk_bf16_f32 v131, v124, v125
    s_mov_b32 s42, 0
    buffer_store_dwordx2 v[130:131], v33, s[20:23], s42 offen offset:64
    s_nop 1
    v_lshlrev_b32 v132, 16, v40
    v_and_b32 v133, 0xffff0000, v40
    v_lshlrev_b32 v134, 16, v41
    v_and_b32 v135, 0xffff0000, v41
    v_cvt_pk_bf16_f32 v130, v68, v69
    v_cvt_pk_bf16_f32 v131, v70, v71
    v_lshlrev_b32 v54, 16, v130
    v_and_b32 v55, 0xffff0000, v130
    v_lshlrev_b32 v124, 16, v131
    v_and_b32 v125, 0xffff0000, v131
    v_pk_add_f32 v[54:55], v[54:55], v[132:133]
    v_pk_add_f32 v[124:125], v[124:125], v[134:135]
    v_cvt_pk_bf16_f32 v130, v54, v55
    v_cvt_pk_bf16_f32 v131, v124, v125
    v_lshlrev_b32 v54, 16, v130
    v_and_b32 v55, 0xffff0000, v130
    v_lshlrev_b32 v124, 16, v131
    v_and_b32 v125, 0xffff0000, v131
    v_lshlrev_b32 v126, 16, v50
    v_and_b32 v127, 0xffff0000, v50
    v_lshlrev_b32 v128, 16, v51
    v_and_b32 v129, 0xffff0000, v51
    v_pk_add_f32 v[54:55], v[54:55], v[126:127]
    v_pk_add_f32 v[124:125], v[124:125], v[128:129]
    v_cvt_pk_bf16_f32 v130, v54, v55
    v_cvt_pk_bf16_f32 v131, v124, v125
    s_mov_b32 s42, 0
    buffer_store_dwordx2 v[130:131], v33, s[20:23], s42 offen offset:96
    s_nop 1
    v_lshlrev_b32 v132, 16, v42
    v_and_b32 v133, 0xffff0000, v42
    v_lshlrev_b32 v134, 16, v43
    v_and_b32 v135, 0xffff0000, v43
    v_cvt_pk_bf16_f32 v130, v72, v73
    v_cvt_pk_bf16_f32 v131, v74, v75
    v_lshlrev_b32 v54, 16, v130
    v_and_b32 v55, 0xffff0000, v130
    v_lshlrev_b32 v124, 16, v131
    v_and_b32 v125, 0xffff0000, v131
    v_pk_add_f32 v[54:55], v[54:55], v[132:133]
    v_pk_add_f32 v[124:125], v[124:125], v[134:135]
    v_cvt_pk_bf16_f32 v130, v54, v55
    v_cvt_pk_bf16_f32 v131, v124, v125
    v_lshlrev_b32 v54, 16, v130
    v_and_b32 v55, 0xffff0000, v130
    v_lshlrev_b32 v124, 16, v131
    v_and_b32 v125, 0xffff0000, v131
    v_lshlrev_b32 v126, 16, v52
    v_and_b32 v127, 0xffff0000, v52
    v_lshlrev_b32 v128, 16, v53
    v_and_b32 v129, 0xffff0000, v53
    v_pk_add_f32 v[54:55], v[54:55], v[126:127]
    v_pk_add_f32 v[124:125], v[124:125], v[128:129]
    v_cvt_pk_bf16_f32 v130, v54, v55
    v_cvt_pk_bf16_f32 v131, v124, v125
    s_mov_b32 s42, 0
    buffer_store_dwordx2 v[130:131], v33, s[20:23], s42 offen offset:128
    s_nop 1
k5_end:
    s_endpgm
.section .rodata,"a"
.p2align 6
.amdhsa_kernel k1_kernel
  .amdhsa_next_free_vgpr 80
  .amdhsa_next_free_sgpr 102
  .amdhsa_accum_offset 80
  .amdhsa_group_segment_fixed_size 0
  .amdhsa_kernarg_size 88
  .amdhsa_user_sgpr_count 2
  .amdhsa_user_sgpr_kernarg_segment_ptr 1
  .amdhsa_system_sgpr_workgroup_id_x 1
.end_amdhsa_kernel
.p2align 6
.amdhsa_kernel k2_kernel
  .amdhsa_next_free_vgpr 88
  .amdhsa_next_free_sgpr 102
  .amdhsa_accum_offset 88
  .amdhsa_group_segment_fixed_size 0
  .amdhsa_kernarg_size 88
  .amdhsa_user_sgpr_count 2
  .amdhsa_user_sgpr_kernarg_segment_ptr 1
  .amdhsa_system_sgpr_workgroup_id_x 1
.end_amdhsa_kernel
.p2align 6
.amdhsa_kernel k3_kernel
  .amdhsa_next_free_vgpr 104
  .amdhsa_next_free_sgpr 102
  .amdhsa_accum_offset 104
  .amdhsa_group_segment_fixed_size 0
  .amdhsa_kernarg_size 88
  .amdhsa_user_sgpr_count 2
  .amdhsa_user_sgpr_kernarg_segment_ptr 1
  .amdhsa_system_sgpr_workgroup_id_x 1
.end_amdhsa_kernel
.p2align 6
.amdhsa_kernel k4_kernel
  .amdhsa_next_free_vgpr 192
  .amdhsa_next_free_sgpr 102
  .amdhsa_accum_offset 192
  .amdhsa_group_segment_fixed_size 0
  .amdhsa_kernarg_size 88
  .amdhsa_user_sgpr_count 2
  .amdhsa_user_sgpr_kernarg_segment_ptr 1
  .amdhsa_system_sgpr_workgroup_id_x 1
.end_amdhsa_kernel
.p2align 6
.amdhsa_kernel k5_kernel
  .amdhsa_next_free_vgpr 136
  .amdhsa_next_free_sgpr 102
  .amdhsa_accum_offset 136
  .amdhsa_group_segment_fixed_size 0
  .amdhsa_kernarg_size 88
  .amdhsa_user_sgpr_count 2
  .amdhsa_user_sgpr_kernarg_segment_ptr 1
  .amdhsa_system_sgpr_workgroup_id_x 1
.end_amdhsa_kernel
```
